```python
import torch

def _softmax(x, axis=-1):
    return torch.softmax(x, dim=axis)
def _gelu(x):
    return torch.nn.functional.gelu(x, approximate="tanh")
def _silu(x):
    return torch.nn.functional.silu(x)
def _sigmoid(x):
    return torch.sigmoid(x)
def _layernorm(x, axis=-1, eps=1e-5):
    m = x.mean(dim=axis, keepdim=True)
    v = x.var(dim=axis, keepdim=True, unbiased=False)
    return (x - m) / torch.sqrt(v + eps)
def _scatter_add(tgt, idx, src, axis=0):
    return tgt.clone().index_add_(axis, idx, src)
def _segment_sum(src, seg, n):
    out = torch.zeros((n,) + src.shape[1:], dtype=src.dtype)
    return out.index_add_(0, seg, src)
def _pad(x, pw):
    flat = tuple(v for pair in reversed(pw) for v in pair)
    return torch.nn.functional.pad(x, flat)

kernel_name = 'standalone__detection_seg_mask2former__vision'

def setup_inputs():

    _w = (lambda a: (lambda t: t.to(torch.bfloat16) if t.is_floating_point() else t)(torch.as_tensor(a)))
    H = W = 256
    C = 384
    Hc, Wc = H // 2, W // 2
    nh = 4
    Nq = 16
    sc = C ** -0.5
    return {
        "q": _w((lambda *s: torch.randn(*s, dtype=torch.bfloat16) * 0.2)(1, Nq, C)),
        "f_hi": _w((lambda *s: torch.randn(*s, dtype=torch.bfloat16) * 0.2)(1, H, W, C)),
        "f_lo": _w((lambda *s: torch.randn(*s, dtype=torch.bfloat16) * 0.4)(1, Hc, Wc, C)),
        "w_lat": _w((lambda *s: torch.randn(*s, dtype=torch.bfloat16) * 0.4)(C, C) * sc),
        "w_q": _w((lambda *s: torch.randn(*s, dtype=torch.bfloat16) * 3.2)(nh, C, C // nh) * sc),
        "w_k": _w((lambda *s: torch.randn(*s, dtype=torch.bfloat16) * 3.2)(nh, C, C // nh) * sc),
        "w_v": _w((lambda *s: torch.randn(*s, dtype=torch.bfloat16) * 3.2)(nh, C, C // nh) * sc),
        "w_o": _w((lambda *s: torch.randn(*s, dtype=torch.bfloat16) * 3.2)(C, C) * sc),
        "w_m": _w((lambda *s: torch.randn(*s, dtype=torch.bfloat16) * 1.6)(C, C) * sc),
    }

def reference(q, f_hi, f_lo, w_lat, w_q, w_k, w_v, w_o, w_m):
    B, Nq, C = q.shape
    _, H, W, _ = f_hi.shape
    nh = w_q.shape[0]
    dh = C // nh
    up = (lambda x, n, axis: torch.repeat_interleave(x, n, dim=axis))((lambda x, n, axis: torch.repeat_interleave(x, n, dim=axis))(f_lo, 2, axis=1), 2, axis=2)
    feat = f_hi + up @ w_lat
    feat = _layernorm(feat, axis=-1)
    kv = feat.reshape(B, H * W, C)
    m_embed = q @ w_m
    mask_bias = torch.einsum('bqc,bkc->bqk', m_embed, kv) * (C ** -0.5)
    Q = torch.einsum('bqc,hcd->bhqd', q, w_q)
    K = torch.einsum('bkc,hcd->bhkd', kv, w_k)
    V = torch.einsum('bkc,hcd->bhkd', kv, w_v)
    logits = torch.einsum('bhqd,bhkd->bhqk', Q, K) * (dh ** -0.5)
    logits = logits + mask_bias[:, None, :, :]
    attn = _softmax(logits, axis=-1)
    ctx = torch.einsum('bhqk,bhkd->bqhd', attn, V).reshape(B, Nq, C)
    return q + ctx @ w_o
```

```asm
; @launch grid=(256,1,1) block=(512,1,1) lds=163840
.amdgcn_target "amdgcn-amd-amdhsa--gfx950"
.text
.globl standalone__detection_seg_mask2former__vision_kernel
.p2align 8
.type standalone__detection_seg_mask2former__vision_kernel,@function
standalone__detection_seg_mask2former__vision_kernel:
    s_cmp_ge_u32 s2, 0x100
    s_cbranch_scc1 L_end
    s_load_dwordx16 s[64:79], s[0:1], 0
    s_load_dwordx8 s[80:87], s[0:1], 64
    v_lshrrev_b32 v24, 6, v0
    v_and_b32 v1, 63, v0
    v_readfirstlane_b32 s4, v24
    v_lshlrev_b32 v23, 4, v1
    s_mov_b32 s56, 0
    v_and_b32 v0, 0xff, v0
    s_and_b32 s3, s4, 3
    s_mov_b32 s1, s4
    s_lshr_b32 s57, s2, 4
    s_bfe_u32 s58, s2, 0x20001
    s_cmp_ge_u32 s1, 4
    s_cbranch_scc1 L_swave
    s_bitcmp1_b32 s2, 3
    s_cbranch_scc1 L_uwave
    s_mov_b32 s49, 0
    s_waitcnt lgkmcnt(0)
    s_mov_b32 s12, s68
    s_and_b32 s13, s69, 0xffff
    s_mov_b32 s14, 0xc00000
    s_mov_b32 s15, 0x20000
    s_mul_i32 s6, s2, 0xc000
    s_mul_i32 s4, s3, 0xc00
    s_add_u32 s6, s6, s4
    s_mul_i32 s5, s3, 0x3000
    s_add_u32 m0, s5, 0x1c000
    s_lshl_b32 s4, s3, 6
    v_xor_b32 v28, s4, v23
    s_mov_b32 s7, 0x901090
    s_mov_b32 exec_hi, 0xffff
    v_xor_b32 v29, 64, v28
    v_xor_b32 v30, 32, v28
    v_xor_b32 v31, 0x60, v28
L_fo_1:
    s_add_u32 s41, s6, 0
    buffer_load_dwordx4 v28, s[12:15], s41 offen nt lds
    s_add_u32 m0, m0, 0x300
    s_add_u32 s41, s6, 0x3000
    buffer_load_dwordx4 v29, s[12:15], s41 offen nt lds
    s_add_u32 m0, m0, 0x300
    s_add_u32 s41, s6, 0x6000
    buffer_load_dwordx4 v30, s[12:15], s41 offen nt lds
    s_add_u32 m0, m0, 0x300
    s_add_u32 s41, s6, 0x9000
    buffer_load_dwordx4 v31, s[12:15], s41 offen nt lds
    s_and_b32 s4, s7, 0xff
    s_add_u32 m0, m0, 0x300
    s_add_u32 s6, s6, 0x300
    v_xor_b32 v28, s4, v28
    v_xor_b32 v29, s4, v29
    v_xor_b32 v30, s4, v30
    v_xor_b32 v31, s4, v31
    s_lshr_b32 s7, s7, 8
    s_cmp_lg_u32 s4, 0
    s_cbranch_scc1 L_fo_1
    s_mov_b32 exec_hi, -1
    s_branch L_urest
L_swave:
    s_mov_b32 s49, 0
    s_bitcmp1_b32 s2, 3
    s_cbranch_scc0 L_early0
    s_cmp_lt_u32 s57, 6
    s_cbranch_scc1 L_prodA
    s_cmp_lt_u32 s57, 9
    s_cbranch_scc1 L_prodV
    s_waitcnt lgkmcnt(0)
    s_mov_b32 s28, s72
    s_and_b32 s29, s73, 0xffff
    s_mov_b32 s30, 0x48000
    s_mov_b32 s31, 0x20000
    s_mul_i32 s4, s58, 0x12000
    s_sub_u32 s5, s57, 9
    s_mul_i32 s5, s5, 0x2980
    s_add_u32 s4, s4, s5
    v_min_u32 v24, 0x52, v0
    s_cmp_ge_u32 s3, 2
    v_lshlrev_b32 v24, 7, v24
    s_cbranch_scc1 L_tc_2
    buffer_load_dword v27, v24, s[28:31], s4 offen
L_tc_2:
    s_mov_b32 s16, s70
    s_and_b32 s17, s71, 0xffff
    s_mov_b32 s18, 0x48000
    s_mov_b32 s19, 0x20000
L_late2:
    s_mov_b32 s8, s66
    s_and_b32 s9, s67, 0xffff
    s_mov_b32 s10, 0x3000000
    s_mov_b32 s11, 0x20000
    s_mov_b32 s20, s86
    s_and_b32 s21, s87, 0xffff
    s_mov_b32 s22, 0x10000000
    s_mov_b32 s23, 0x20000
    s_mov_b32 s24, s84
    s_and_b32 s25, s85, 0xffff
    s_mov_b32 s26, 0x100
    s_mov_b32 s27, 0x20000
    s_mov_b32 s88, 0x30000
    v_add_u32 v24, 0, v1
    v_mul_u32_u24 v25, 0x556, v24
    v_lshrrev_b32 v60, 16, v25
    v_mul_u32_u24 v25, 48, v60
    v_sub_u32 v24, v24, v25
    v_lshlrev_b32 v25, 2, v60
    v_xor_b32 v24, v24, v25
    v_lshlrev_b32 v24, 4, v24
    v_and_b32 v25, 1, v60
    v_mul_u32_u24 v25, 0x300, v25
    v_add_u32 v24, v24, v25
    v_lshrrev_b32 v25, 1, v60
    v_mul_lo_u32 v25, v25, s88
    v_add_u32 v2, v24, v25
    v_xor_b32 v5, 32, v2
    v_add_u32 v24, 64, v1
    v_mul_u32_u24 v25, 0x556, v24
    v_lshrrev_b32 v60, 16, v25
    v_mul_u32_u24 v25, 48, v60
    v_sub_u32 v24, v24, v25
    v_lshlrev_b32 v25, 2, v60
    v_xor_b32 v24, v24, v25
    v_lshlrev_b32 v24, 4, v24
    v_and_b32 v25, 1, v60
    v_mul_u32_u24 v25, 0x300, v25
    v_add_u32 v24, v24, v25
    v_lshrrev_b32 v25, 1, v60
    v_mul_lo_u32 v25, v25, s88
    v_add_u32 v3, v24, v25
    v_subrev_u32 v3, 0x400, v3
    v_xor_b32 v6, 32, v3
    v_add_u32 v24, 0x80, v1
    v_mul_u32_u24 v25, 0x556, v24
    v_lshrrev_b32 v60, 16, v25
    v_mul_u32_u24 v25, 48, v60
    v_sub_u32 v24, v24, v25
    v_lshlrev_b32 v25, 2, v60
    v_xor_b32 v24, v24, v25
    v_lshlrev_b32 v24, 4, v24
    v_and_b32 v25, 1, v60
    v_mul_u32_u24 v25, 0x300, v25
    v_add_u32 v24, v24, v25
    v_lshrrev_b32 v25, 1, v60
    v_mul_lo_u32 v25, v25, s88
    v_add_u32 v4, v24, v25
    v_subrev_u32 v4, 0x800, v4
    v_xor_b32 v7, 32, v4
    s_lshr_b32 s4, s2, 1
    s_mul_i32 s40, s4, 0x60000
    s_and_b32 s4, s2, 1
    s_mul_i32 s4, s4, 0x18000
    s_add_u32 s40, s40, s4
    s_mul_i32 s4, s3, 0x1800
    s_add_u32 s40, s40, s4
    s_mul_i32 s101, s3, 0x3000
    s_add_u32 s42, s40, 0
    buffer_load_dwordx4 v[64:67], v2, s[8:11], s42 offen nt
    buffer_load_dwordx4 v[68:71], v3, s[8:11], s42 offen offset:1024 nt
    buffer_load_dwordx4 v[72:75], v4, s[8:11], s42 offen offset:2048 nt
    s_add_u32 s42, s40, 0x600
    buffer_load_dwordx4 v[76:79], v5, s[8:11], s42 offen nt
    buffer_load_dwordx4 v[80:83], v6, s[8:11], s42 offen offset:1024 nt
    buffer_load_dwordx4 v[84:87], v7, s[8:11], s42 offen offset:2048 nt
    s_add_u32 s42, s40, 0xc00
    buffer_load_dwordx4 v[88:91], v2, s[8:11], s42 offen nt
    buffer_load_dwordx4 v[92:95], v3, s[8:11], s42 offen offset:1024 nt
    buffer_load_dwordx4 v[96:99], v4, s[8:11], s42 offen offset:2048 nt
    s_add_u32 s42, s40, 0x1200
    buffer_load_dwordx4 v[100:103], v5, s[8:11], s42 offen nt
    buffer_load_dwordx4 v[104:107], v6, s[8:11], s42 offen offset:1024 nt
    buffer_load_dwordx4 v[108:111], v7, s[8:11], s42 offen offset:2048 nt
    s_mul_i32 s43, s3, 0x1800
    s_mov_b32 s98, s43
    s_and_b32 s4, s3, 1
    s_lshl_b32 s4, s4, 3
    v_add_u32 v24, 0, v1
    v_mul_u32_u24 v25, 0x556, v24
    v_lshrrev_b32 v60, 16, v25
    v_mul_u32_u24 v25, 48, v60
    v_sub_u32 v24, v24, v25
    v_lshl_or_b32 v25, v60, 1, s4
    v_xor_b32 v24, v24, v25
    v_mul_u32_u24 v25, 0x300, v60
    v_lshl_add_u32 v32, v24, 4, v25
    v_add_u32 v24, 64, v1
    v_mul_u32_u24 v25, 0x556, v24
    v_lshrrev_b32 v60, 16, v25
    v_mul_u32_u24 v25, 48, v60
    v_sub_u32 v24, v24, v25
    v_lshl_or_b32 v25, v60, 1, s4
    v_xor_b32 v24, v24, v25
    v_mul_u32_u24 v25, 0x300, v60
    v_lshl_add_u32 v33, v24, 4, v25
    v_subrev_u32 v33, 0x400, v33
    v_add_u32 v24, 0x80, v1
    v_mul_u32_u24 v25, 0x556, v24
    v_lshrrev_b32 v60, 16, v25
    v_mul_u32_u24 v25, 48, v60
    v_sub_u32 v24, v24, v25
    v_lshl_or_b32 v25, v60, 1, s4
    v_xor_b32 v24, v24, v25
    v_mul_u32_u24 v25, 0x300, v60
    v_lshl_add_u32 v34, v24, 4, v25
    v_subrev_u32 v34, 0x800, v34
    v_and_b32 v24, 15, v1
    v_lshrrev_b32 v25, 2, v24
    v_lshrrev_b32 v26, 3, v24
    v_xor_b32 v26, v25, v26
    v_and_b32 v26, 1, v26
    v_lshlrev_b32 v26, 3, v26
    v_and_b32 v25, 1, v25
    v_or_b32 v26, v26, v25
    v_and_b32 v25, 1, v24
    v_lshl_or_b32 v26, v25, 2, v26
    v_and_b32 v25, 2, v24
    v_or_b32 v26, v26, v25
    v_lshrrev_b32 v25, 4, v1
    v_xor_b32 v26, v26, v25
    v_lshlrev_b32 v26, 4, v26
    v_mul_u32_u24 v24, 0x300, v24
    v_add_u32 v24, 0x1c000, v24
    v_xor_b32 v25, 0, v26
    v_add_u32 v36, v24, v25
    v_xor_b32 v25, 64, v26
    v_add_u32 v37, v24, v25
    v_xor_b32 v25, 0x80, v26
    v_add_u32 v38, v24, v25
    v_xor_b32 v25, 0xc0, v26
    v_add_u32 v39, v24, v25
    v_lshrrev_b32 v56, 4, v1
    v_and_b32 v57, 15, v1
    v_lshrrev_b32 v61, 2, v57
    v_and_b32 v24, 3, v57
    v_lshlrev_b32 v24, 2, v24
    v_lshrrev_b32 v25, 1, v57
    v_and_b32 v25, 2, v25
    v_or_b32 v24, v24, v25
    v_xor_b32 v24, v24, v56
    v_lshlrev_b32 v24, 4, v24
    v_mul_u32_u24 v25, 0x300, v57
    s_mul_i32 s4, s3, 0x3000
    v_xor_b32 v26, 0, v24
    v_add_u32 v8, v25, v26
    v_add_u32 v12, s4, v8
    v_xor_b32 v26, 64, v24
    v_add_u32 v9, v25, v26
    v_add_u32 v13, s4, v9
    v_xor_b32 v26, 0x80, v24
    v_add_u32 v10, v25, v26
    v_add_u32 v14, s4, v10
    v_xor_b32 v26, 0xc0, v24
    v_add_u32 v11, v25, v26
    v_add_u32 v15, s4, v11
    s_lshl_b32 s4, s3, 11
    s_add_u32 s4, s4, 0xc000
    v_lshrrev_b32 v24, 1, v57
    v_lshrrev_b32 v25, 1, v56
    v_xor_b32 v24, v24, v25
    v_lshlrev_b32 v24, 4, v24
    v_and_b32 v25, 1, v56
    v_lshl_add_u32 v24, v25, 3, v24
    v_lshlrev_b32 v25, 7, v57
    v_add_u32 v25, s4, v25
    v_xor_b32 v26, 0, v24
    v_add_u32 v16, v25, v26
    v_xor_b32 v26, 32, v24
    v_add_u32 v17, v25, v26
    v_xor_b32 v26, 64, v24
    v_add_u32 v18, v25, v26
    v_xor_b32 v26, 0x60, v24
    v_add_u32 v19, v25, v26
    s_lshl_b32 s4, s3, 9
    s_add_u32 s4, s4, 0xe000
    v_lshlrev_b32 v24, 5, v57
    v_add_u32 v24, s4, v24
    v_lshrrev_b32 v25, 1, v56
    v_lshrrev_b32 v26, 3, v57
    v_xor_b32 v25, v25, v26
    v_lshl_add_u32 v24, v25, 4, v24
    v_and_b32 v25, 1, v56
    v_lshl_add_u32 v20, v25, 3, v24
    v_lshlrev_b32 v24, 4, v56
    v_add_u32 v21, 0xe800, v24
    s_lshl_b32 s4, s3, 6
    s_add_u32 s4, s4, 0xe800
    v_lshlrev_b32 v24, 2, v57
    v_add_u32 v24, s4, v24
    v_lshlrev_b32 v25, 2, v1
    v_add_u32 v25, 0xf100, v25
    v_cmp_eq_u32 vcc, v61, v56
    s_nop 1
    v_cndmask_b32 v22, v25, v24, vcc
    s_mov_b32 s92, 0x22222222
    s_mov_b32 s93, 0x22222222
    s_mov_b32 s94, 0xcccccccc
    s_mov_b32 s95, 0xcccccccc
    s_mov_b32 s96, 0x88888888
    s_mov_b32 s97, 0x88888888
    s_mov_b32 s89, 0x3b2aaaab
    s_mov_b32 s90, 0x3727c5ac
    s_mov_b32 s91, 0x4e800000
    s_mul_i32 s58, s3, 0x12000
    s_add_u32 s58, s58, 0x10000
    s_branch L_late
L_prodA:
    s_and_b32 s4, s2, 1
    s_mul_i32 s59, s4, 6
    s_add_u32 s59, s59, s57
    s_waitcnt lgkmcnt(0)
    s_mov_b32 s32, s80
    s_and_b32 s33, s81, 0xffff
    s_mov_b32 s34, 0x48000
    s_mov_b32 s35, 0x20000
    v_lshrrev_b32 v24, 2, v1
    v_mul_u32_u24 v24, 0x300, v24
    v_and_b32 v25, 3, v1
    v_lshl_add_u32 v232, v25, 4, v24
    s_mul_i32 s41, s3, 0x12000
    s_lshl_b32 s4, s59, 6
    s_add_u32 s41, s41, s4
    s_mul_i32 s5, s3, 0x1800
    s_add_u32 s5, s5, 0x16000
    s_add_u32 m0, s5, 0
    s_add_u32 s42, s41, 0
    buffer_load_dwordx4 v232, s[32:35], s42 offen lds
    s_add_u32 m0, s5, 0x400
    s_add_u32 s42, s41, 0x3000
    buffer_load_dwordx4 v232, s[32:35], s42 offen lds
    s_add_u32 m0, s5, 0x800
    s_add_u32 s42, s41, 0x6000
    buffer_load_dwordx4 v232, s[32:35], s42 offen lds
    s_add_u32 m0, s5, 0xc00
    s_add_u32 s42, s41, 0x9000
    buffer_load_dwordx4 v232, s[32:35], s42 offen lds
    s_add_u32 m0, s5, 0x1000
    s_add_u32 s42, s41, 0xc000
    buffer_load_dwordx4 v232, s[32:35], s42 offen lds
    s_add_u32 m0, s5, 0x1400
    s_add_u32 s42, s41, 0xf000
    buffer_load_dwordx4 v232, s[32:35], s42 offen lds
    s_mov_b32 s36, s64
    s_and_b32 s37, s65, 0xffff
    s_mov_b32 s38, 0x3000
    s_mov_b32 s39, 0x20000
    s_lshl_b32 s4, s3, 2
    s_lshr_b32 s4, 0x1890, s4
    s_and_b32 s4, s4, 15
    s_lshl_b32 s4, s4, 4
    s_mul_i32 s6, s3, 0xc00
    s_add_u32 s5, s6, 0xc000
    s_xor_b32 s88, s4, 0
    s_xor_b32 s89, s4, 64
    s_xor_b32 s90, s4, 32
    s_xor_b32 s91, s4, 0x60
    s_mov_b32 exec_hi, 0xffff
    s_add_u32 m0, s5, 0
    s_add_u32 s41, s6, 0
    v_xor_b32 v24, s88, v23
    buffer_load_dwordx4 v24, s[36:39], s41 offen lds
    s_add_u32 m0, s5, 0x300
    s_add_u32 s41, s6, 0x300
    v_xor_b32 v24, s89, v23
    buffer_load_dwordx4 v24, s[36:39], s41 offen lds
    s_add_u32 m0, s5, 0x600
    s_add_u32 s41, s6, 0x600
    v_xor_b32 v24, s90, v23
    buffer_load_dwordx4 v24, s[36:39], s41 offen lds
    s_add_u32 m0, s5, 0x900
    s_add_u32 s41, s6, 0x900
    v_xor_b32 v24, s91, v23
    buffer_load_dwordx4 v24, s[36:39], s41 offen lds
    s_mov_b32 exec_hi, -1
    v_lshrrev_b32 v24, 4, v1
    v_lshlrev_b32 v25, 3, v24
    v_bfe_u32 v26, v1, 2, 2
    v_add_u32 v25, v25, v26
    v_mul_u32_u24 v25, 0xc0, v25
    v_and_b32 v26, 3, v1
    v_lshl_add_u32 v25, v26, 3, v25
    v_and_b32 v24, 1, v24
    v_lshlrev_b32 v24, 5, v24
    v_add_u32 v236, v25, v24
    v_sub_u32 v237, v25, v24
    v_and_b32 v24, 15, v1
    v_lshrrev_b32 v25, 2, v24
    v_lshrrev_b32 v26, 3, v24
    v_xor_b32 v26, v25, v26
    v_and_b32 v26, 1, v26
    v_lshlrev_b32 v26, 3, v26
    v_and_b32 v25, 1, v25
    v_or_b32 v26, v26, v25
    v_and_b32 v25, 1, v24
    v_lshl_or_b32 v26, v25, 2, v26
    v_and_b32 v25, 2, v24
    v_or_b32 v26, v26, v25
    v_lshrrev_b32 v25, 4, v1
    v_xor_b32 v26, v26, v25
    v_lshlrev_b32 v26, 4, v26
    v_mul_u32_u24 v24, 0x300, v24
    v_add_u32 v24, 0xc000, v24
    v_xor_b32 v25, 0, v26
    v_add_u32 v240, v24, v25
    v_xor_b32 v25, 64, v26
    v_add_u32 v241, v24, v25
    v_xor_b32 v25, 0x80, v26
    v_add_u32 v242, v24, v25
    v_xor_b32 v25, 0xc0, v26
    v_add_u32 v243, v24, v25
    s_lshl_b32 s4, s3, 6
    v_add_u32 v236, s4, v236
    v_add_u32 v237, s4, v237
    v_add_u32 v238, 0x10000, v236
    v_add_u32 v239, 0x10000, v237
    v_lshrrev_b32 v24, 4, v1
    v_lshlrev_b32 v24, 3, v24
    v_bfe_u32 v25, v1, 2, 2
    v_add_u32 v24, v24, v25
    v_lshlrev_b32 v24, 6, v24
    v_and_b32 v25, 3, v1
    v_lshl_add_u32 v24, v25, 4, v24
    v_add_u32 v244, 0x16000, v24
    s_mov_b32 s20, s86
    s_and_b32 s21, s87, 0xffff
    s_mov_b32 s22, 0x10000000
    s_mov_b32 s23, 0x20000
    s_mov_b32 s24, s84
    s_and_b32 s25, s85, 0xffff
    s_mov_b32 s26, 0x100
    s_mov_b32 s27, 0x20000
    s_mov_b32 s16, s70
    s_and_b32 s17, s71, 0xffff
    s_mov_b32 s18, 0x48000
    s_mov_b32 s19, 0x20000
    s_mov_b32 s8, s66
    s_and_b32 s9, s67, 0xffff
    s_mov_b32 s10, 0x3000000
    s_mov_b32 s11, 0x20000
    s_mov_b32 s47, s58
    s_mul_i32 s43, s3, 0x1800
    s_mov_b32 s98, s43
    s_and_b32 s4, s3, 1
    s_lshl_b32 s4, s4, 3
    v_add_u32 v24, 0, v1
    v_mul_u32_u24 v25, 0x556, v24
    v_lshrrev_b32 v60, 16, v25
    v_mul_u32_u24 v25, 48, v60
    v_sub_u32 v24, v24, v25
    v_lshl_or_b32 v25, v60, 1, s4
    v_xor_b32 v24, v24, v25
    v_mul_u32_u24 v25, 0x300, v60
    v_lshl_add_u32 v32, v24, 4, v25
    v_add_u32 v24, 64, v1
    v_mul_u32_u24 v25, 0x556, v24
    v_lshrrev_b32 v60, 16, v25
    v_mul_u32_u24 v25, 48, v60
    v_sub_u32 v24, v24, v25
    v_lshl_or_b32 v25, v60, 1, s4
    v_xor_b32 v24, v24, v25
    v_mul_u32_u24 v25, 0x300, v60
    v_lshl_add_u32 v33, v24, 4, v25
    v_subrev_u32 v33, 0x400, v33
    v_add_u32 v24, 0x80, v1
    v_mul_u32_u24 v25, 0x556, v24
    v_lshrrev_b32 v60, 16, v25
    v_mul_u32_u24 v25, 48, v60
    v_sub_u32 v24, v24, v25
    v_lshl_or_b32 v25, v60, 1, s4
    v_xor_b32 v24, v24, v25
    v_mul_u32_u24 v25, 0x300, v60
    v_lshl_add_u32 v34, v24, 4, v25
    v_subrev_u32 v34, 0x800, v34
    v_lshrrev_b32 v56, 4, v1
    v_and_b32 v57, 15, v1
    v_lshrrev_b32 v61, 2, v57
    v_and_b32 v24, 3, v57
    v_lshlrev_b32 v24, 2, v24
    v_lshrrev_b32 v25, 1, v57
    v_and_b32 v25, 2, v25
    v_or_b32 v24, v24, v25
    v_xor_b32 v24, v24, v56
    v_lshlrev_b32 v24, 4, v24
    v_mul_u32_u24 v25, 0x300, v57
    s_mul_i32 s4, s3, 0x3000
    v_xor_b32 v26, 0, v24
    v_add_u32 v8, v25, v26
    v_add_u32 v12, s4, v8
    v_xor_b32 v26, 64, v24
    v_add_u32 v9, v25, v26
    v_add_u32 v13, s4, v9
    v_xor_b32 v26, 0x80, v24
    v_add_u32 v10, v25, v26
    v_add_u32 v14, s4, v10
    v_xor_b32 v26, 0xc0, v24
    v_add_u32 v11, v25, v26
    v_add_u32 v15, s4, v11
    s_lshl_b32 s4, s3, 11
    s_add_u32 s4, s4, 0xc000
    v_lshrrev_b32 v24, 1, v57
    v_lshrrev_b32 v25, 1, v56
    v_xor_b32 v24, v24, v25
    v_lshlrev_b32 v24, 4, v24
    v_and_b32 v25, 1, v56
    v_lshl_add_u32 v24, v25, 3, v24
    v_lshlrev_b32 v25, 7, v57
    v_add_u32 v25, s4, v25
    v_xor_b32 v26, 0, v24
    v_add_u32 v16, v25, v26
    v_xor_b32 v26, 32, v24
    v_add_u32 v17, v25, v26
    v_xor_b32 v26, 64, v24
    v_add_u32 v18, v25, v26
    v_xor_b32 v26, 0x60, v24
    v_add_u32 v19, v25, v26
    s_lshl_b32 s4, s3, 9
    s_add_u32 s4, s4, 0xe000
    v_lshlrev_b32 v24, 5, v57
    v_add_u32 v24, s4, v24
    v_lshrrev_b32 v25, 1, v56
    v_lshrrev_b32 v26, 3, v57
    v_xor_b32 v25, v25, v26
    v_lshl_add_u32 v24, v25, 4, v24
    v_and_b32 v25, 1, v56
    v_lshl_add_u32 v20, v25, 3, v24
    v_lshlrev_b32 v24, 4, v56
    v_add_u32 v21, 0xe800, v24
    s_lshl_b32 s4, s3, 6
    s_add_u32 s4, s4, 0xe800
    v_lshlrev_b32 v24, 2, v57
    v_add_u32 v24, s4, v24
    v_lshlrev_b32 v25, 2, v1
    v_add_u32 v25, 0xf100, v25
    v_cmp_eq_u32 vcc, v61, v56
    s_nop 1
    v_cndmask_b32 v22, v25, v24, vcc
    s_mov_b32 s92, 0x22222222
    s_mov_b32 s93, 0x22222222
    s_mov_b32 s94, 0xcccccccc
    s_mov_b32 s95, 0xcccccccc
    s_mov_b32 s96, 0x88888888
    s_mov_b32 s97, 0x88888888
    s_mov_b32 s89, 0x3b2aaaab
    s_mov_b32 s90, 0x3727c5ac
    s_mov_b32 s91, 0x4e800000
    s_mul_i32 s58, s3, 0x12000
    s_add_u32 s58, s58, 0x10000
    s_mov_b32 s28, s72
    s_and_b32 s29, s73, 0xffff
    s_mov_b32 s30, 0x48000
    s_mov_b32 s31, 0x20000
    v_add_u32 v24, 0, v1
    v_mul_u32_u24 v25, 0x1556, v24
    v_lshrrev_b32 v25, 16, v25
    v_mul_u32_u24 v26, 12, v25
    v_sub_u32 v24, v24, v26
    v_lshrrev_b32 v26, 2, v25
    v_and_b32 v26, 2, v26
    v_xor_b32 v24, v24, v26
    v_lshlrev_b32 v24, 4, v24
    v_mul_u32_u24 v25, 0xc0, v25
    v_add_u32 v233, v24, v25
    v_add_u32 v24, 64, v1
    v_mul_u32_u24 v25, 0x1556, v24
    v_lshrrev_b32 v25, 16, v25
    v_mul_u32_u24 v26, 12, v25
    v_sub_u32 v24, v24, v26
    v_lshrrev_b32 v26, 2, v25
    v_and_b32 v26, 2, v26
    v_xor_b32 v24, v24, v26
    v_lshlrev_b32 v24, 4, v24
    v_mul_u32_u24 v25, 0xc0, v25
    v_add_u32 v234, v24, v25
    v_add_u32 v24, 0x80, v1
    v_mul_u32_u24 v25, 0x1556, v24
    v_lshrrev_b32 v25, 16, v25
    v_mul_u32_u24 v26, 12, v25
    v_sub_u32 v24, v24, v26
    v_lshrrev_b32 v26, 2, v25
    v_and_b32 v26, 2, v26
    v_xor_b32 v24, v24, v26
    v_lshlrev_b32 v24, 4, v24
    v_mul_u32_u24 v25, 0xc0, v25
    v_add_u32 v235, v24, v25
    s_mul_i32 s41, s47, 0x12000
    s_mul_i32 s4, s3, 0x4800
    s_add_u32 s41, s41, s4
    s_mul_i32 s4, s3, 3
    s_add_u32 s4, s4, 0
    s_mul_i32 s5, s4, 0x1800
    s_cmp_ge_u32 s4, 8
    s_cselect_b32 s6, 0x4000, 0
    s_add_u32 s5, s5, s6
    s_add_u32 m0, s5, 0
    s_add_u32 s42, s41, 0
    buffer_load_dwordx4 v233, s[28:31], s42 offen lds
    s_add_u32 m0, s5, 0x400
    s_add_u32 s42, s41, 0
    buffer_load_dwordx4 v234, s[28:31], s42 offen lds
    s_add_u32 m0, s5, 0x800
    s_add_u32 s42, s41, 0
    buffer_load_dwordx4 v235, s[28:31], s42 offen lds
    s_add_u32 m0, s5, 0xc00
    s_add_u32 s42, s41, 0xc00
    buffer_load_dwordx4 v233, s[28:31], s42 offen lds
    s_add_u32 m0, s5, 0x1000
    s_add_u32 s42, s41, 0xc00
    buffer_load_dwordx4 v234, s[28:31], s42 offen lds
    s_add_u32 m0, s5, 0x1400
    s_add_u32 s42, s41, 0xc00
    buffer_load_dwordx4 v235, s[28:31], s42 offen lds
    s_mul_i32 s4, s3, 3
    s_add_u32 s4, s4, 1
    s_mul_i32 s5, s4, 0x1800
    s_cmp_ge_u32 s4, 8
    s_cselect_b32 s6, 0x4000, 0
    s_add_u32 s5, s5, s6
    s_add_u32 m0, s5, 0
    s_add_u32 s42, s41, 0x1800
    buffer_load_dwordx4 v233, s[28:31], s42 offen lds
    s_add_u32 m0, s5, 0x400
    s_add_u32 s42, s41, 0x1800
    buffer_load_dwordx4 v234, s[28:31], s42 offen lds
    s_add_u32 m0, s5, 0x800
    s_add_u32 s42, s41, 0x1800
    buffer_load_dwordx4 v235, s[28:31], s42 offen lds
    s_add_u32 m0, s5, 0xc00
    s_add_u32 s42, s41, 0x2400
    buffer_load_dwordx4 v233, s[28:31], s42 offen lds
    s_add_u32 m0, s5, 0x1000
    s_add_u32 s42, s41, 0x2400
    buffer_load_dwordx4 v234, s[28:31], s42 offen lds
    s_add_u32 m0, s5, 0x1400
    s_add_u32 s42, s41, 0x2400
    buffer_load_dwordx4 v235, s[28:31], s42 offen lds
    s_mul_i32 s4, s3, 3
    s_add_u32 s4, s4, 2
    s_mul_i32 s5, s4, 0x1800
    s_cmp_ge_u32 s4, 8
    s_cselect_b32 s6, 0x4000, 0
    s_add_u32 s5, s5, s6
    s_add_u32 m0, s5, 0
    s_add_u32 s42, s41, 0x3000
    buffer_load_dwordx4 v233, s[28:31], s42 offen lds
    s_add_u32 m0, s5, 0x400
    s_add_u32 s42, s41, 0x3000
    buffer_load_dwordx4 v234, s[28:31], s42 offen lds
    s_add_u32 m0, s5, 0x800
    s_add_u32 s42, s41, 0x3000
    buffer_load_dwordx4 v235, s[28:31], s42 offen lds
    s_add_u32 m0, s5, 0xc00
    s_add_u32 s42, s41, 0x3c00
    buffer_load_dwordx4 v233, s[28:31], s42 offen lds
    s_add_u32 m0, s5, 0x1000
    s_add_u32 s42, s41, 0x3c00
    buffer_load_dwordx4 v234, s[28:31], s42 offen lds
    s_add_u32 m0, s5, 0x1400
    s_add_u32 s42, s41, 0x3c00
    buffer_load_dwordx4 v235, s[28:31], s42 offen lds
    s_barrier
    v_and_b32 v24, 15, v1
    v_lshrrev_b32 v25, 2, v24
    v_lshrrev_b32 v26, 3, v24
    v_xor_b32 v26, v25, v26
    v_and_b32 v26, 1, v26
    v_lshlrev_b32 v26, 3, v26
    v_and_b32 v25, 1, v25
    v_or_b32 v26, v26, v25
    v_and_b32 v25, 1, v24
    v_lshl_or_b32 v26, v25, 2, v26
    v_and_b32 v25, 2, v24
    v_or_b32 v26, v26, v25
    v_lshrrev_b32 v25, 4, v1
    v_xor_b32 v26, v26, v25
    v_lshlrev_b32 v26, 4, v26
    v_mul_u32_u24 v24, 0x300, v24
    v_add_u32 v24, 0x1c000, v24
    v_xor_b32 v25, 0, v26
    v_add_u32 v36, v24, v25
    v_xor_b32 v25, 64, v26
    v_add_u32 v37, v24, v25
    v_xor_b32 v25, 0x80, v26
    v_add_u32 v38, v24, v25
    v_xor_b32 v25, 0xc0, v26
    v_add_u32 v39, v24, v25
    s_mov_b32 s88, 0x30000
    v_add_u32 v24, 0, v1
    v_mul_u32_u24 v25, 0x556, v24
    v_lshrrev_b32 v60, 16, v25
    v_mul_u32_u24 v25, 48, v60
    v_sub_u32 v24, v24, v25
    v_lshlrev_b32 v25, 2, v60
    v_xor_b32 v24, v24, v25
    v_lshlrev_b32 v24, 4, v24
    v_and_b32 v25, 1, v60
    v_mul_u32_u24 v25, 0x300, v25
    v_add_u32 v24, v24, v25
    v_lshrrev_b32 v25, 1, v60
    v_mul_lo_u32 v25, v25, s88
    v_add_u32 v2, v24, v25
    v_xor_b32 v5, 32, v2
    v_add_u32 v24, 64, v1
    v_mul_u32_u24 v25, 0x556, v24
    v_lshrrev_b32 v60, 16, v25
    v_mul_u32_u24 v25, 48, v60
    v_sub_u32 v24, v24, v25
    v_lshlrev_b32 v25, 2, v60
    v_xor_b32 v24, v24, v25
    v_lshlrev_b32 v24, 4, v24
    v_and_b32 v25, 1, v60
    v_mul_u32_u24 v25, 0x300, v25
    v_add_u32 v24, v24, v25
    v_lshrrev_b32 v25, 1, v60
    v_mul_lo_u32 v25, v25, s88
    v_add_u32 v3, v24, v25
    v_subrev_u32 v3, 0x400, v3
    v_xor_b32 v6, 32, v3
    v_add_u32 v24, 0x80, v1
    v_mul_u32_u24 v25, 0x556, v24
    v_lshrrev_b32 v60, 16, v25
    v_mul_u32_u24 v25, 48, v60
    v_sub_u32 v24, v24, v25
    v_lshlrev_b32 v25, 2, v60
    v_xor_b32 v24, v24, v25
    v_lshlrev_b32 v24, 4, v24
    v_and_b32 v25, 1, v60
    v_mul_u32_u24 v25, 0x300, v25
    v_add_u32 v24, v24, v25
    v_lshrrev_b32 v25, 1, v60
    v_mul_lo_u32 v25, v25, s88
    v_add_u32 v4, v24, v25
    v_subrev_u32 v4, 0x800, v4
    v_xor_b32 v7, 32, v4
    s_lshr_b32 s4, s2, 1
    s_mul_i32 s40, s4, 0x60000
    s_and_b32 s4, s2, 1
    s_mul_i32 s4, s4, 0x18000
    s_add_u32 s40, s40, s4
    s_mul_i32 s4, s3, 0x1800
    s_add_u32 s40, s40, s4
    s_mul_i32 s101, s3, 0x3000
    s_waitcnt vmcnt(0)
    s_barrier
    s_cmp_eq_u32 s3, 3
    s_cbranch_scc1 L_pam_3
    ds_read_b128 v[88:91], v240
    ds_read_b64_tr_b16 v[136:137], v236
    ds_read_b64_tr_b16 v[138:139], v236 offset:768
    ds_read_b64_tr_b16 v[140:141], v237 offset:32
    ds_read_b64_tr_b16 v[142:143], v237 offset:800
    ds_read_b128 v[92:95], v241
    ds_read_b64_tr_b16 v[144:145], v236 offset:6144
    ds_read_b64_tr_b16 v[146:147], v236 offset:6912
    ds_read_b64_tr_b16 v[148:149], v237 offset:6176
    ds_read_b64_tr_b16 v[150:151], v237 offset:6944
    ds_read_b128 v[96:99], v242
    ds_read_b64_tr_b16 v[152:153], v236 offset:12288
    ds_read_b64_tr_b16 v[154:155], v236 offset:13056
    ds_read_b64_tr_b16 v[156:157], v237 offset:12320
    ds_read_b64_tr_b16 v[158:159], v237 offset:13088
    s_waitcnt lgkmcnt(11)
    v_mfma_f32_16x16x32_bf16 v[56:59], v[136:139], v[88:91], 0
    s_waitcnt lgkmcnt(9)
    v_mfma_f32_16x16x32_bf16 v[60:63], v[140:143], v[88:91], 0
    ds_read_b128 v[100:103], v243
    ds_read_b64_tr_b16 v[160:161], v236 offset:18432
    ds_read_b64_tr_b16 v[162:163], v236 offset:19200
    ds_read_b64_tr_b16 v[164:165], v237 offset:18464
    ds_read_b64_tr_b16 v[166:167], v237 offset:19232
    s_waitcnt lgkmcnt(11)
    v_mfma_f32_16x16x32_bf16 v[56:59], v[144:147], v[92:95], v[56:59]
    s_waitcnt lgkmcnt(9)
    v_mfma_f32_16x16x32_bf16 v[60:63], v[148:151], v[92:95], v[60:63]
    ds_read_b128 v[104:107], v240 offset:256
    ds_read_b64_tr_b16 v[168:169], v236 offset:24576
    ds_read_b64_tr_b16 v[170:171], v236 offset:25344
    ds_read_b64_tr_b16 v[172:173], v237 offset:24608
    ds_read_b64_tr_b16 v[174:175], v237 offset:25376
    s_waitcnt lgkmcnt(11)
    v_mfma_f32_16x16x32_bf16 v[56:59], v[152:155], v[96:99], v[56:59]
    s_waitcnt lgkmcnt(9)
    v_mfma_f32_16x16x32_bf16 v[60:63], v[156:159], v[96:99], v[60:63]
    ds_read_b128 v[108:111], v241 offset:256
    ds_read_b64_tr_b16 v[176:177], v236 offset:30720
    ds_read_b64_tr_b16 v[178:179], v236 offset:31488
    ds_read_b64_tr_b16 v[180:181], v237 offset:30752
    ds_read_b64_tr_b16 v[182:183], v237 offset:31520
    s_waitcnt lgkmcnt(11)
    v_mfma_f32_16x16x32_bf16 v[56:59], v[160:163], v[100:103], v[56:59]
    s_waitcnt lgkmcnt(9)
    v_mfma_f32_16x16x32_bf16 v[60:63], v[164:167], v[100:103], v[60:63]
    ds_read_b128 v[112:115], v242 offset:256
    ds_read_b64_tr_b16 v[184:185], v236 offset:36864
    ds_read_b64_tr_b16 v[186:187], v236 offset:37632
    ds_read_b64_tr_b16 v[188:189], v237 offset:36896
    ds_read_b64_tr_b16 v[190:191], v237 offset:37664
    s_waitcnt lgkmcnt(11)
    v_mfma_f32_16x16x32_bf16 v[56:59], v[168:171], v[104:107], v[56:59]
    s_waitcnt lgkmcnt(9)
    v_mfma_f32_16x16x32_bf16 v[60:63], v[172:175], v[104:107], v[60:63]
    ds_read_b128 v[116:119], v243 offset:256
    ds_read_b64_tr_b16 v[192:193], v236 offset:43008
    ds_read_b64_tr_b16 v[194:195], v236 offset:43776
    ds_read_b64_tr_b16 v[196:197], v237 offset:43040
    ds_read_b64_tr_b16 v[198:199], v237 offset:43808
    s_waitcnt lgkmcnt(11)
    v_mfma_f32_16x16x32_bf16 v[56:59], v[176:179], v[108:111], v[56:59]
    s_waitcnt lgkmcnt(9)
    v_mfma_f32_16x16x32_bf16 v[60:63], v[180:183], v[108:111], v[60:63]
    ds_read_b128 v[120:123], v240 offset:512
    ds_read_b64_tr_b16 v[200:201], v238
    ds_read_b64_tr_b16 v[202:203], v238 offset:768
    ds_read_b64_tr_b16 v[204:205], v239 offset:32
    ds_read_b64_tr_b16 v[206:207], v239 offset:800
    s_waitcnt lgkmcnt(11)
    v_mfma_f32_16x16x32_bf16 v[56:59], v[184:187], v[112:115], v[56:59]
    s_waitcnt lgkmcnt(9)
    v_mfma_f32_16x16x32_bf16 v[60:63], v[188:191], v[112:115], v[60:63]
    ds_read_b128 v[124:127], v241 offset:512
    ds_read_b64_tr_b16 v[208:209], v238 offset:6144
    ds_read_b64_tr_b16 v[210:211], v238 offset:6912
    ds_read_b64_tr_b16 v[212:213], v239 offset:6176
    ds_read_b64_tr_b16 v[214:215], v239 offset:6944
    s_waitcnt lgkmcnt(11)
    v_mfma_f32_16x16x32_bf16 v[56:59], v[192:195], v[116:119], v[56:59]
    s_waitcnt lgkmcnt(9)
    v_mfma_f32_16x16x32_bf16 v[60:63], v[196:199], v[116:119], v[60:63]
    ds_read_b128 v[128:131], v242 offset:512
    ds_read_b64_tr_b16 v[216:217], v238 offset:12288
    ds_read_b64_tr_b16 v[218:219], v238 offset:13056
    ds_read_b64_tr_b16 v[220:221], v239 offset:12320
    ds_read_b64_tr_b16 v[222:223], v239 offset:13088
    s_waitcnt lgkmcnt(11)
    v_mfma_f32_16x16x32_bf16 v[56:59], v[200:203], v[120:123], v[56:59]
    s_waitcnt lgkmcnt(9)
    v_mfma_f32_16x16x32_bf16 v[60:63], v[204:207], v[120:123], v[60:63]
    ds_read_b128 v[132:135], v243 offset:512
    ds_read_b64_tr_b16 v[224:225], v238 offset:18432
    ds_read_b64_tr_b16 v[226:227], v238 offset:19200
    ds_read_b64_tr_b16 v[228:229], v239 offset:18464
    ds_read_b64_tr_b16 v[230:231], v239 offset:19232
    s_waitcnt lgkmcnt(11)
    v_mfma_f32_16x16x32_bf16 v[56:59], v[208:211], v[124:127], v[56:59]
    s_waitcnt lgkmcnt(9)
    v_mfma_f32_16x16x32_bf16 v[60:63], v[212:215], v[124:127], v[60:63]
    s_waitcnt lgkmcnt(6)
    v_mfma_f32_16x16x32_bf16 v[56:59], v[216:219], v[128:131], v[56:59]
    s_waitcnt lgkmcnt(4)
    v_mfma_f32_16x16x32_bf16 v[60:63], v[220:223], v[128:131], v[60:63]
    s_waitcnt lgkmcnt(2)
    v_mfma_f32_16x16x32_bf16 v[56:59], v[224:227], v[132:135], v[56:59]
    s_waitcnt lgkmcnt(0)
    v_mfma_f32_16x16x32_bf16 v[60:63], v[228:231], v[132:135], v[60:63]
    s_nop 5
    v_cvt_pk_bf16_f32 v72, v56, v57
    v_cvt_pk_bf16_f32 v73, v58, v59
    v_cvt_pk_bf16_f32 v74, v60, v61
    v_cvt_pk_bf16_f32 v75, v62, v63
    s_lshl_b32 s4, s3, 10
    s_add_u32 s4, s4, 0xf000
    v_add_u32 v24, s4, v23
    ds_write_b128 v24, v[72:75]
    s_waitcnt lgkmcnt(0)
    s_barrier
    s_branch L_paj_4
L_pam_3:
    ds_read_b128 v[88:91], v240
    ds_read_b64_tr_b16 v[136:137], v244
    ds_read_b64_tr_b16 v[138:139], v244 offset:256
    ds_read_b64_tr_b16 v[140:141], v244 offset:8
    ds_read_b64_tr_b16 v[142:143], v244 offset:264
    ds_read_b128 v[92:95], v241
    ds_read_b64_tr_b16 v[144:145], v244 offset:2048
    ds_read_b64_tr_b16 v[146:147], v244 offset:2304
    ds_read_b64_tr_b16 v[148:149], v244 offset:2056
    ds_read_b64_tr_b16 v[150:151], v244 offset:2312
    ds_read_b128 v[96:99], v242
    ds_read_b64_tr_b16 v[152:153], v244 offset:4096
    ds_read_b64_tr_b16 v[154:155], v244 offset:4352
    ds_read_b64_tr_b16 v[156:157], v244 offset:4104
    ds_read_b64_tr_b16 v[158:159], v244 offset:4360
    s_waitcnt lgkmcnt(11)
    v_mfma_f32_16x16x32_bf16 v[56:59], v[136:139], v[88:91], 0
    s_waitcnt lgkmcnt(9)
    v_mfma_f32_16x16x32_bf16 v[60:63], v[140:143], v[88:91], 0
    ds_read_b128 v[100:103], v243
    ds_read_b64_tr_b16 v[160:161], v244 offset:6144
    ds_read_b64_tr_b16 v[162:163], v244 offset:6400
    ds_read_b64_tr_b16 v[164:165], v244 offset:6152
    ds_read_b64_tr_b16 v[166:167], v244 offset:6408
    s_waitcnt lgkmcnt(11)
    v_mfma_f32_16x16x32_bf16 v[56:59], v[144:147], v[92:95], v[56:59]
    s_waitcnt lgkmcnt(9)
    v_mfma_f32_16x16x32_bf16 v[60:63], v[148:151], v[92:95], v[60:63]
    ds_read_b128 v[104:107], v240 offset:256
    ds_read_b64_tr_b16 v[168:169], v244 offset:8192
    ds_read_b64_tr_b16 v[170:171], v244 offset:8448
    ds_read_b64_tr_b16 v[172:173], v244 offset:8200
    ds_read_b64_tr_b16 v[174:175], v244 offset:8456
    s_waitcnt lgkmcnt(11)
    v_mfma_f32_16x16x32_bf16 v[56:59], v[152:155], v[96:99], v[56:59]
    s_waitcnt lgkmcnt(9)
    v_mfma_f32_16x16x32_bf16 v[60:63], v[156:159], v[96:99], v[60:63]
    ds_read_b128 v[108:111], v241 offset:256
    ds_read_b64_tr_b16 v[176:177], v244 offset:10240
    ds_read_b64_tr_b16 v[178:179], v244 offset:10496
    ds_read_b64_tr_b16 v[180:181], v244 offset:10248
    ds_read_b64_tr_b16 v[182:183], v244 offset:10504
    s_waitcnt lgkmcnt(11)
    v_mfma_f32_16x16x32_bf16 v[56:59], v[160:163], v[100:103], v[56:59]
    s_waitcnt lgkmcnt(9)
    v_mfma_f32_16x16x32_bf16 v[60:63], v[164:167], v[100:103], v[60:63]
    ds_read_b128 v[112:115], v242 offset:256
    ds_read_b64_tr_b16 v[184:185], v244 offset:12288
    ds_read_b64_tr_b16 v[186:187], v244 offset:12544
    ds_read_b64_tr_b16 v[188:189], v244 offset:12296
    ds_read_b64_tr_b16 v[190:191], v244 offset:12552
    s_waitcnt lgkmcnt(11)
    v_mfma_f32_16x16x32_bf16 v[56:59], v[168:171], v[104:107], v[56:59]
    s_waitcnt lgkmcnt(9)
    v_mfma_f32_16x16x32_bf16 v[60:63], v[172:175], v[104:107], v[60:63]
    ds_read_b128 v[116:119], v243 offset:256
    ds_read_b64_tr_b16 v[192:193], v244 offset:14336
    ds_read_b64_tr_b16 v[194:195], v244 offset:14592
    ds_read_b64_tr_b16 v[196:197], v244 offset:14344
    ds_read_b64_tr_b16 v[198:199], v244 offset:14600
    s_waitcnt lgkmcnt(11)
    v_mfma_f32_16x16x32_bf16 v[56:59], v[176:179], v[108:111], v[56:59]
    s_waitcnt lgkmcnt(9)
    v_mfma_f32_16x16x32_bf16 v[60:63], v[180:183], v[108:111], v[60:63]
    ds_read_b128 v[120:123], v240 offset:512
    ds_read_b64_tr_b16 v[200:201], v244 offset:16384
    ds_read_b64_tr_b16 v[202:203], v244 offset:16640
    ds_read_b64_tr_b16 v[204:205], v244 offset:16392
    ds_read_b64_tr_b16 v[206:207], v244 offset:16648
    s_waitcnt lgkmcnt(11)
    v_mfma_f32_16x16x32_bf16 v[56:59], v[184:187], v[112:115], v[56:59]
    s_waitcnt lgkmcnt(9)
    v_mfma_f32_16x16x32_bf16 v[60:63], v[188:191], v[112:115], v[60:63]
    ds_read_b128 v[124:127], v241 offset:512
    ds_read_b64_tr_b16 v[208:209], v244 offset:18432
    ds_read_b64_tr_b16 v[210:211], v244 offset:18688
    ds_read_b64_tr_b16 v[212:213], v244 offset:18440
    ds_read_b64_tr_b16 v[214:215], v244 offset:18696
    s_waitcnt lgkmcnt(11)
    v_mfma_f32_16x16x32_bf16 v[56:59], v[192:195], v[116:119], v[56:59]
    s_waitcnt lgkmcnt(9)
    v_mfma_f32_16x16x32_bf16 v[60:63], v[196:199], v[116:119], v[60:63]
    ds_read_b128 v[128:131], v242 offset:512
    ds_read_b64_tr_b16 v[216:217], v244 offset:20480
    ds_read_b64_tr_b16 v[218:219], v244 offset:20736
    ds_read_b64_tr_b16 v[220:221], v244 offset:20488
    ds_read_b64_tr_b16 v[222:223], v244 offset:20744
    s_waitcnt lgkmcnt(11)
    v_mfma_f32_16x16x32_bf16 v[56:59], v[200:203], v[120:123], v[56:59]
    s_waitcnt lgkmcnt(9)
    v_mfma_f32_16x16x32_bf16 v[60:63], v[204:207], v[120:123], v[60:63]
    ds_read_b128 v[132:135], v243 offset:512
    ds_read_b64_tr_b16 v[224:225], v244 offset:22528
    ds_read_b64_tr_b16 v[226:227], v244 offset:22784
    ds_read_b64_tr_b16 v[228:229], v244 offset:22536
    ds_read_b64_tr_b16 v[230:231], v244 offset:22792
    s_waitcnt lgkmcnt(11)
    v_mfma_f32_16x16x32_bf16 v[56:59], v[208:211], v[124:127], v[56:59]
    s_waitcnt lgkmcnt(9)
    v_mfma_f32_16x16x32_bf16 v[60:63], v[212:215], v[124:127], v[60:63]
    s_waitcnt lgkmcnt(6)
    v_mfma_f32_16x16x32_bf16 v[56:59], v[216:219], v[128:131], v[56:59]
    s_waitcnt lgkmcnt(4)
    v_mfma_f32_16x16x32_bf16 v[60:63], v[220:223], v[128:131], v[60:63]
    s_waitcnt lgkmcnt(2)
    v_mfma_f32_16x16x32_bf16 v[56:59], v[224:227], v[132:135], v[56:59]
    s_waitcnt lgkmcnt(0)
    v_mfma_f32_16x16x32_bf16 v[60:63], v[228:231], v[132:135], v[60:63]
    s_mov_b32 s90, 0x3d96c740
    v_add_u32 v24, 0x16000, v23
    s_nop 3
    v_mul_f32 v56, s90, v56
    v_mul_f32 v57, s90, v57
    v_mul_f32 v58, s90, v58
    v_mul_f32 v59, s90, v59
    ds_write_b128 v24, v[56:59]
    v_mul_f32 v60, s90, v60
    v_mul_f32 v61, s90, v61
    v_mul_f32 v62, s90, v62
    v_mul_f32 v63, s90, v63
    ds_write_b128 v24, v[60:63] offset:1024
    s_waitcnt lgkmcnt(0)
    s_barrier
L_paj_4:
    s_add_u32 m0, s43, 0
    s_add_u32 s41, s98, 0
    buffer_load_dwordx4 v32, s[16:19], s41 offen lds
    buffer_load_dwordx4 v33, s[16:19], s41 offen offset:1024 lds
    buffer_load_dwordx4 v34, s[16:19], s41 offen offset:2048 lds
    s_add_u32 m0, s43, 0xc00
    s_add_u32 s41, s98, 0xc00
    buffer_load_dwordx4 v32, s[16:19], s41 offen lds
    buffer_load_dwordx4 v33, s[16:19], s41 offen offset:1024 lds
    buffer_load_dwordx4 v34, s[16:19], s41 offen offset:2048 lds
    s_mov_b32 s90, 0x3727c5ac
    s_barrier
    s_add_u32 m0, s43, 0x6000
    s_add_u32 s41, s98, 0x6000
    buffer_load_dwordx4 v32, s[16:19], s41 offen lds
    buffer_load_dwordx4 v33, s[16:19], s41 offen offset:1024 lds
    buffer_load_dwordx4 v34, s[16:19], s41 offen offset:2048 lds
    s_add_u32 m0, s43, 0x6c00
    s_add_u32 s41, s98, 0x6c00
    buffer_load_dwordx4 v32, s[16:19], s41 offen lds
    buffer_load_dwordx4 v33, s[16:19], s41 offen offset:1024 lds
    buffer_load_dwordx4 v34, s[16:19], s41 offen offset:2048 lds
    v_mov_b32 v24, 0
    buffer_load_dword v30, v24, s[16:19], 0 offen
    s_waitcnt vmcnt(7)
    s_branch L_emain3
L_prodV:
    s_mov_b32 s47, s58
    s_and_b32 s4, s2, 1
    s_mul_i32 s59, s4, 3
    s_add_u32 s59, s59, s57
    s_sub_u32 s59, s59, 6
    s_waitcnt lgkmcnt(0)
    s_mov_b32 s28, s76
    s_and_b32 s29, s77, 0xffff
    s_mov_b32 s30, 0x48000
    s_mov_b32 s31, 0x20000
    v_lshrrev_b32 v24, 1, v1
    v_mul_u32_u24 v24, 0xc0, v24
    v_and_b32 v25, 1, v1
    v_lshl_add_u32 v184, v25, 4, v24
    s_mul_i32 s41, s47, 0x12000
    s_mul_i32 s4, s3, 0x4800
    s_add_u32 s41, s41, s4
    s_lshl_b32 s4, s59, 5
    s_add_u32 s41, s41, s4
    s_mul_i32 s5, s3, 0xc00
    s_add_u32 m0, s5, 0
    s_add_u32 s42, s41, 0
    buffer_load_dwordx4 v184, s[28:31], s42 offen lds
    s_add_u32 m0, s5, 0x400
    s_add_u32 s42, s41, 0x1800
    buffer_load_dwordx4 v184, s[28:31], s42 offen lds
    s_add_u32 m0, s5, 0x800
    s_add_u32 s42, s41, 0x3000
    buffer_load_dwordx4 v184, s[28:31], s42 offen lds
    s_mov_b32 s16, s70
    s_and_b32 s17, s71, 0xffff
    s_mov_b32 s18, 0x48000
    s_mov_b32 s19, 0x20000
    s_mov_b32 s8, s66
    s_and_b32 s9, s67, 0xffff
    s_mov_b32 s10, 0x3000000
    s_mov_b32 s11, 0x20000
    s_mov_b32 s20, s86
    s_and_b32 s21, s87, 0xffff
    s_mov_b32 s22, 0x10000000
    s_mov_b32 s23, 0x20000
    s_mov_b32 s24, s84
    s_and_b32 s25, s85, 0xffff
    s_mov_b32 s26, 0x100
    s_mov_b32 s27, 0x20000
    s_mul_i32 s43, s3, 0x1800
    s_mov_b32 s98, s43
    s_and_b32 s4, s3, 1
    s_lshl_b32 s4, s4, 3
    v_add_u32 v24, 0, v1
    v_mul_u32_u24 v25, 0x556, v24
    v_lshrrev_b32 v60, 16, v25
    v_mul_u32_u24 v25, 48, v60
    v_sub_u32 v24, v24, v25
    v_lshl_or_b32 v25, v60, 1, s4
    v_xor_b32 v24, v24, v25
    v_mul_u32_u24 v25, 0x300, v60
    v_lshl_add_u32 v32, v24, 4, v25
    v_add_u32 v24, 64, v1
    v_mul_u32_u24 v25, 0x556, v24
    v_lshrrev_b32 v60, 16, v25
    v_mul_u32_u24 v25, 48, v60
    v_sub_u32 v24, v24, v25
    v_lshl_or_b32 v25, v60, 1, s4
    v_xor_b32 v24, v24, v25
    v_mul_u32_u24 v25, 0x300, v60
    v_lshl_add_u32 v33, v24, 4, v25
    v_subrev_u32 v33, 0x400, v33
    v_add_u32 v24, 0x80, v1
    v_mul_u32_u24 v25, 0x556, v24
    v_lshrrev_b32 v60, 16, v25
    v_mul_u32_u24 v25, 48, v60
    v_sub_u32 v24, v24, v25
    v_lshl_or_b32 v25, v60, 1, s4
    v_xor_b32 v24, v24, v25
    v_mul_u32_u24 v25, 0x300, v60
    v_lshl_add_u32 v34, v24, 4, v25
    v_subrev_u32 v34, 0x800, v34
    v_and_b32 v24, 15, v1
    v_lshrrev_b32 v25, 2, v24
    v_lshrrev_b32 v26, 3, v24
    v_xor_b32 v26, v25, v26
    v_and_b32 v26, 1, v26
    v_lshlrev_b32 v26, 3, v26
    v_and_b32 v25, 1, v25
    v_or_b32 v26, v26, v25
    v_and_b32 v25, 1, v24
    v_lshl_or_b32 v26, v25, 2, v26
    v_and_b32 v25, 2, v24
    v_or_b32 v26, v26, v25
    v_lshrrev_b32 v25, 4, v1
    v_xor_b32 v26, v26, v25
    v_lshlrev_b32 v26, 4, v26
    v_mul_u32_u24 v24, 0x300, v24
    v_add_u32 v24, 0x1c000, v24
    v_xor_b32 v25, 0, v26
    v_add_u32 v36, v24, v25
    v_xor_b32 v25, 64, v26
    v_add_u32 v37, v24, v25
    v_xor_b32 v25, 0x80, v26
    v_add_u32 v38, v24, v25
    v_xor_b32 v25, 0xc0, v26
    v_add_u32 v39, v24, v25
    v_lshrrev_b32 v56, 4, v1
    v_and_b32 v57, 15, v1
    v_lshrrev_b32 v61, 2, v57
    v_and_b32 v24, 3, v57
    v_lshlrev_b32 v24, 2, v24
    v_lshrrev_b32 v25, 1, v57
    v_and_b32 v25, 2, v25
    v_or_b32 v24, v24, v25
    v_xor_b32 v24, v24, v56
    v_lshlrev_b32 v24, 4, v24
    v_mul_u32_u24 v25, 0x300, v57
    s_mul_i32 s4, s3, 0x3000
    v_xor_b32 v26, 0, v24
    v_add_u32 v8, v25, v26
    v_add_u32 v12, s4, v8
    v_xor_b32 v26, 64, v24
    v_add_u32 v9, v25, v26
    v_add_u32 v13, s4, v9
    v_xor_b32 v26, 0x80, v24
    v_add_u32 v10, v25, v26
    v_add_u32 v14, s4, v10
    v_xor_b32 v26, 0xc0, v24
    v_add_u32 v11, v25, v26
    v_add_u32 v15, s4, v11
    s_lshl_b32 s4, s3, 11
    s_add_u32 s4, s4, 0xc000
    v_lshrrev_b32 v24, 1, v57
    v_lshrrev_b32 v25, 1, v56
    v_xor_b32 v24, v24, v25
    v_lshlrev_b32 v24, 4, v24
    v_and_b32 v25, 1, v56
    v_lshl_add_u32 v24, v25, 3, v24
    v_lshlrev_b32 v25, 7, v57
    v_add_u32 v25, s4, v25
    v_xor_b32 v26, 0, v24
    v_add_u32 v16, v25, v26
    v_xor_b32 v26, 32, v24
    v_add_u32 v17, v25, v26
    v_xor_b32 v26, 64, v24
    v_add_u32 v18, v25, v26
    v_xor_b32 v26, 0x60, v24
    v_add_u32 v19, v25, v26
    s_lshl_b32 s4, s3, 9
    s_add_u32 s4, s4, 0xe000
    v_lshlrev_b32 v24, 5, v57
    v_add_u32 v24, s4, v24
    v_lshrrev_b32 v25, 1, v56
    v_lshrrev_b32 v26, 3, v57
    v_xor_b32 v25, v25, v26
    v_lshl_add_u32 v24, v25, 4, v24
    v_and_b32 v25, 1, v56
    v_lshl_add_u32 v20, v25, 3, v24
    v_lshlrev_b32 v24, 4, v56
    v_add_u32 v21, 0xe800, v24
    s_lshl_b32 s4, s3, 6
    s_add_u32 s4, s4, 0xe800
    v_lshlrev_b32 v24, 2, v57
    v_add_u32 v24, s4, v24
    v_lshlrev_b32 v25, 2, v1
    v_add_u32 v25, 0xf100, v25
    v_cmp_eq_u32 vcc, v61, v56
    s_nop 1
    v_cndmask_b32 v22, v25, v24, vcc
    s_mov_b32 s92, 0x22222222
    s_mov_b32 s93, 0x22222222
    s_mov_b32 s94, 0xcccccccc
    s_mov_b32 s95, 0xcccccccc
    s_mov_b32 s96, 0x88888888
    s_mov_b32 s97, 0x88888888
    s_mov_b32 s89, 0x3b2aaaab
    s_mov_b32 s90, 0x3727c5ac
    s_mov_b32 s91, 0x4e800000
    s_mul_i32 s58, s3, 0x12000
    s_add_u32 s58, s58, 0x10000
    s_mov_b32 s88, 0x30000
    v_add_u32 v24, 0, v1
    v_mul_u32_u24 v25, 0x556, v24
    v_lshrrev_b32 v60, 16, v25
    v_mul_u32_u24 v25, 48, v60
    v_sub_u32 v24, v24, v25
    v_lshlrev_b32 v25, 2, v60
    v_xor_b32 v24, v24, v25
    v_lshlrev_b32 v24, 4, v24
    v_and_b32 v25, 1, v60
    v_mul_u32_u24 v25, 0x300, v25
    v_add_u32 v24, v24, v25
    v_lshrrev_b32 v25, 1, v60
    v_mul_lo_u32 v25, v25, s88
    v_add_u32 v2, v24, v25
    v_xor_b32 v5, 32, v2
    v_add_u32 v24, 64, v1
    v_mul_u32_u24 v25, 0x556, v24
    v_lshrrev_b32 v60, 16, v25
    v_mul_u32_u24 v25, 48, v60
    v_sub_u32 v24, v24, v25
    v_lshlrev_b32 v25, 2, v60
    v_xor_b32 v24, v24, v25
    v_lshlrev_b32 v24, 4, v24
    v_and_b32 v25, 1, v60
    v_mul_u32_u24 v25, 0x300, v25
    v_add_u32 v24, v24, v25
    v_lshrrev_b32 v25, 1, v60
    v_mul_lo_u32 v25, v25, s88
    v_add_u32 v3, v24, v25
    v_subrev_u32 v3, 0x400, v3
    v_xor_b32 v6, 32, v3
    v_add_u32 v24, 0x80, v1
    v_mul_u32_u24 v25, 0x556, v24
    v_lshrrev_b32 v60, 16, v25
    v_mul_u32_u24 v25, 48, v60
    v_sub_u32 v24, v24, v25
    v_lshlrev_b32 v25, 2, v60
    v_xor_b32 v24, v24, v25
    v_lshlrev_b32 v24, 4, v24
    v_and_b32 v25, 1, v60
    v_mul_u32_u24 v25, 0x300, v25
    v_add_u32 v24, v24, v25
    v_lshrrev_b32 v25, 1, v60
    v_mul_lo_u32 v25, v25, s88
    v_add_u32 v4, v24, v25
    v_subrev_u32 v4, 0x800, v4
    v_xor_b32 v7, 32, v4
    s_lshr_b32 s4, s2, 1
    s_mul_i32 s40, s4, 0x60000
    s_and_b32 s4, s2, 1
    s_mul_i32 s4, s4, 0x18000
    s_add_u32 s40, s40, s4
    s_mul_i32 s4, s3, 0x1800
    s_add_u32 s40, s40, s4
    s_mul_i32 s101, s3, 0x3000
    s_add_u32 s42, s40, 0
    buffer_load_dwordx4 v[64:67], v2, s[8:11], s42 offen nt
    buffer_load_dwordx4 v[68:71], v3, s[8:11], s42 offen offset:1024 nt
    buffer_load_dwordx4 v[72:75], v4, s[8:11], s42 offen offset:2048 nt
    s_add_u32 s42, s40, 0x600
    buffer_load_dwordx4 v[76:79], v5, s[8:11], s42 offen nt
    buffer_load_dwordx4 v[80:83], v6, s[8:11], s42 offen offset:1024 nt
    buffer_load_dwordx4 v[84:87], v7, s[8:11], s42 offen offset:2048 nt
    s_add_u32 s42, s40, 0xc00
    buffer_load_dwordx4 v[88:91], v2, s[8:11], s42 offen nt
    buffer_load_dwordx4 v[92:95], v3, s[8:11], s42 offen offset:1024 nt
    buffer_load_dwordx4 v[96:99], v4, s[8:11], s42 offen offset:2048 nt
    s_add_u32 s42, s40, 0x1200
    buffer_load_dwordx4 v[100:103], v5, s[8:11], s42 offen nt
    buffer_load_dwordx4 v[104:107], v6, s[8:11], s42 offen offset:1024 nt
    buffer_load_dwordx4 v[108:111], v7, s[8:11], s42 offen offset:2048 nt
    v_lshrrev_b32 v24, 4, v1
    v_lshlrev_b32 v24, 3, v24
    v_bfe_u32 v25, v1, 2, 2
    v_add_u32 v24, v24, v25
    v_lshlrev_b32 v24, 5, v24
    v_and_b32 v25, 3, v1
    v_lshl_add_u32 v24, v25, 3, v24
    s_mul_i32 s5, s3, 0xc00
    v_add_u32 v185, s5, v24
    v_mov_b32 v160, 0x3f803f80
    v_mov_b32 v161, 0x3f803f80
    v_mov_b32 v162, 0x3f803f80
    v_mov_b32 v163, 0x3f803f80
    s_waitcnt vmcnt(12)
    ds_read_b64_tr_b16 v[164:165], v185
    ds_read_b64_tr_b16 v[166:167], v185 offset:128
    ds_read_b64_tr_b16 v[168:169], v185 offset:1024
    ds_read_b64_tr_b16 v[170:171], v185 offset:1152
    ds_read_b64_tr_b16 v[172:173], v185 offset:2048
    ds_read_b64_tr_b16 v[174:175], v185 offset:2176
    s_waitcnt lgkmcnt(3)
    v_mfma_f32_16x16x32_bf16 v[176:179], v[160:163], v[164:167], 0
    s_waitcnt lgkmcnt(2)
    v_mfma_f32_16x16x32_bf16 v[176:179], v[160:163], v[168:171], v[176:179]
    s_waitcnt lgkmcnt(0)
    v_mfma_f32_16x16x32_bf16 v[176:179], v[160:163], v[172:175], v[176:179]
    v_and_b32 v24, 15, v1
    v_lshlrev_b32 v24, 4, v24
    s_lshl_b32 s4, s3, 2
    v_add_u32 v25, s4, v24
    s_nop 3
    ds_write_b32 v25, v176 offset:49152
    s_waitcnt lgkmcnt(0)
    s_barrier
    ds_read_b128 v[180:183], v24 offset:49152
    s_waitcnt lgkmcnt(0)
    v_add_f32 v180, v180, v181
    v_add_f32 v182, v182, v183
    v_add_f32 v180, v180, v182
    v_mul_f32 v180, 0x3b2aaaab, v180
    s_mul_i32 s4, s47, 12
    s_mul_i32 s5, s3, 3
    s_add_u32 s4, s4, s5
    s_mul_i32 s4, s4, 6
    s_add_u32 s4, s4, s59
    s_lshl_b32 s4, s4, 10
    s_add_u32 s4, s4, 0x10000
    s_add_u32 m0, s43, 0
    s_add_u32 s41, s98, 0
    buffer_load_dwordx4 v32, s[16:19], s41 offen lds
    buffer_load_dwordx4 v33, s[16:19], s41 offen offset:1024 lds
    buffer_load_dwordx4 v34, s[16:19], s41 offen offset:2048 lds
    s_add_u32 m0, s43, 0xc00
    s_add_u32 s41, s98, 0xc00
    buffer_load_dwordx4 v32, s[16:19], s41 offen lds
    buffer_load_dwordx4 v33, s[16:19], s41 offen offset:1024 lds
    buffer_load_dwordx4 v34, s[16:19], s41 offen offset:2048 lds
    s_add_u32 m0, s43, 0x6000
    s_add_u32 s41, s98, 0x6000
    buffer_load_dwordx4 v32, s[16:19], s41 offen lds
    buffer_load_dwordx4 v33, s[16:19], s41 offen offset:1024 lds
    buffer_load_dwordx4 v34, s[16:19], s41 offen offset:2048 lds
    s_add_u32 m0, s43, 0x6c00
    s_add_u32 s41, s98, 0x6c00
    buffer_load_dwordx4 v32, s[16:19], s41 offen lds
    buffer_load_dwordx4 v33, s[16:19], s41 offen offset:1024 lds
    buffer_load_dwordx4 v34, s[16:19], s41 offen offset:2048 lds
    buffer_store_dwordx4 v[164:167], v23, s[20:23], s4 offen sc1
    s_add_u32 s4, s4, 0x1800
    buffer_store_dwordx4 v[168:171], v23, s[20:23], s4 offen sc1
    s_add_u32 s4, s4, 0x1800
    buffer_store_dwordx4 v[172:175], v23, s[20:23], s4 offen sc1
    s_add_u32 s4, s4, 0x1800
    s_lshl_b32 s4, s47, 9
    s_lshl_b32 s5, s59, 2
    s_add_u32 s4, s4, s5
    s_add_u32 s4, s4, 0x78000
    v_lshlrev_b32 v24, 5, v0
    v_mov_b32 v25, 0x7ffffff0
    v_cmp_gt_u32 vcc, 16, v0
    s_nop 1
    v_cndmask_b32 v24, v25, v24, vcc
    buffer_store_dword v180, v24, s[20:23], s4 offen sc1
    s_mul_i32 s5, s47, 18
    s_add_u32 s5, s5, s59
    s_add_u32 s5, s5, 12
    s_cmp_eq_u32 s3, 0
    s_cselect_b32 s49, s5, 0
    s_waitcnt vmcnt(10)
    s_branch L_Lmain3
L_early0:
L_early:
    s_waitcnt lgkmcnt(0)
    s_mov_b32 s24, s84
    s_and_b32 s25, s85, 0xffff
    s_mov_b32 s26, 0x100
    s_mov_b32 s27, 0x20000
    s_or_b32 s4, s2, s3
    s_cmp_lg_u32 s4, 0
    s_cbranch_scc1 L_ep_5
    s_memrealtime s[6:7]
    s_waitcnt lgkmcnt(0)
    s_or_b32 s6, s6, 1
    v_mov_b32 v56, s6
    v_mov_b32 v55, 0
    s_mov_b64 exec, 1
    buffer_store_dword v56, v55, s[24:27], 0 offen offset:0 sc1
    s_mov_b64 exec, -1
L_ep_5:
    s_mov_b32 s16, s70
    s_and_b32 s17, s71, 0xffff
    s_mov_b32 s18, 0x48000
    s_mov_b32 s19, 0x20000
    s_mov_b32 s8, s66
    s_and_b32 s9, s67, 0xffff
    s_mov_b32 s10, 0x3000000
    s_mov_b32 s11, 0x20000
    s_mov_b32 s20, s86
    s_and_b32 s21, s87, 0xffff
    s_mov_b32 s22, 0x10000000
    s_mov_b32 s23, 0x20000
    s_mov_b32 s24, s84
    s_and_b32 s25, s85, 0xffff
    s_mov_b32 s26, 0x100
    s_mov_b32 s27, 0x20000
    s_mul_i32 s43, s3, 0x1800
    s_mov_b32 s98, s43
    s_and_b32 s4, s3, 1
    s_lshl_b32 s4, s4, 3
    v_add_u32 v24, 0, v1
    v_mul_u32_u24 v25, 0x556, v24
    v_lshrrev_b32 v60, 16, v25
    v_mul_u32_u24 v25, 48, v60
    v_sub_u32 v24, v24, v25
    v_lshl_or_b32 v25, v60, 1, s4
    v_xor_b32 v24, v24, v25
    v_mul_u32_u24 v25, 0x300, v60
    v_lshl_add_u32 v32, v24, 4, v25
    v_add_u32 v24, 64, v1
    v_mul_u32_u24 v25, 0x556, v24
    v_lshrrev_b32 v60, 16, v25
    v_mul_u32_u24 v25, 48, v60
    v_sub_u32 v24, v24, v25
    v_lshl_or_b32 v25, v60, 1, s4
    v_xor_b32 v24, v24, v25
    v_mul_u32_u24 v25, 0x300, v60
    v_lshl_add_u32 v33, v24, 4, v25
    v_subrev_u32 v33, 0x400, v33
    v_add_u32 v24, 0x80, v1
    v_mul_u32_u24 v25, 0x556, v24
    v_lshrrev_b32 v60, 16, v25
    v_mul_u32_u24 v25, 48, v60
    v_sub_u32 v24, v24, v25
    v_lshl_or_b32 v25, v60, 1, s4
    v_xor_b32 v24, v24, v25
    v_mul_u32_u24 v25, 0x300, v60
    v_lshl_add_u32 v34, v24, 4, v25
    v_subrev_u32 v34, 0x800, v34
    v_and_b32 v24, 15, v1
    v_lshrrev_b32 v25, 2, v24
    v_lshrrev_b32 v26, 3, v24
    v_xor_b32 v26, v25, v26
    v_and_b32 v26, 1, v26
    v_lshlrev_b32 v26, 3, v26
    v_and_b32 v25, 1, v25
    v_or_b32 v26, v26, v25
    v_and_b32 v25, 1, v24
    v_lshl_or_b32 v26, v25, 2, v26
    v_and_b32 v25, 2, v24
    v_or_b32 v26, v26, v25
    v_lshrrev_b32 v25, 4, v1
    v_xor_b32 v26, v26, v25
    v_lshlrev_b32 v26, 4, v26
    v_mul_u32_u24 v24, 0x300, v24
    v_add_u32 v24, 0x1c000, v24
    v_xor_b32 v25, 0, v26
    v_add_u32 v36, v24, v25
    v_xor_b32 v25, 64, v26
    v_add_u32 v37, v24, v25
    v_xor_b32 v25, 0x80, v26
    v_add_u32 v38, v24, v25
    v_xor_b32 v25, 0xc0, v26
    v_add_u32 v39, v24, v25
    v_lshrrev_b32 v56, 4, v1
    v_and_b32 v57, 15, v1
    v_lshrrev_b32 v61, 2, v57
    v_and_b32 v24, 3, v57
    v_lshlrev_b32 v24, 2, v24
    v_lshrrev_b32 v25, 1, v57
    v_and_b32 v25, 2, v25
    v_or_b32 v24, v24, v25
    v_xor_b32 v24, v24, v56
    v_lshlrev_b32 v24, 4, v24
    v_mul_u32_u24 v25, 0x300, v57
    s_mul_i32 s4, s3, 0x3000
    v_xor_b32 v26, 0, v24
    v_add_u32 v8, v25, v26
    v_add_u32 v12, s4, v8
    v_xor_b32 v26, 64, v24
    v_add_u32 v9, v25, v26
    v_add_u32 v13, s4, v9
    v_xor_b32 v26, 0x80, v24
    v_add_u32 v10, v25, v26
    v_add_u32 v14, s4, v10
    v_xor_b32 v26, 0xc0, v24
    v_add_u32 v11, v25, v26
    v_add_u32 v15, s4, v11
    s_lshl_b32 s4, s3, 11
    s_add_u32 s4, s4, 0xc000
    v_lshrrev_b32 v24, 1, v57
    v_lshrrev_b32 v25, 1, v56
    v_xor_b32 v24, v24, v25
    v_lshlrev_b32 v24, 4, v24
    v_and_b32 v25, 1, v56
    v_lshl_add_u32 v24, v25, 3, v24
    v_lshlrev_b32 v25, 7, v57
    v_add_u32 v25, s4, v25
    v_xor_b32 v26, 0, v24
    v_add_u32 v16, v25, v26
    v_xor_b32 v26, 32, v24
    v_add_u32 v17, v25, v26
    v_xor_b32 v26, 64, v24
    v_add_u32 v18, v25, v26
    v_xor_b32 v26, 0x60, v24
    v_add_u32 v19, v25, v26
    s_lshl_b32 s4, s3, 9
    s_add_u32 s4, s4, 0xe000
    v_lshlrev_b32 v24, 5, v57
    v_add_u32 v24, s4, v24
    v_lshrrev_b32 v25, 1, v56
    v_lshrrev_b32 v26, 3, v57
    v_xor_b32 v25, v25, v26
    v_lshl_add_u32 v24, v25, 4, v24
    v_and_b32 v25, 1, v56
    v_lshl_add_u32 v20, v25, 3, v24
    v_lshlrev_b32 v24, 4, v56
    v_add_u32 v21, 0xe800, v24
    s_lshl_b32 s4, s3, 6
    s_add_u32 s4, s4, 0xe800
    v_lshlrev_b32 v24, 2, v57
    v_add_u32 v24, s4, v24
    v_lshlrev_b32 v25, 2, v1
    v_add_u32 v25, 0xf100, v25
    v_cmp_eq_u32 vcc, v61, v56
    s_nop 1
    v_cndmask_b32 v22, v25, v24, vcc
    s_mov_b32 s92, 0x22222222
    s_mov_b32 s93, 0x22222222
    s_mov_b32 s94, 0xcccccccc
    s_mov_b32 s95, 0xcccccccc
    s_mov_b32 s96, 0x88888888
    s_mov_b32 s97, 0x88888888
    s_mov_b32 s89, 0x3b2aaaab
    s_mov_b32 s90, 0x3727c5ac
    s_mov_b32 s91, 0x4e800000
    s_mul_i32 s58, s3, 0x12000
    s_add_u32 s58, s58, 0x10000
    s_mov_b32 s88, 0x30000
    v_add_u32 v24, 0, v1
    v_mul_u32_u24 v25, 0x556, v24
    v_lshrrev_b32 v60, 16, v25
    v_mul_u32_u24 v25, 48, v60
    v_sub_u32 v24, v24, v25
    v_lshlrev_b32 v25, 2, v60
    v_xor_b32 v24, v24, v25
    v_lshlrev_b32 v24, 4, v24
    v_and_b32 v25, 1, v60
    v_mul_u32_u24 v25, 0x300, v25
    v_add_u32 v24, v24, v25
    v_lshrrev_b32 v25, 1, v60
    v_mul_lo_u32 v25, v25, s88
    v_add_u32 v2, v24, v25
    v_xor_b32 v5, 32, v2
    v_add_u32 v24, 64, v1
    v_mul_u32_u24 v25, 0x556, v24
    v_lshrrev_b32 v60, 16, v25
    v_mul_u32_u24 v25, 48, v60
    v_sub_u32 v24, v24, v25
    v_lshlrev_b32 v25, 2, v60
    v_xor_b32 v24, v24, v25
    v_lshlrev_b32 v24, 4, v24
    v_and_b32 v25, 1, v60
    v_mul_u32_u24 v25, 0x300, v25
    v_add_u32 v24, v24, v25
    v_lshrrev_b32 v25, 1, v60
    v_mul_lo_u32 v25, v25, s88
    v_add_u32 v3, v24, v25
    v_subrev_u32 v3, 0x400, v3
    v_xor_b32 v6, 32, v3
    v_add_u32 v24, 0x80, v1
    v_mul_u32_u24 v25, 0x556, v24
    v_lshrrev_b32 v60, 16, v25
    v_mul_u32_u24 v25, 48, v60
    v_sub_u32 v24, v24, v25
    v_lshlrev_b32 v25, 2, v60
    v_xor_b32 v24, v24, v25
    v_lshlrev_b32 v24, 4, v24
    v_and_b32 v25, 1, v60
    v_mul_u32_u24 v25, 0x300, v25
    v_add_u32 v24, v24, v25
    v_lshrrev_b32 v25, 1, v60
    v_mul_lo_u32 v25, v25, s88
    v_add_u32 v4, v24, v25
    v_subrev_u32 v4, 0x800, v4
    v_xor_b32 v7, 32, v4
    s_lshr_b32 s4, s2, 1
    s_mul_i32 s40, s4, 0x60000
    s_and_b32 s4, s2, 1
    s_mul_i32 s4, s4, 0x18000
    s_add_u32 s40, s40, s4
    s_mul_i32 s4, s3, 0x1800
    s_add_u32 s40, s40, s4
    s_mul_i32 s101, s3, 0x3000
L_emain:
    s_add_u32 m0, s43, 0
    s_add_u32 s41, s98, 0
    buffer_load_dwordx4 v32, s[16:19], s41 offen lds
    buffer_load_dwordx4 v33, s[16:19], s41 offen offset:1024 lds
    buffer_load_dwordx4 v34, s[16:19], s41 offen offset:2048 lds
    s_add_u32 m0, s43, 0xc00
    s_add_u32 s41, s98, 0xc00
    buffer_load_dwordx4 v32, s[16:19], s41 offen lds
    buffer_load_dwordx4 v33, s[16:19], s41 offen offset:1024 lds
    buffer_load_dwordx4 v34, s[16:19], s41 offen offset:2048 lds
    s_add_u32 m0, s43, 0x6000
    s_add_u32 s41, s98, 0x6000
    buffer_load_dwordx4 v32, s[16:19], s41 offen lds
    buffer_load_dwordx4 v33, s[16:19], s41 offen offset:1024 lds
    buffer_load_dwordx4 v34, s[16:19], s41 offen offset:2048 lds
    s_add_u32 m0, s43, 0x6c00
    s_add_u32 s41, s98, 0x6c00
    buffer_load_dwordx4 v32, s[16:19], s41 offen lds
    buffer_load_dwordx4 v33, s[16:19], s41 offen offset:1024 lds
    buffer_load_dwordx4 v34, s[16:19], s41 offen offset:2048 lds
    s_lshl_b32 s4, s57, 2
    s_add_u32 s4, s4, s3
    s_mul_i32 s4, s4, 0xc00
    s_add_u32 s4, s4, 0x19000
    v_min_u32 v24, 23, v1
    v_lshlrev_b32 v24, 7, v24
    buffer_load_dword v30, v24, s[16:19], s4 offen
    s_waitcnt vmcnt(7)
L_emain3:
    s_barrier
    s_add_u32 m0, s43, 0x10000
    s_add_u32 s41, s98, 0xc000
    buffer_load_dwordx4 v32, s[16:19], s41 offen lds
    buffer_load_dwordx4 v33, s[16:19], s41 offen offset:1024 lds
    buffer_load_dwordx4 v34, s[16:19], s41 offen offset:2048 lds
    s_add_u32 m0, s43, 0x10c00
    s_add_u32 s41, s98, 0xcc00
    buffer_load_dwordx4 v32, s[16:19], s41 offen lds
    buffer_load_dwordx4 v33, s[16:19], s41 offen offset:1024 lds
    buffer_load_dwordx4 v34, s[16:19], s41 offen offset:2048 lds
    s_add_u32 m0, s43, 0x16000
    s_add_u32 s41, s98, 0x12000
    buffer_load_dwordx4 v32, s[16:19], s41 offen lds
    buffer_load_dwordx4 v33, s[16:19], s41 offen offset:1024 lds
    buffer_load_dwordx4 v34, s[16:19], s41 offen offset:2048 lds
    s_add_u32 m0, s43, 0x16c00
    s_add_u32 s41, s98, 0x12c00
    buffer_load_dwordx4 v32, s[16:19], s41 offen lds
    buffer_load_dwordx4 v33, s[16:19], s41 offen offset:1024 lds
    buffer_load_dwordx4 v34, s[16:19], s41 offen offset:2048 lds
    s_waitcnt vmcnt(13)
    s_barrier
    v_mov_b32 v29, 0
    buffer_load_dword v29, v29, s[24:27], 0 offen sc1
    s_add_u32 m0, s43, 0
    s_add_u32 s41, s98, 0x18000
    buffer_load_dwordx4 v32, s[16:19], s41 offen lds
    buffer_load_dwordx4 v33, s[16:19], s41 offen offset:1024 lds
    buffer_load_dwordx4 v34, s[16:19], s41 offen offset:2048 lds
    s_add_u32 m0, s43, 0xc00
    s_add_u32 s41, s98, 0x18c00
    buffer_load_dwordx4 v32, s[16:19], s41 offen lds
    buffer_load_dwordx4 v33, s[16:19], s41 offen offset:1024 lds
    buffer_load_dwordx4 v34, s[16:19], s41 offen offset:2048 lds
    s_waitcnt vmcnt(13)
    s_barrier
    s_add_u32 m0, s43, 0x6000
    s_add_u32 s41, s98, 0x1e000
    buffer_load_dwordx4 v32, s[16:19], s41 offen lds
    buffer_load_dwordx4 v33, s[16:19], s41 offen offset:1024 lds
    buffer_load_dwordx4 v34, s[16:19], s41 offen offset:2048 lds
    s_add_u32 m0, s43, 0x6c00
    s_add_u32 s41, s98, 0x1ec00
    buffer_load_dwordx4 v32, s[16:19], s41 offen lds
    buffer_load_dwordx4 v33, s[16:19], s41 offen offset:1024 lds
    buffer_load_dwordx4 v34, s[16:19], s41 offen offset:2048 lds
    s_waitcnt vmcnt(13)
    s_barrier
    s_waitcnt vmcnt(12)
    v_readfirstlane_b32 s44, v29
    s_nop 0
    s_cmp_eq_u32 s44, 0
    s_cbranch_scc1 L_es_6
L_eb_7:
    s_mul_i32 s45, s44, 0x9e3779b1
    s_getreg_b32 s46, hwreg(HW_REG_XCC_ID)
    s_and_b32 s46, s46, 15
    s_add_u32 m0, s43, 0x10000
    s_add_u32 s41, s98, 0x24000
    buffer_load_dwordx4 v32, s[16:19], s41 offen lds
    buffer_load_dwordx4 v33, s[16:19], s41 offen offset:1024 lds
    buffer_load_dwordx4 v34, s[16:19], s41 offen offset:2048 lds
    s_add_u32 m0, s43, 0x10c00
    s_add_u32 s41, s98, 0x24c00
    buffer_load_dwordx4 v32, s[16:19], s41 offen lds
    buffer_load_dwordx4 v33, s[16:19], s41 offen offset:1024 lds
    buffer_load_dwordx4 v34, s[16:19], s41 offen offset:2048 lds
    s_waitcnt vmcnt(12)
    s_barrier
    s_add_u32 m0, s43, 0x16000
    s_add_u32 s41, s98, 0x2a000
    buffer_load_dwordx4 v32, s[16:19], s41 offen lds
    buffer_load_dwordx4 v33, s[16:19], s41 offen offset:1024 lds
    buffer_load_dwordx4 v34, s[16:19], s41 offen offset:2048 lds
    s_add_u32 m0, s43, 0x16c00
    s_add_u32 s41, s98, 0x2ac00
    buffer_load_dwordx4 v32, s[16:19], s41 offen lds
    buffer_load_dwordx4 v33, s[16:19], s41 offen offset:1024 lds
    buffer_load_dwordx4 v34, s[16:19], s41 offen offset:2048 lds
    s_waitcnt vmcnt(12)
    s_barrier
    s_add_u32 m0, s43, 0
    s_add_u32 s41, s98, 0x30000
    buffer_load_dwordx4 v32, s[16:19], s41 offen lds
    buffer_load_dwordx4 v33, s[16:19], s41 offen offset:1024 lds
    buffer_load_dwordx4 v34, s[16:19], s41 offen offset:2048 lds
    s_add_u32 m0, s43, 0xc00
    s_add_u32 s41, s98, 0x30c00
    buffer_load_dwordx4 v32, s[16:19], s41 offen lds
    buffer_load_dwordx4 v33, s[16:19], s41 offen offset:1024 lds
    buffer_load_dwordx4 v34, s[16:19], s41 offen offset:2048 lds
    s_cmp_eq_u32 s49, 0
    s_cbranch_scc1 L_vs_8
    v_mov_b32 v24, s45
    s_lshl_b32 s4, s49, 7
    s_add_u32 s4, s4, 0x70000
    v_mov_b32 v25, 0
    s_mov_b64 exec, 1
    buffer_store_dword v24, v25, s[20:23], s4 offen sc1
    s_mov_b64 exec, -1
L_vs_8:
    s_waitcnt vmcnt(12)
    s_barrier
    s_add_u32 m0, s43, 0x6000
    s_add_u32 s41, s98, 0x36000
    buffer_load_dwordx4 v32, s[16:19], s41 offen lds
    buffer_load_dwordx4 v33, s[16:19], s41 offen offset:1024 lds
    buffer_load_dwordx4 v34, s[16:19], s41 offen offset:2048 lds
    s_add_u32 m0, s43, 0x6c00
    s_add_u32 s41, s98, 0x36c00
    buffer_load_dwordx4 v32, s[16:19], s41 offen lds
    buffer_load_dwordx4 v33, s[16:19], s41 offen offset:1024 lds
    buffer_load_dwordx4 v34, s[16:19], s41 offen offset:2048 lds
    s_waitcnt vmcnt(12)
    s_barrier
    s_add_u32 m0, s43, 0x10000
    s_add_u32 s41, s98, 0x3c000
    buffer_load_dwordx4 v32, s[16:19], s41 offen lds
    buffer_load_dwordx4 v33, s[16:19], s41 offen offset:1024 lds
    buffer_load_dwordx4 v34, s[16:19], s41 offen offset:2048 lds
    s_add_u32 m0, s43, 0x10c00
    s_add_u32 s41, s98, 0x3cc00
    buffer_load_dwordx4 v32, s[16:19], s41 offen lds
    buffer_load_dwordx4 v33, s[16:19], s41 offen offset:1024 lds
    buffer_load_dwordx4 v34, s[16:19], s41 offen offset:2048 lds
    s_waitcnt vmcnt(12)
    s_barrier
    s_add_u32 m0, s43, 0x16000
    s_add_u32 s41, s98, 0x42000
    buffer_load_dwordx4 v32, s[16:19], s41 offen lds
    buffer_load_dwordx4 v33, s[16:19], s41 offen offset:1024 lds
    buffer_load_dwordx4 v34, s[16:19], s41 offen offset:2048 lds
    s_add_u32 m0, s43, 0x16c00
    s_add_u32 s41, s98, 0x42c00
    buffer_load_dwordx4 v32, s[16:19], s41 offen lds
    buffer_load_dwordx4 v33, s[16:19], s41 offen offset:1024 lds
    buffer_load_dwordx4 v34, s[16:19], s41 offen offset:2048 lds
    s_waitcnt vmcnt(12)
    s_barrier
    s_waitcnt vmcnt(6)
    s_barrier
    v_min_u32 v24, 17, v1
    v_lshlrev_b32 v24, 7, v24
    s_mul_i32 s4, s3, 0x900
    s_add_u32 s4, s4, 0x70000
    buffer_load_dword v27, v24, s[20:23], s4 offen sc1
    s_add_u32 m0, s101, 0
    s_add_u32 s42, s40, 0
    buffer_load_dwordx4 v2, s[8:11], s42 offen nt lds
    buffer_load_dwordx4 v3, s[8:11], s42 offen offset:1024 nt lds
    buffer_load_dwordx4 v4, s[8:11], s42 offen offset:2048 nt lds
    s_waitcnt vmcnt(4)
    s_barrier
    s_add_u32 m0, s101, 0xc00
    s_add_u32 s42, s40, 0x600
    buffer_load_dwordx4 v5, s[8:11], s42 offen nt lds
    buffer_load_dwordx4 v6, s[8:11], s42 offen offset:1024 nt lds
    buffer_load_dwordx4 v7, s[8:11], s42 offen offset:2048 nt lds
    s_mov_b32 s47, 2
    s_waitcnt vmcnt(6)
    v_cmp_ne_u32 vcc, s45, v27
    s_nop 0
    s_lshr_b32 s0, vcc_lo, 12
    s_and_b32 s4, vcc_lo, 0xfff
    s_cbranch_scc1 L_ar_9
L_ag_10:
    s_mul_i32 s100, s3, 0x3000
    buffer_load_dwordx4 v[192:195], v23, s[20:23], s100 offen
    buffer_load_dwordx4 v[196:199], v23, s[20:23], s100 offen offset:1024
    buffer_load_dwordx4 v[200:203], v23, s[20:23], s100 offen offset:2048
    buffer_load_dwordx4 v[204:207], v23, s[20:23], s100 offen offset:3072
    s_add_u32 s100, s100, 0x1000
    buffer_load_dwordx4 v[208:211], v23, s[20:23], s100 offen
    buffer_load_dwordx4 v[212:215], v23, s[20:23], s100 offen offset:1024
    buffer_load_dwordx4 v[216:219], v23, s[20:23], s100 offen offset:2048
    buffer_load_dwordx4 v[220:223], v23, s[20:23], s100 offen offset:3072
    s_add_u32 s100, s100, 0x1000
    buffer_load_dwordx4 v[224:227], v23, s[20:23], s100 offen
    buffer_load_dwordx4 v[228:231], v23, s[20:23], s100 offen offset:1024
    buffer_load_dwordx4 v[232:235], v23, s[20:23], s100 offen offset:2048
    buffer_load_dwordx4 v[236:239], v23, s[20:23], s100 offen offset:3072
    s_add_u32 m0, s101, 0x1800
    s_add_u32 s42, s40, 0xc00
    buffer_load_dwordx4 v2, s[8:11], s42 offen nt lds
    buffer_load_dwordx4 v3, s[8:11], s42 offen offset:1024 nt lds
    buffer_load_dwordx4 v4, s[8:11], s42 offen offset:2048 nt lds
    s_add_u32 m0, s101, 0x2400
    s_add_u32 s42, s40, 0x1200
    buffer_load_dwordx4 v5, s[8:11], s42 offen nt lds
    buffer_load_dwordx4 v6, s[8:11], s42 offen offset:1024 nt lds
    buffer_load_dwordx4 v7, s[8:11], s42 offen offset:2048 nt lds
    v_mov_b32 v92, 0x3f803f80
    v_mov_b32 v93, 0x3f803f80
    v_mov_b32 v94, 0x3f803f80
    v_mov_b32 v95, 0x3f803f80
    s_barrier
    s_setprio 1
    s_lshl_b32 s4, s3, 6
    v_xor_b32 v96, s4, v36
    v_add_u32 v96, s101, v96
    v_xor_b32 v97, s4, v37
    v_add_u32 v97, s101, v97
    v_xor_b32 v98, s4, v38
    v_add_u32 v98, s101, v98
    v_xor_b32 v99, s4, v39
    v_add_u32 v99, s101, v99
    v_min_u32 v24, 17, v1
    v_lshlrev_b32 v24, 7, v24
    s_mul_i32 s4, s3, 0x900
    s_add_u32 s4, s4, 0x70000
    buffer_load_dword v35, v24, s[20:23], s4 offen sc1
    ds_read_b128 v[112:115], v36
    ds_read_b128 v[116:119], v37
    ds_read_b128 v[120:123], v38
    ds_read_b128 v[124:127], v39
    ds_read_b128 v[128:131], v36 offset:256
    ds_read_b128 v[132:135], v37 offset:256
    s_waitcnt vmcnt(18)
    v_mfma_f32_16x16x32_bf16 v[88:91], v[92:95], v[192:195], 0
    ds_read_b128 v[144:147], v96
    s_waitcnt vmcnt(17)
    v_mfma_f32_16x16x32_bf16 v[88:91], v[92:95], v[196:199], v[88:91]
    ds_read_b128 v[148:151], v97
    s_waitcnt vmcnt(16)
    v_mfma_f32_16x16x32_bf16 v[88:91], v[92:95], v[200:203], v[88:91]
    ds_read_b128 v[152:155], v98
    s_waitcnt vmcnt(15)
    v_mfma_f32_16x16x32_bf16 v[88:91], v[92:95], v[204:207], v[88:91]
    ds_read_b128 v[156:159], v99
    s_waitcnt vmcnt(14)
    v_mfma_f32_16x16x32_bf16 v[88:91], v[92:95], v[208:211], v[88:91]
    ds_read_b128 v[160:163], v96 offset:256
    s_waitcnt vmcnt(13)
    v_mfma_f32_16x16x32_bf16 v[88:91], v[92:95], v[212:215], v[88:91]
    ds_read_b128 v[164:167], v97 offset:256
    s_waitcnt vmcnt(12)
    v_mfma_f32_16x16x32_bf16 v[88:91], v[92:95], v[216:219], v[88:91]
    ds_read_b128 v[168:171], v98 offset:256
    s_waitcnt vmcnt(11)
    v_mfma_f32_16x16x32_bf16 v[88:91], v[92:95], v[220:223], v[88:91]
    ds_read_b128 v[172:175], v99 offset:256
    s_waitcnt vmcnt(10)
    v_mfma_f32_16x16x32_bf16 v[88:91], v[92:95], v[224:227], v[88:91]
    ds_read_b128 v[176:179], v96 offset:512
    s_waitcnt vmcnt(9)
    v_mfma_f32_16x16x32_bf16 v[88:91], v[92:95], v[228:231], v[88:91]
    ds_read_b128 v[180:183], v97 offset:512
    s_waitcnt vmcnt(8)
    v_mfma_f32_16x16x32_bf16 v[88:91], v[92:95], v[232:235], v[88:91]
    ds_read_b128 v[184:187], v98 offset:512
    s_waitcnt vmcnt(7)
    v_mfma_f32_16x16x32_bf16 v[88:91], v[92:95], v[236:239], v[88:91]
    ds_read_b128 v[188:191], v99 offset:512
    s_waitcnt lgkmcnt(15)
    v_mfma_f32_16x16x32_bf16 v[48:51], v[112:115], v[192:195], 0
    ds_read_b128 v[136:139], v38 offset:256
    v_mfma_f32_16x16x32_bf16 v[48:51], v[116:119], v[196:199], v[48:51]
    ds_read_b128 v[140:143], v39 offset:256
    v_mfma_f32_16x16x32_bf16 v[48:51], v[120:123], v[200:203], v[48:51]
    ds_read_b128 v[112:115], v36 offset:512
    s_waitcnt lgkmcnt(15)
    v_mfma_f32_16x16x32_bf16 v[48:51], v[124:127], v[204:207], v[48:51]
    ds_read_b128 v[116:119], v37 offset:512
    v_mfma_f32_16x16x32_bf16 v[48:51], v[128:131], v[208:211], v[48:51]
    ds_read_b128 v[120:123], v38 offset:512
    v_mov_b32 v29, v88
    v_mfma_f32_16x16x32_bf16 v[48:51], v[132:135], v[212:215], v[48:51]
    ds_read_b128 v[124:127], v39 offset:512
    s_waitcnt lgkmcnt(3)
    v_mfma_f32_16x16x32_bf16 v[48:51], v[136:139], v[216:219], v[48:51]
    ds_read_b128 v[128:131], v37 offset:12288
    v_mfma_f32_16x16x32_bf16 v[48:51], v[140:143], v[220:223], v[48:51]
    ds_read_b128 v[132:135], v36 offset:12288
    v_mfma_f32_16x16x32_bf16 v[48:51], v[112:115], v[224:227], v[48:51]
    ds_read_b128 v[136:139], v39 offset:12288
    s_waitcnt lgkmcnt(3)
    v_mfma_f32_16x16x32_bf16 v[48:51], v[116:119], v[228:231], v[48:51]
    ds_read_b128 v[140:143], v38 offset:12288
    v_mfma_f32_16x16x32_bf16 v[48:51], v[120:123], v[232:235], v[48:51]
    ds_read_b128 v[112:115], v37 offset:12544
    v_mfma_f32_16x16x32_bf16 v[48:51], v[124:127], v[236:239], v[48:51]
    ds_read_b128 v[116:119], v36 offset:12544
    s_waitcnt lgkmcnt(3)
    v_mfma_f32_16x16x32_bf16 v[52:55], v[128:131], v[192:195], 0
    ds_read_b128 v[120:123], v39 offset:12544
    v_mfma_f32_16x16x32_bf16 v[52:55], v[132:135], v[196:199], v[52:55]
    ds_read_b128 v[124:127], v38 offset:12544
    v_mfma_f32_16x16x32_bf16 v[52:55], v[136:139], v[200:203], v[52:55]
    ds_read_b128 v[128:131], v37 offset:12800
    s_waitcnt lgkmcnt(3)
    v_mfma_f32_16x16x32_bf16 v[52:55], v[140:143], v[204:207], v[52:55]
    ds_read_b128 v[132:135], v36 offset:12800
    v_mfma_f32_16x16x32_bf16 v[52:55], v[112:115], v[208:211], v[52:55]
    ds_read_b128 v[136:139], v39 offset:12800
    v_mfma_f32_16x16x32_bf16 v[52:55], v[116:119], v[212:215], v[52:55]
    ds_read_b128 v[140:143], v38 offset:12800
    s_waitcnt lgkmcnt(3)
    v_mfma_f32_16x16x32_bf16 v[52:55], v[120:123], v[216:219], v[52:55]
    ds_read_b128 v[112:115], v38 offset:24576
    v_mfma_f32_16x16x32_bf16 v[52:55], v[124:127], v[220:223], v[52:55]
    ds_read_b128 v[116:119], v39 offset:24576
    v_mfma_f32_16x16x32_bf16 v[52:55], v[128:131], v[224:227], v[52:55]
    ds_read_b128 v[120:123], v36 offset:24576
    s_waitcnt lgkmcnt(3)
    v_mfma_f32_16x16x32_bf16 v[52:55], v[132:135], v[228:231], v[52:55]
    ds_read_b128 v[124:127], v37 offset:24576
    v_mfma_f32_16x16x32_bf16 v[52:55], v[136:139], v[232:235], v[52:55]
    ds_read_b128 v[128:131], v38 offset:24832
    v_mfma_f32_16x16x32_bf16 v[52:55], v[140:143], v[236:239], v[52:55]
    ds_read_b128 v[132:135], v39 offset:24832
    s_waitcnt lgkmcnt(3)
    v_mfma_f32_16x16x32_bf16 v[56:59], v[112:115], v[192:195], 0
    ds_read_b128 v[136:139], v36 offset:24832
    v_mfma_f32_16x16x32_bf16 v[56:59], v[116:119], v[196:199], v[56:59]
    ds_read_b128 v[140:143], v37 offset:24832
    v_mfma_f32_16x16x32_bf16 v[56:59], v[120:123], v[200:203], v[56:59]
    ds_read_b128 v[112:115], v38 offset:25088
    s_waitcnt lgkmcnt(3)
    v_mfma_f32_16x16x32_bf16 v[56:59], v[124:127], v[204:207], v[56:59]
    ds_read_b128 v[116:119], v39 offset:25088
    v_mfma_f32_16x16x32_bf16 v[56:59], v[128:131], v[208:211], v[56:59]
    ds_read_b128 v[120:123], v36 offset:25088
    v_mfma_f32_16x16x32_bf16 v[56:59], v[132:135], v[212:215], v[56:59]
    ds_read_b128 v[124:127], v37 offset:25088
    s_waitcnt lgkmcnt(3)
    v_mfma_f32_16x16x32_bf16 v[56:59], v[136:139], v[216:219], v[56:59]
    ds_read_b128 v[128:131], v39 offset:36864
    v_mfma_f32_16x16x32_bf16 v[56:59], v[140:143], v[220:223], v[56:59]
    ds_read_b128 v[132:135], v38 offset:36864
    v_mfma_f32_16x16x32_bf16 v[56:59], v[112:115], v[224:227], v[56:59]
    ds_read_b128 v[136:139], v37 offset:36864
    s_waitcnt lgkmcnt(3)
    v_mfma_f32_16x16x32_bf16 v[56:59], v[116:119], v[228:231], v[56:59]
    ds_read_b128 v[140:143], v36 offset:36864
    v_mfma_f32_16x16x32_bf16 v[56:59], v[120:123], v[232:235], v[56:59]
    ds_read_b128 v[112:115], v39 offset:37120
    v_mfma_f32_16x16x32_bf16 v[56:59], v[124:127], v[236:239], v[56:59]
    ds_read_b128 v[116:119], v38 offset:37120
    s_waitcnt lgkmcnt(3)
    v_mfma_f32_16x16x32_bf16 v[60:63], v[128:131], v[192:195], 0
    ds_read_b128 v[120:123], v37 offset:37120
    v_mfma_f32_16x16x32_bf16 v[60:63], v[132:135], v[196:199], v[60:63]
    ds_read_b128 v[124:127], v36 offset:37120
    v_mfma_f32_16x16x32_bf16 v[60:63], v[136:139], v[200:203], v[60:63]
    ds_read_b128 v[128:131], v39 offset:37376
    s_waitcnt lgkmcnt(3)
    v_mfma_f32_16x16x32_bf16 v[60:63], v[140:143], v[204:207], v[60:63]
    ds_read_b128 v[132:135], v38 offset:37376
    v_mfma_f32_16x16x32_bf16 v[60:63], v[112:115], v[208:211], v[60:63]
    ds_read_b128 v[136:139], v37 offset:37376
    v_mfma_f32_16x16x32_bf16 v[60:63], v[116:119], v[212:215], v[60:63]
    ds_read_b128 v[140:143], v36 offset:37376
    s_waitcnt lgkmcnt(3)
    v_mfma_f32_16x16x32_bf16 v[60:63], v[120:123], v[216:219], v[60:63]
    v_mfma_f32_16x16x32_bf16 v[60:63], v[124:127], v[220:223], v[60:63]
    v_mfma_f32_16x16x32_bf16 v[60:63], v[128:131], v[224:227], v[60:63]
    s_waitcnt lgkmcnt(2)
    v_mfma_f32_16x16x32_bf16 v[60:63], v[132:135], v[228:231], v[60:63]
    s_waitcnt lgkmcnt(1)
    v_mfma_f32_16x16x32_bf16 v[60:63], v[136:139], v[232:235], v[60:63]
    s_waitcnt lgkmcnt(0)
    v_mfma_f32_16x16x32_bf16 v[60:63], v[140:143], v[236:239], v[60:63]
    s_waitcnt vmcnt(0)
    v_cmp_ne_u32 vcc, s45, v35
    s_nop 0
    s_lshr_b32 s0, vcc_lo, 12
    s_and_b32 s4, vcc_lo, 0xfff
    v_mov_b32 v28, 0
    s_cmp_lg_u32 s3, 3
    s_cbranch_scc1 L_ts_11
    s_and_b32 s4, s45, 0xfffffff0
    s_or_b32 s4, s4, s46
    v_mov_b32 v24, s4
    s_lshl_b32 s5, s2, 4
    s_add_u32 s5, s5, 0x60000
    v_mov_b32 v25, 0
    s_mov_b64 exec, 1
    buffer_store_dword v24, v25, s[20:23], s5 offen sc1
    s_mov_b64 exec, -1
L_ts_11:
    s_barrier
    s_lshl_b32 s4, s3, 6
    v_add_u32 v26, s4, v21
    ds_read_b128 v[40:43], v26 offset:768
    ds_read_b128 v[44:47], v26 offset:1024
    ds_read_b128 v[112:115], v12
    ds_read_b128 v[116:119], v13
    ds_read_b128 v[120:123], v14
    ds_read_b128 v[124:127], v15
    ds_read_b128 v[128:131], v12 offset:256
    ds_read_b128 v[132:135], v13 offset:256
    s_waitcnt lgkmcnt(4)
    v_mfma_f32_16x16x32_bf16 v[80:83], v[112:115], v[112:115], 0
    ds_read_b128 v[136:139], v14 offset:256
    v_mfma_f32_16x16x32_bf16 v[84:87], v[144:147], v[112:115], 0
    v_mfma_f32_16x16x32_bf16 v[88:91], v[92:95], v[112:115], 0
    v_mfma_f32_16x16x32_bf16 v[80:83], v[116:119], v[116:119], v[80:83]
    ds_read_b128 v[140:143], v15 offset:256
    v_mfma_f32_16x16x32_bf16 v[84:87], v[148:151], v[116:119], v[84:87]
    v_mfma_f32_16x16x32_bf16 v[88:91], v[92:95], v[116:119], v[88:91]
    s_waitcnt lgkmcnt(4)
    v_mfma_f32_16x16x32_bf16 v[80:83], v[120:123], v[120:123], v[80:83]
    ds_read_b128 v[112:115], v12 offset:512
    v_mfma_f32_16x16x32_bf16 v[84:87], v[152:155], v[120:123], v[84:87]
    v_mfma_f32_16x16x32_bf16 v[88:91], v[92:95], v[120:123], v[88:91]
    v_mfma_f32_16x16x32_bf16 v[80:83], v[124:127], v[124:127], v[80:83]
    ds_read_b128 v[116:119], v13 offset:512
    v_mfma_f32_16x16x32_bf16 v[84:87], v[156:159], v[124:127], v[84:87]
    v_mfma_f32_16x16x32_bf16 v[88:91], v[92:95], v[124:127], v[88:91]
    s_waitcnt lgkmcnt(4)
    v_mfma_f32_16x16x32_bf16 v[80:83], v[128:131], v[128:131], v[80:83]
    ds_read_b128 v[120:123], v14 offset:512
    v_mfma_f32_16x16x32_bf16 v[84:87], v[160:163], v[128:131], v[84:87]
    v_mfma_f32_16x16x32_bf16 v[88:91], v[92:95], v[128:131], v[88:91]
    v_mfma_f32_16x16x32_bf16 v[80:83], v[132:135], v[132:135], v[80:83]
    ds_read_b128 v[124:127], v15 offset:512
    v_mfma_f32_16x16x32_bf16 v[84:87], v[164:167], v[132:135], v[84:87]
    v_mfma_f32_16x16x32_bf16 v[88:91], v[92:95], v[132:135], v[88:91]
    s_waitcnt lgkmcnt(4)
    v_mfma_f32_16x16x32_bf16 v[80:83], v[136:139], v[136:139], v[80:83]
    ds_read_b128 v[128:131], v8
    v_mfma_f32_16x16x32_bf16 v[84:87], v[168:171], v[136:139], v[84:87]
    v_mfma_f32_16x16x32_bf16 v[88:91], v[92:95], v[136:139], v[88:91]
    v_mfma_f32_16x16x32_bf16 v[80:83], v[140:143], v[140:143], v[80:83]
    ds_read_b128 v[132:135], v9
    v_mfma_f32_16x16x32_bf16 v[84:87], v[172:175], v[140:143], v[84:87]
    v_mfma_f32_16x16x32_bf16 v[88:91], v[92:95], v[140:143], v[88:91]
    s_waitcnt lgkmcnt(4)
    v_mfma_f32_16x16x32_bf16 v[80:83], v[112:115], v[112:115], v[80:83]
    ds_read_b128 v[136:139], v10
    v_mfma_f32_16x16x32_bf16 v[84:87], v[176:179], v[112:115], v[84:87]
    v_mfma_f32_16x16x32_bf16 v[88:91], v[92:95], v[112:115], v[88:91]
    v_mfma_f32_16x16x32_bf16 v[80:83], v[116:119], v[116:119], v[80:83]
    ds_read_b128 v[140:143], v11
    v_mfma_f32_16x16x32_bf16 v[84:87], v[180:183], v[116:119], v[84:87]
    v_mfma_f32_16x16x32_bf16 v[88:91], v[92:95], v[116:119], v[88:91]
    s_waitcnt lgkmcnt(4)
    v_mfma_f32_16x16x32_bf16 v[80:83], v[120:123], v[120:123], v[80:83]
    ds_read_b128 v[112:115], v8 offset:256
    v_mfma_f32_16x16x32_bf16 v[84:87], v[184:187], v[120:123], v[84:87]
    v_mfma_f32_16x16x32_bf16 v[88:91], v[92:95], v[120:123], v[88:91]
    v_mfma_f32_16x16x32_bf16 v[80:83], v[124:127], v[124:127], v[80:83]
    ds_read_b128 v[116:119], v9 offset:256
    v_mfma_f32_16x16x32_bf16 v[84:87], v[188:191], v[124:127], v[84:87]
    v_mfma_f32_16x16x32_bf16 v[88:91], v[92:95], v[124:127], v[88:91]
    s_waitcnt lgkmcnt(4)
    v_mfma_f32_16x16x32_bf16 v[64:67], v[128:131], v[192:195], 0
    ds_read_b128 v[120:123], v10 offset:256
    v_mfma_f32_16x16x32_bf16 v[64:67], v[132:135], v[196:199], v[64:67]
    ds_read_b128 v[124:127], v11 offset:256
    s_waitcnt lgkmcnt(4)
    v_mfma_f32_16x16x32_bf16 v[64:67], v[136:139], v[200:203], v[64:67]
    ds_read_b128 v[128:131], v8 offset:512
    v_mfma_f32_16x16x32_bf16 v[64:67], v[140:143], v[204:207], v[64:67]
    ds_read_b128 v[132:135], v9 offset:512
    v_cndmask_b32 v24, v80, v81, s[92:93]
    v_cndmask_b32 v25, v82, v83, s[96:97]
    v_add_f32 v31, v88, v44
    v_cndmask_b32 v24, v24, v25, s[94:95]
    v_mul_f32 v31, s89, v31
    v_fma_f32 v24, v84, 2.0, v24
    v_add_f32 v24, v24, v40
    v_mul_f32 v25, v31, v31
    v_fma_f32 v24, v24, s89, -v25
    v_max_f32 v24, 0, v24
    v_add_f32 v24, s90, v24
    v_rsq_f32 v24, v24
    ds_write_b32 v22, v31 offset:256
    ds_write_b32 v22, v24
    s_waitcnt lgkmcnt(6)
    v_mfma_f32_16x16x32_bf16 v[64:67], v[112:115], v[208:211], v[64:67]
    ds_read_b128 v[136:139], v10 offset:512
    v_mfma_f32_16x16x32_bf16 v[64:67], v[116:119], v[212:215], v[64:67]
    ds_read_b128 v[140:143], v11 offset:512
    s_waitcnt lgkmcnt(6)
    v_mfma_f32_16x16x32_bf16 v[64:67], v[120:123], v[216:219], v[64:67]
    ds_read_b128 v[112:115], v8 offset:12288
    v_mfma_f32_16x16x32_bf16 v[64:67], v[124:127], v[220:223], v[64:67]
    ds_read_b128 v[116:119], v9 offset:12288
    s_waitcnt lgkmcnt(6)
    v_mfma_f32_16x16x32_bf16 v[64:67], v[128:131], v[224:227], v[64:67]
    ds_read_b128 v[120:123], v10 offset:12288
    v_mfma_f32_16x16x32_bf16 v[64:67], v[132:135], v[228:231], v[64:67]
    ds_read_b128 v[124:127], v11 offset:12288
    s_waitcnt lgkmcnt(4)
    v_mfma_f32_16x16x32_bf16 v[64:67], v[136:139], v[232:235], v[64:67]
    ds_read_b128 v[128:131], v8 offset:12544
    v_mfma_f32_16x16x32_bf16 v[64:67], v[140:143], v[236:239], v[64:67]
    ds_read_b128 v[132:135], v9 offset:12544
    s_barrier
    ds_read_b128 v[96:99], v21
    ds_read_b128 v[100:103], v21 offset:256
    ds_read_b128 v[104:107], v21 offset:64
    ds_read_b128 v[108:111], v21 offset:320
    s_mov_b32 exec_lo, 0x11111111
    s_mov_b32 exec_hi, 0x11111111
    v_mov_b64 v[144:145], v[92:93]
    v_mov_b64 v[146:147], v[92:93]
    v_mov_b64 v[148:149], v[92:93]
    v_mov_b64 v[150:151], v[92:93]
    v_mov_b64 v[152:153], v[92:93]
    v_mov_b64 v[154:155], v[92:93]
    v_mov_b64 v[156:157], v[92:93]
    v_mov_b64 v[158:159], v[92:93]
    v_mov_b64 v[160:161], v[92:93]
    v_mov_b64 v[162:163], v[92:93]
    v_mov_b64 v[164:165], v[92:93]
    v_mov_b64 v[166:167], v[92:93]
    v_mov_b64 v[168:169], v[92:93]
    v_mov_b64 v[170:171], v[92:93]
    v_mov_b64 v[172:173], v[92:93]
    v_mov_b64 v[174:175], v[92:93]
    v_mov_b64 v[176:177], v[92:93]
    v_mov_b64 v[178:179], v[92:93]
    v_mov_b64 v[180:181], v[92:93]
    v_mov_b64 v[182:183], v[92:93]
    v_mov_b64 v[184:185], v[92:93]
    v_mov_b64 v[186:187], v[92:93]
    v_mov_b64 v[188:189], v[92:93]
    v_mov_b64 v[190:191], v[92:93]
    s_mov_b64 exec, -1
    s_waitcnt lgkmcnt(8)
    v_mfma_f32_16x16x32_bf16 v[68:71], v[112:115], v[192:195], 0
    ds_read_b128 v[136:139], v10 offset:12544
    v_add_u32 v12, 0x10000, v12
    v_mfma_f32_16x16x32_bf16 v[68:71], v[116:119], v[196:199], v[68:71]
    ds_read_b128 v[140:143], v11 offset:12544
    v_add_u32 v13, 0x10000, v13
    s_waitcnt lgkmcnt(8)
    v_mfma_f32_16x16x32_bf16 v[68:71], v[120:123], v[200:203], v[68:71]
    ds_read_b128 v[112:115], v8 offset:12800
    v_add_u32 v14, 0x10000, v14
    v_mfma_f32_16x16x32_bf16 v[68:71], v[124:127], v[204:207], v[68:71]
    ds_read_b128 v[116:119], v9 offset:12800
    v_add_u32 v15, 0x10000, v15
    s_waitcnt lgkmcnt(8)
    v_mfma_f32_16x16x32_bf16 v[68:71], v[128:131], v[208:211], v[68:71]
    ds_read_b128 v[120:123], v10 offset:12800
    v_mfma_f32_16x16x32_bf16 v[68:71], v[132:135], v[212:215], v[68:71]
    ds_read_b128 v[124:127], v11 offset:12800
    s_waitcnt lgkmcnt(4)
    v_mfma_f32_16x16x32_bf16 v[68:71], v[136:139], v[216:219], v[68:71]
    ds_read_b128 v[128:131], v8 offset:24576
    v_mfma_f32_16x16x32_bf16 v[68:71], v[140:143], v[220:223], v[68:71]
    ds_read_b128 v[132:135], v9 offset:24576
    s_waitcnt lgkmcnt(4)
    v_mfma_f32_16x16x32_bf16 v[68:71], v[112:115], v[224:227], v[68:71]
    ds_read_b128 v[136:139], v10 offset:24576
    v_mfma_f32_16x16x32_bf16 v[68:71], v[116:119], v[228:231], v[68:71]
    ds_read_b128 v[140:143], v11 offset:24576
    s_waitcnt lgkmcnt(4)
    v_mfma_f32_16x16x32_bf16 v[68:71], v[120:123], v[232:235], v[68:71]
    ds_read_b128 v[112:115], v8 offset:24832
    v_mfma_f32_16x16x32_bf16 v[68:71], v[124:127], v[236:239], v[68:71]
    ds_read_b128 v[116:119], v9 offset:24832
    v_fma_f32 v100, -v100, v29, v48
    v_fma_f32 v101, -v101, v29, v48
    v_fma_f32 v102, -v102, v29, v48
    v_fma_f32 v103, -v103, v29, v48
    v_add_f32 v100, v100, v64
    v_add_f32 v101, v101, v65
    v_add_f32 v102, v102, v66
    v_add_f32 v103, v103, v67
    v_mul_f32 v100, v100, v96
    v_mul_f32 v101, v101, v97
    v_mul_f32 v102, v102, v98
    v_mul_f32 v103, v103, v99
    v_max3_f32 v27, v100, v101, v102
    v_max_f32 v27, v27, v103
    v_mov_b32 v26, v27
    s_nop 1
    v_permlane16_swap_b32 v26, v27
    v_max_f32 v27, v27, v26
    v_mov_b32 v26, v27
    s_nop 1
    v_permlane32_swap_b32 v26, v27
    v_max_f32 v27, v27, v26
    v_sub_f32 v100, v100, v27
    v_sub_f32 v101, v101, v27
    v_sub_f32 v102, v102, v27
    v_sub_f32 v103, v103, v27
    v_exp_f32 v100, v100
    v_exp_f32 v101, v101
    v_exp_f32 v102, v102
    v_exp_f32 v103, v103
    v_mul_f32 v96, v96, v100
    v_mul_f32 v97, v97, v101
    v_mul_f32 v98, v98, v102
    v_mul_f32 v99, v99, v103
    v_add_f32 v100, v100, v101
    v_add_f32 v102, v102, v103
    v_add_f32 v30, v100, v102
    v_cvt_pk_bf16_f32 v102, v96, v97
    v_cvt_pk_bf16_f32 v103, v98, v99
    v_add_f32 v96, v96, v97
    v_add_f32 v98, v98, v99
    ds_write_b64 v16, v[102:103]
    v_add_f32 v32, v96, v98
    ds_read_b128 v[96:99], v21 offset:128
    ds_read_b128 v[100:103], v21 offset:384
    s_waitcnt lgkmcnt(7)
    v_mfma_f32_16x16x32_bf16 v[72:75], v[128:131], v[192:195], 0
    ds_read_b128 v[120:123], v10 offset:24832
    v_mfma_f32_16x16x32_bf16 v[72:75], v[132:135], v[196:199], v[72:75]
    ds_read_b128 v[124:127], v11 offset:24832
    s_waitcnt lgkmcnt(7)
    v_mfma_f32_16x16x32_bf16 v[72:75], v[136:139], v[200:203], v[72:75]
    ds_read_b128 v[128:131], v8 offset:25088
    v_mfma_f32_16x16x32_bf16 v[72:75], v[140:143], v[204:207], v[72:75]
    ds_read_b128 v[132:135], v9 offset:25088
    s_waitcnt lgkmcnt(7)
    v_mfma_f32_16x16x32_bf16 v[72:75], v[112:115], v[208:211], v[72:75]
    ds_read_b128 v[136:139], v10 offset:25088
    v_mfma_f32_16x16x32_bf16 v[72:75], v[116:119], v[212:215], v[72:75]
    ds_read_b128 v[140:143], v11 offset:25088
    s_waitcnt lgkmcnt(4)
    v_mfma_f32_16x16x32_bf16 v[72:75], v[120:123], v[216:219], v[72:75]
    ds_read_b128 v[112:115], v8 offset:36864
    v_mfma_f32_16x16x32_bf16 v[72:75], v[124:127], v[220:223], v[72:75]
    ds_read_b128 v[116:119], v9 offset:36864
    s_waitcnt lgkmcnt(4)
    v_mfma_f32_16x16x32_bf16 v[72:75], v[128:131], v[224:227], v[72:75]
    ds_read_b128 v[120:123], v10 offset:36864
    v_mfma_f32_16x16x32_bf16 v[72:75], v[132:135], v[228:231], v[72:75]
    ds_read_b128 v[124:127], v11 offset:36864
    s_waitcnt lgkmcnt(4)
    v_mfma_f32_16x16x32_bf16 v[72:75], v[136:139], v[232:235], v[72:75]
    ds_read_b128 v[128:131], v8 offset:37120
    v_mfma_f32_16x16x32_bf16 v[72:75], v[140:143], v[236:239], v[72:75]
    ds_read_b128 v[132:135], v9 offset:37120
    v_fma_f32 v108, -v108, v29, v52
    v_fma_f32 v109, -v109, v29, v52
    v_fma_f32 v110, -v110, v29, v52
    v_fma_f32 v111, -v111, v29, v52
    v_add_f32 v108, v108, v68
    v_add_f32 v109, v109, v69
    v_add_f32 v110, v110, v70
    v_add_f32 v111, v111, v71
    v_fma_f32 v108, v108, v104, -v27
    v_fma_f32 v109, v109, v105, -v27
    v_fma_f32 v110, v110, v106, -v27
    v_fma_f32 v111, v111, v107, -v27
    v_exp_f32 v108, v108
    v_exp_f32 v109, v109
    v_exp_f32 v110, v110
    v_exp_f32 v111, v111
    v_mul_f32 v104, v104, v108
    v_mul_f32 v105, v105, v109
    v_mul_f32 v106, v106, v110
    v_mul_f32 v107, v107, v111
    v_add_f32 v108, v108, v109
    v_add_f32 v110, v110, v111
    v_add_f32 v108, v108, v110
    v_add_f32 v30, v30, v108
    v_cvt_pk_bf16_f32 v110, v104, v105
    v_cvt_pk_bf16_f32 v111, v106, v107
    v_add_f32 v104, v104, v105
    v_add_f32 v106, v106, v107
    ds_write_b64 v17, v[110:111]
    v_add_f32 v33, v104, v106
    ds_read_b128 v[104:107], v21 offset:192
    ds_read_b128 v[108:111], v21 offset:448
    s_waitcnt lgkmcnt(7)
    v_mfma_f32_16x16x32_bf16 v[76:79], v[112:115], v[192:195], 0
    ds_read_b128 v[136:139], v10 offset:37120
    v_mfma_f32_16x16x32_bf16 v[76:79], v[116:119], v[196:199], v[76:79]
    ds_read_b128 v[140:143], v11 offset:37120
    s_waitcnt lgkmcnt(7)
    v_mfma_f32_16x16x32_bf16 v[76:79], v[120:123], v[200:203], v[76:79]
    ds_read_b128 v[112:115], v8 offset:37376
    v_mfma_f32_16x16x32_bf16 v[76:79], v[124:127], v[204:207], v[76:79]
    ds_read_b128 v[116:119], v9 offset:37376
    s_waitcnt lgkmcnt(7)
    v_mfma_f32_16x16x32_bf16 v[76:79], v[128:131], v[208:211], v[76:79]
    ds_read_b128 v[120:123], v10 offset:37376
    v_mfma_f32_16x16x32_bf16 v[76:79], v[132:135], v[212:215], v[76:79]
    ds_read_b128 v[124:127], v11 offset:37376
    s_waitcnt lgkmcnt(4)
    v_mfma_f32_16x16x32_bf16 v[76:79], v[136:139], v[216:219], v[76:79]
    v_mfma_f32_16x16x32_bf16 v[76:79], v[140:143], v[220:223], v[76:79]
    v_add_u32 v8, 0x10000, v8
    s_waitcnt lgkmcnt(3)
    v_mfma_f32_16x16x32_bf16 v[76:79], v[112:115], v[224:227], v[76:79]
    v_add_u32 v9, 0x10000, v9
    s_waitcnt lgkmcnt(2)
    v_mfma_f32_16x16x32_bf16 v[76:79], v[116:119], v[228:231], v[76:79]
    v_add_u32 v10, 0x10000, v10
    s_waitcnt lgkmcnt(1)
    v_mfma_f32_16x16x32_bf16 v[76:79], v[120:123], v[232:235], v[76:79]
    v_add_u32 v11, 0x10000, v11
    s_waitcnt lgkmcnt(0)
    v_mfma_f32_16x16x32_bf16 v[76:79], v[124:127], v[236:239], v[76:79]
    v_fma_f32 v100, -v100, v29, v56
    v_fma_f32 v101, -v101, v29, v56
    v_fma_f32 v102, -v102, v29, v56
    v_fma_f32 v103, -v103, v29, v56
    v_add_f32 v100, v100, v72
    v_add_f32 v101, v101, v73
    v_add_f32 v102, v102, v74
    v_add_f32 v103, v103, v75
    v_fma_f32 v100, v100, v96, -v27
    v_fma_f32 v101, v101, v97, -v27
    v_fma_f32 v102, v102, v98, -v27
    v_fma_f32 v103, v103, v99, -v27
    v_exp_f32 v100, v100
    v_exp_f32 v101, v101
    v_exp_f32 v102, v102
    v_exp_f32 v103, v103
    v_mul_f32 v96, v96, v100
    v_mul_f32 v97, v97, v101
    v_mul_f32 v98, v98, v102
    v_mul_f32 v99, v99, v103
    v_add_f32 v100, v100, v101
    v_add_f32 v102, v102, v103
    v_add_f32 v100, v100, v102
    v_add_f32 v30, v30, v100
    v_cvt_pk_bf16_f32 v102, v96, v97
    v_cvt_pk_bf16_f32 v103, v98, v99
    v_add_f32 v96, v96, v97
    v_add_f32 v98, v98, v99
    ds_write_b64 v18, v[102:103]
    v_add_f32 v34, v96, v98
    v_fma_f32 v108, -v108, v29, v60
    v_fma_f32 v109, -v109, v29, v60
    v_fma_f32 v110, -v110, v29, v60
    v_fma_f32 v111, -v111, v29, v60
    v_add_f32 v108, v108, v76
    v_add_f32 v109, v109, v77
    v_add_f32 v110, v110, v78
    v_add_f32 v111, v111, v79
    v_fma_f32 v108, v108, v104, -v27
    v_fma_f32 v109, v109, v105, -v27
    v_fma_f32 v110, v110, v106, -v27
    v_fma_f32 v111, v111, v107, -v27
    v_exp_f32 v108, v108
    v_exp_f32 v109, v109
    v_exp_f32 v110, v110
    v_exp_f32 v111, v111
    v_mul_f32 v104, v104, v108
    v_mul_f32 v105, v105, v109
    v_mul_f32 v106, v106, v110
    v_mul_f32 v107, v107, v111
    v_add_f32 v108, v108, v109
    v_add_f32 v110, v110, v111
    v_add_f32 v108, v108, v110
    v_add_f32 v30, v30, v108
    v_cvt_pk_bf16_f32 v110, v104, v105
    v_cvt_pk_bf16_f32 v111, v106, v107
    v_add_f32 v104, v104, v105
    v_add_f32 v106, v106, v107
    ds_write_b64 v19, v[110:111]
    v_add_f32 v35, v104, v106
    v_cmp_nge_f32 vcc, s91, v30
    v_cvt_pk_bf16_f32 v32, v32, v33
    v_cvt_pk_bf16_f32 v33, v34, v35
    ds_write_b64 v20, v[32:33]
    s_cbranch_vccnz L_rare_12
L_back_13:
    v_add_f32 v28, v28, v30
    s_waitcnt lgkmcnt(0)
    s_barrier
    ds_read_b128 v[112:115], v12
    ds_read_b128 v[116:119], v13
    ds_read_b128 v[120:123], v14
    ds_read_b128 v[124:127], v15
    ds_read_b128 v[128:131], v12 offset:256
    ds_read_b128 v[132:135], v13 offset:256
    s_waitcnt lgkmcnt(4)
    v_mfma_f32_16x16x32_bf16 v[80:83], v[112:115], v[112:115], 0
    ds_read_b128 v[136:139], v14 offset:256
    v_mfma_f32_16x16x32_bf16 v[84:87], v[144:147], v[112:115], 0
    v_mfma_f32_16x16x32_bf16 v[80:83], v[116:119], v[116:119], v[80:83]
    ds_read_b128 v[140:143], v15 offset:256
    v_mfma_f32_16x16x32_bf16 v[84:87], v[148:151], v[116:119], v[84:87]
    s_waitcnt lgkmcnt(4)
    v_mfma_f32_16x16x32_bf16 v[80:83], v[120:123], v[120:123], v[80:83]
    ds_read_b128 v[112:115], v12 offset:512
    v_mfma_f32_16x16x32_bf16 v[84:87], v[152:155], v[120:123], v[84:87]
    v_mfma_f32_16x16x32_bf16 v[80:83], v[124:127], v[124:127], v[80:83]
    ds_read_b128 v[116:119], v13 offset:512
    v_mfma_f32_16x16x32_bf16 v[84:87], v[156:159], v[124:127], v[84:87]
    s_waitcnt lgkmcnt(4)
    v_mfma_f32_16x16x32_bf16 v[80:83], v[128:131], v[128:131], v[80:83]
    ds_read_b128 v[120:123], v14 offset:512
    v_mfma_f32_16x16x32_bf16 v[84:87], v[160:163], v[128:131], v[84:87]
    v_mfma_f32_16x16x32_bf16 v[80:83], v[132:135], v[132:135], v[80:83]
    ds_read_b128 v[124:127], v15 offset:512
    v_mfma_f32_16x16x32_bf16 v[84:87], v[164:167], v[132:135], v[84:87]
    s_waitcnt lgkmcnt(4)
    v_mfma_f32_16x16x32_bf16 v[80:83], v[136:139], v[136:139], v[80:83]
    ds_read_b128 v[128:131], v8
    v_mfma_f32_16x16x32_bf16 v[84:87], v[168:171], v[136:139], v[84:87]
    v_mfma_f32_16x16x32_bf16 v[80:83], v[140:143], v[140:143], v[80:83]
    ds_read_b128 v[132:135], v9
    v_mfma_f32_16x16x32_bf16 v[84:87], v[172:175], v[140:143], v[84:87]
    s_waitcnt lgkmcnt(4)
    v_mfma_f32_16x16x32_bf16 v[80:83], v[112:115], v[112:115], v[80:83]
    ds_read_b128 v[136:139], v10
    v_mfma_f32_16x16x32_bf16 v[84:87], v[176:179], v[112:115], v[84:87]
    v_mfma_f32_16x16x32_bf16 v[80:83], v[116:119], v[116:119], v[80:83]
    ds_read_b128 v[140:143], v11
    v_mfma_f32_16x16x32_bf16 v[84:87], v[180:183], v[116:119], v[84:87]
    s_waitcnt lgkmcnt(4)
    v_mfma_f32_16x16x32_bf16 v[80:83], v[120:123], v[120:123], v[80:83]
    ds_read_b128 v[112:115], v8 offset:256
    v_mfma_f32_16x16x32_bf16 v[84:87], v[184:187], v[120:123], v[84:87]
    v_mfma_f32_16x16x32_bf16 v[80:83], v[124:127], v[124:127], v[80:83]
    ds_read_b128 v[116:119], v9 offset:256
    v_mfma_f32_16x16x32_bf16 v[84:87], v[188:191], v[124:127], v[84:87]
    s_waitcnt lgkmcnt(4)
    v_mfma_f32_16x16x32_bf16 v[64:67], v[128:131], v[192:195], 0
    ds_read_b128 v[120:123], v10 offset:256
    v_mfma_f32_16x16x32_bf16 v[64:67], v[132:135], v[196:199], v[64:67]
    ds_read_b128 v[124:127], v11 offset:256
    s_waitcnt lgkmcnt(4)
    v_mfma_f32_16x16x32_bf16 v[64:67], v[136:139], v[200:203], v[64:67]
    ds_read_b128 v[128:131], v8 offset:512
    v_mfma_f32_16x16x32_bf16 v[64:67], v[140:143], v[204:207], v[64:67]
    ds_read_b128 v[132:135], v9 offset:512
    v_cndmask_b32 v24, v80, v81, s[92:93]
    v_cndmask_b32 v25, v82, v83, s[96:97]
    v_add_f32 v31, v84, v45
    v_cndmask_b32 v24, v24, v25, s[94:95]
    v_mul_f32 v31, s89, v31
    v_fma_f32 v24, v85, 2.0, v24
    v_add_f32 v24, v24, v41
    v_mul_f32 v25, v31, v31
    v_fma_f32 v24, v24, s89, -v25
    v_max_f32 v24, 0, v24
    v_add_f32 v24, s90, v24
    v_rsq_f32 v24, v24
    ds_write_b32 v22, v31 offset:256
    ds_write_b32 v22, v24
    s_waitcnt lgkmcnt(6)
    v_mfma_f32_16x16x32_bf16 v[64:67], v[112:115], v[208:211], v[64:67]
    ds_read_b128 v[136:139], v10 offset:512
    v_mfma_f32_16x16x32_bf16 v[64:67], v[116:119], v[212:215], v[64:67]
    ds_read_b128 v[140:143], v11 offset:512
    s_waitcnt lgkmcnt(6)
    v_mfma_f32_16x16x32_bf16 v[64:67], v[120:123], v[216:219], v[64:67]
    ds_read_b128 v[112:115], v8 offset:12288
    v_mfma_f32_16x16x32_bf16 v[64:67], v[124:127], v[220:223], v[64:67]
    ds_read_b128 v[116:119], v9 offset:12288
    s_waitcnt lgkmcnt(6)
    v_mfma_f32_16x16x32_bf16 v[64:67], v[128:131], v[224:227], v[64:67]
    ds_read_b128 v[120:123], v10 offset:12288
    v_mfma_f32_16x16x32_bf16 v[64:67], v[132:135], v[228:231], v[64:67]
    ds_read_b128 v[124:127], v11 offset:12288
    s_waitcnt lgkmcnt(4)
    v_mfma_f32_16x16x32_bf16 v[64:67], v[136:139], v[232:235], v[64:67]
    ds_read_b128 v[128:131], v8 offset:12544
    v_mfma_f32_16x16x32_bf16 v[64:67], v[140:143], v[236:239], v[64:67]
    ds_read_b128 v[132:135], v9 offset:12544
    s_barrier
    ds_read_b128 v[96:99], v21
    ds_read_b128 v[100:103], v21 offset:256
    ds_read_b128 v[104:107], v21 offset:64
    ds_read_b128 v[108:111], v21 offset:320
    s_waitcnt lgkmcnt(8)
    v_mfma_f32_16x16x32_bf16 v[68:71], v[112:115], v[192:195], 0
    ds_read_b128 v[136:139], v10 offset:12544
    v_add_u32 v12, 0xc000, v12
    v_mfma_f32_16x16x32_bf16 v[68:71], v[116:119], v[196:199], v[68:71]
    ds_read_b128 v[140:143], v11 offset:12544
    v_add_u32 v13, 0xc000, v13
    s_waitcnt lgkmcnt(8)
    v_mfma_f32_16x16x32_bf16 v[68:71], v[120:123], v[200:203], v[68:71]
    ds_read_b128 v[112:115], v8 offset:12800
    v_add_u32 v14, 0xc000, v14
    v_mfma_f32_16x16x32_bf16 v[68:71], v[124:127], v[204:207], v[68:71]
    ds_read_b128 v[116:119], v9 offset:12800
    v_add_u32 v15, 0xc000, v15
    s_waitcnt lgkmcnt(8)
    v_mfma_f32_16x16x32_bf16 v[68:71], v[128:131], v[208:211], v[68:71]
    ds_read_b128 v[120:123], v10 offset:12800
    v_mfma_f32_16x16x32_bf16 v[68:71], v[132:135], v[212:215], v[68:71]
    ds_read_b128 v[124:127], v11 offset:12800
    s_waitcnt lgkmcnt(4)
    v_mfma_f32_16x16x32_bf16 v[68:71], v[136:139], v[216:219], v[68:71]
    ds_read_b128 v[128:131], v8 offset:24576
    v_mfma_f32_16x16x32_bf16 v[68:71], v[140:143], v[220:223], v[68:71]
    ds_read_b128 v[132:135], v9 offset:24576
    s_waitcnt lgkmcnt(4)
    v_mfma_f32_16x16x32_bf16 v[68:71], v[112:115], v[224:227], v[68:71]
    ds_read_b128 v[136:139], v10 offset:24576
    v_mfma_f32_16x16x32_bf16 v[68:71], v[116:119], v[228:231], v[68:71]
    ds_read_b128 v[140:143], v11 offset:24576
    s_waitcnt lgkmcnt(4)
    v_mfma_f32_16x16x32_bf16 v[68:71], v[120:123], v[232:235], v[68:71]
    ds_read_b128 v[112:115], v8 offset:24832
    v_mfma_f32_16x16x32_bf16 v[68:71], v[124:127], v[236:239], v[68:71]
    ds_read_b128 v[116:119], v9 offset:24832
    v_fma_f32 v100, -v100, v29, v49
    v_fma_f32 v101, -v101, v29, v49
    v_fma_f32 v102, -v102, v29, v49
    v_fma_f32 v103, -v103, v29, v49
    v_add_f32 v100, v100, v64
    s_cmp_lg_u32 s0, 0
    s_cbranch_scc1 L_fv_14
L_fvb_15:
    v_add_f32 v101, v101, v65
    v_add_f32 v102, v102, v66
    v_add_f32 v103, v103, v67
    v_fma_f32 v100, v100, v96, -v27
    v_fma_f32 v101, v101, v97, -v27
    s_add_u32 s42, s58, 0
    buffer_load_dwordx4 v[240:243], v23, s[20:23], s42 offen
    v_fma_f32 v102, v102, v98, -v27
    v_fma_f32 v103, v103, v99, -v27
    v_exp_f32 v100, v100
    v_exp_f32 v101, v101
    v_exp_f32 v102, v102
    buffer_load_dwordx4 v[244:247], v23, s[20:23], s42 offen offset:1024
    v_exp_f32 v103, v103
    v_mul_f32 v96, v96, v100
    v_mul_f32 v97, v97, v101
    v_mul_f32 v98, v98, v102
    v_mul_f32 v99, v99, v103
    buffer_load_dwordx4 v[248:251], v23, s[20:23], s42 offen offset:2048
    v_add_f32 v100, v100, v101
    v_add_f32 v102, v102, v103
    v_add_f32 v30, v100, v102
    v_cvt_pk_bf16_f32 v102, v96, v97
    v_cvt_pk_bf16_f32 v103, v98, v99
    v_add_f32 v96, v96, v97
    v_add_f32 v98, v98, v99
    ds_write_b64 v16, v[102:103]
    v_add_f32 v32, v96, v98
    ds_read_b128 v[96:99], v21 offset:128
    ds_read_b128 v[100:103], v21 offset:384
    s_waitcnt lgkmcnt(7)
    v_mfma_f32_16x16x32_bf16 v[72:75], v[128:131], v[192:195], 0
    ds_read_b128 v[120:123], v10 offset:24832
    v_mfma_f32_16x16x32_bf16 v[72:75], v[132:135], v[196:199], v[72:75]
    ds_read_b128 v[124:127], v11 offset:24832
    s_waitcnt lgkmcnt(7)
    v_mfma_f32_16x16x32_bf16 v[72:75], v[136:139], v[200:203], v[72:75]
    ds_read_b128 v[128:131], v8 offset:25088
    v_mfma_f32_16x16x32_bf16 v[72:75], v[140:143], v[204:207], v[72:75]
    ds_read_b128 v[132:135], v9 offset:25088
    s_waitcnt lgkmcnt(7)
    v_mfma_f32_16x16x32_bf16 v[72:75], v[112:115], v[208:211], v[72:75]
    ds_read_b128 v[136:139], v10 offset:25088
    v_mfma_f32_16x16x32_bf16 v[72:75], v[116:119], v[212:215], v[72:75]
    ds_read_b128 v[140:143], v11 offset:25088
    s_waitcnt lgkmcnt(4)
    v_mfma_f32_16x16x32_bf16 v[72:75], v[120:123], v[216:219], v[72:75]
    ds_read_b128 v[112:115], v8 offset:36864
    v_mfma_f32_16x16x32_bf16 v[72:75], v[124:127], v[220:223], v[72:75]
    ds_read_b128 v[116:119], v9 offset:36864
    s_waitcnt lgkmcnt(4)
    v_mfma_f32_16x16x32_bf16 v[72:75], v[128:131], v[224:227], v[72:75]
    ds_read_b128 v[120:123], v10 offset:36864
    v_mfma_f32_16x16x32_bf16 v[72:75], v[132:135], v[228:231], v[72:75]
    ds_read_b128 v[124:127], v11 offset:36864
    s_waitcnt lgkmcnt(4)
    v_mfma_f32_16x16x32_bf16 v[72:75], v[136:139], v[232:235], v[72:75]
    ds_read_b128 v[128:131], v8 offset:37120
    v_mfma_f32_16x16x32_bf16 v[72:75], v[140:143], v[236:239], v[72:75]
    ds_read_b128 v[132:135], v9 offset:37120
    v_fma_f32 v108, -v108, v29, v53
    v_fma_f32 v109, -v109, v29, v53
    v_fma_f32 v110, -v110, v29, v53
    v_fma_f32 v111, -v111, v29, v53
    v_add_f32 v108, v108, v68
    buffer_load_dwordx4 v[252:255], v23, s[20:23], s42 offen offset:3072
    v_add_f32 v109, v109, v69
    v_add_f32 v110, v110, v70
    v_add_f32 v111, v111, v71
    v_fma_f32 v108, v108, v104, -v27
    v_fma_f32 v109, v109, v105, -v27
    s_add_u32 s42, s58, 0x1000
    buffer_load_dwordx4 v[88:91], v23, s[20:23], s42 offen
    v_fma_f32 v110, v110, v106, -v27
    v_fma_f32 v111, v111, v107, -v27
    v_exp_f32 v108, v108
    v_exp_f32 v109, v109
    v_exp_f32 v110, v110
    buffer_load_dwordx4 v[92:95], v23, s[20:23], s42 offen offset:1024
    v_exp_f32 v111, v111
    v_mul_f32 v104, v104, v108
    v_mul_f32 v105, v105, v109
    v_mul_f32 v106, v106, v110
    v_mul_f32 v107, v107, v111
    s_mov_b32 s28, s78
    s_and_b32 s29, s79, 0xffff
    s_mov_b32 s30, 0x48000
    s_mov_b32 s31, 0x20000
    v_min_u32 v26, 17, v1
    s_mul_i32 s4, s3, 18
    v_add_u32 v26, s4, v26
    v_lshlrev_b32 v26, 7, v26
    s_lshr_b32 s4, s2, 3
    s_mul_i32 s4, s4, 0x2400
    buffer_load_dword v40, v26, s[28:31], s4 offen
    v_add_f32 v108, v108, v109
    v_add_f32 v110, v110, v111
    v_add_f32 v108, v108, v110
    v_add_f32 v30, v30, v108
    v_cvt_pk_bf16_f32 v110, v104, v105
    v_cvt_pk_bf16_f32 v111, v106, v107
    v_add_f32 v104, v104, v105
    v_add_f32 v106, v106, v107
    ds_write_b64 v17, v[110:111]
    v_add_f32 v33, v104, v106
    ds_read_b128 v[104:107], v21 offset:192
    ds_read_b128 v[108:111], v21 offset:448
    s_waitcnt lgkmcnt(7)
    v_mfma_f32_16x16x32_bf16 v[76:79], v[112:115], v[192:195], 0
    ds_read_b128 v[136:139], v10 offset:37120
    v_mfma_f32_16x16x32_bf16 v[76:79], v[116:119], v[196:199], v[76:79]
    ds_read_b128 v[140:143], v11 offset:37120
    s_waitcnt lgkmcnt(7)
    v_mfma_f32_16x16x32_bf16 v[76:79], v[120:123], v[200:203], v[76:79]
    ds_read_b128 v[112:115], v8 offset:37376
    v_mfma_f32_16x16x32_bf16 v[76:79], v[124:127], v[204:207], v[76:79]
    ds_read_b128 v[116:119], v9 offset:37376
    s_waitcnt lgkmcnt(7)
    v_mfma_f32_16x16x32_bf16 v[76:79], v[128:131], v[208:211], v[76:79]
    ds_read_b128 v[120:123], v10 offset:37376
    v_mfma_f32_16x16x32_bf16 v[76:79], v[132:135], v[212:215], v[76:79]
    ds_read_b128 v[124:127], v11 offset:37376
    s_waitcnt lgkmcnt(4)
    v_mfma_f32_16x16x32_bf16 v[76:79], v[136:139], v[216:219], v[76:79]
    v_mfma_f32_16x16x32_bf16 v[76:79], v[140:143], v[220:223], v[76:79]
    v_add_u32 v8, 0xc000, v8
    s_waitcnt lgkmcnt(3)
    v_mfma_f32_16x16x32_bf16 v[76:79], v[112:115], v[224:227], v[76:79]
    v_add_u32 v9, 0xc000, v9
    s_waitcnt lgkmcnt(2)
    v_mfma_f32_16x16x32_bf16 v[76:79], v[116:119], v[228:231], v[76:79]
    v_add_u32 v10, 0xc000, v10
    s_waitcnt lgkmcnt(1)
    v_mfma_f32_16x16x32_bf16 v[76:79], v[120:123], v[232:235], v[76:79]
    v_add_u32 v11, 0xc000, v11
    s_waitcnt lgkmcnt(0)
    v_mfma_f32_16x16x32_bf16 v[76:79], v[124:127], v[236:239], v[76:79]
    v_fma_f32 v100, -v100, v29, v57
    v_fma_f32 v101, -v101, v29, v57
    v_fma_f32 v102, -v102, v29, v57
    v_fma_f32 v103, -v103, v29, v57
    v_add_f32 v100, v100, v72
    v_add_f32 v101, v101, v73
    v_add_f32 v102, v102, v74
    v_add_f32 v103, v103, v75
    v_fma_f32 v100, v100, v96, -v27
    v_fma_f32 v101, v101, v97, -v27
    v_fma_f32 v102, v102, v98, -v27
    v_fma_f32 v103, v103, v99, -v27
    v_exp_f32 v100, v100
    v_exp_f32 v101, v101
    v_exp_f32 v102, v102
    v_exp_f32 v103, v103
    v_mul_f32 v96, v96, v100
    v_mul_f32 v97, v97, v101
    v_mul_f32 v98, v98, v102
    v_mul_f32 v99, v99, v103
    v_add_f32 v100, v100, v101
    v_add_f32 v102, v102, v103
    v_add_f32 v100, v100, v102
    v_add_f32 v30, v30, v100
    v_cvt_pk_bf16_f32 v102, v96, v97
    v_cvt_pk_bf16_f32 v103, v98, v99
    v_add_f32 v96, v96, v97
    v_add_f32 v98, v98, v99
    ds_write_b64 v18, v[102:103]
    v_add_f32 v34, v96, v98
    v_fma_f32 v108, -v108, v29, v61
    v_fma_f32 v109, -v109, v29, v61
    v_fma_f32 v110, -v110, v29, v61
    v_fma_f32 v111, -v111, v29, v61
    v_add_f32 v108, v108, v76
    v_add_f32 v109, v109, v77
    v_add_f32 v110, v110, v78
    v_add_f32 v111, v111, v79
    v_fma_f32 v108, v108, v104, -v27
    v_fma_f32 v109, v109, v105, -v27
    v_fma_f32 v110, v110, v106, -v27
    v_fma_f32 v111, v111, v107, -v27
    v_exp_f32 v108, v108
    v_exp_f32 v109, v109
    v_exp_f32 v110, v110
    v_exp_f32 v111, v111
    v_mul_f32 v104, v104, v108
    v_mul_f32 v105, v105, v109
    v_mul_f32 v106, v106, v110
    v_mul_f32 v107, v107, v111
    v_add_f32 v108, v108, v109
    v_add_f32 v110, v110, v111
    v_add_f32 v108, v108, v110
    v_add_f32 v30, v30, v108
    v_cvt_pk_bf16_f32 v110, v104, v105
    v_cvt_pk_bf16_f32 v111, v106, v107
    v_add_f32 v104, v104, v105
    v_add_f32 v106, v106, v107
    ds_write_b64 v19, v[110:111]
    v_add_f32 v35, v104, v106
    v_cmp_nge_f32 vcc, s91, v30
    v_cvt_pk_bf16_f32 v32, v32, v33
    v_cvt_pk_bf16_f32 v33, v34, v35
    ds_write_b64 v20, v[32:33]
    s_cbranch_vccnz L_rare_16
L_back_17:
    v_add_f32 v28, v28, v30
    s_waitcnt lgkmcnt(0)
    s_barrier
    ds_read_b128 v[112:115], v12
    ds_read_b128 v[116:119], v13
    ds_read_b128 v[120:123], v14
    ds_read_b128 v[124:127], v15
    ds_read_b128 v[128:131], v12 offset:256
    ds_read_b128 v[132:135], v13 offset:256
    s_waitcnt lgkmcnt(4)
    v_mfma_f32_16x16x32_bf16 v[80:83], v[112:115], v[112:115], 0
    ds_read_b128 v[136:139], v14 offset:256
    v_mfma_f32_16x16x32_bf16 v[84:87], v[144:147], v[112:115], 0
    v_mfma_f32_16x16x32_bf16 v[80:83], v[116:119], v[116:119], v[80:83]
    ds_read_b128 v[140:143], v15 offset:256
    v_mfma_f32_16x16x32_bf16 v[84:87], v[148:151], v[116:119], v[84:87]
    s_waitcnt lgkmcnt(4)
    v_mfma_f32_16x16x32_bf16 v[80:83], v[120:123], v[120:123], v[80:83]
    ds_read_b128 v[112:115], v12 offset:512
    v_mfma_f32_16x16x32_bf16 v[84:87], v[152:155], v[120:123], v[84:87]
    v_mfma_f32_16x16x32_bf16 v[80:83], v[124:127], v[124:127], v[80:83]
    ds_read_b128 v[116:119], v13 offset:512
    v_mfma_f32_16x16x32_bf16 v[84:87], v[156:159], v[124:127], v[84:87]
    s_waitcnt lgkmcnt(4)
    v_mfma_f32_16x16x32_bf16 v[80:83], v[128:131], v[128:131], v[80:83]
    ds_read_b128 v[120:123], v14 offset:512
    v_mfma_f32_16x16x32_bf16 v[84:87], v[160:163], v[128:131], v[84:87]
    v_mfma_f32_16x16x32_bf16 v[80:83], v[132:135], v[132:135], v[80:83]
    ds_read_b128 v[124:127], v15 offset:512
    v_mfma_f32_16x16x32_bf16 v[84:87], v[164:167], v[132:135], v[84:87]
    s_waitcnt lgkmcnt(4)
    v_mfma_f32_16x16x32_bf16 v[80:83], v[136:139], v[136:139], v[80:83]
    ds_read_b128 v[128:131], v8
    v_mfma_f32_16x16x32_bf16 v[84:87], v[168:171], v[136:139], v[84:87]
    v_mfma_f32_16x16x32_bf16 v[80:83], v[140:143], v[140:143], v[80:83]
    ds_read_b128 v[132:135], v9
    v_mfma_f32_16x16x32_bf16 v[84:87], v[172:175], v[140:143], v[84:87]
    s_waitcnt lgkmcnt(4)
    v_mfma_f32_16x16x32_bf16 v[80:83], v[112:115], v[112:115], v[80:83]
    ds_read_b128 v[136:139], v10
    v_mfma_f32_16x16x32_bf16 v[84:87], v[176:179], v[112:115], v[84:87]
    v_mfma_f32_16x16x32_bf16 v[80:83], v[116:119], v[116:119], v[80:83]
    ds_read_b128 v[140:143], v11
    v_mfma_f32_16x16x32_bf16 v[84:87], v[180:183], v[116:119], v[84:87]
    s_waitcnt lgkmcnt(4)
    v_mfma_f32_16x16x32_bf16 v[80:83], v[120:123], v[120:123], v[80:83]
    ds_read_b128 v[112:115], v8 offset:256
    v_mfma_f32_16x16x32_bf16 v[84:87], v[184:187], v[120:123], v[84:87]
    v_mfma_f32_16x16x32_bf16 v[80:83], v[124:127], v[124:127], v[80:83]
    ds_read_b128 v[116:119], v9 offset:256
    v_mfma_f32_16x16x32_bf16 v[84:87], v[188:191], v[124:127], v[84:87]
    s_waitcnt lgkmcnt(4)
    v_mfma_f32_16x16x32_bf16 v[64:67], v[128:131], v[192:195], 0
    ds_read_b128 v[120:123], v10 offset:256
    v_mfma_f32_16x16x32_bf16 v[64:67], v[132:135], v[196:199], v[64:67]
    ds_read_b128 v[124:127], v11 offset:256
    s_waitcnt lgkmcnt(4)
    v_mfma_f32_16x16x32_bf16 v[64:67], v[136:139], v[200:203], v[64:67]
    ds_read_b128 v[128:131], v8 offset:512
    v_mfma_f32_16x16x32_bf16 v[64:67], v[140:143], v[204:207], v[64:67]
    ds_read_b128 v[132:135], v9 offset:512
    v_cndmask_b32 v24, v80, v81, s[92:93]
    v_cndmask_b32 v25, v82, v83, s[96:97]
    v_add_f32 v31, v84, v46
    v_cndmask_b32 v24, v24, v25, s[94:95]
    v_mul_f32 v31, s89, v31
    v_fma_f32 v24, v86, 2.0, v24
    v_add_f32 v24, v24, v42
    v_mul_f32 v25, v31, v31
    v_fma_f32 v24, v24, s89, -v25
    v_max_f32 v24, 0, v24
    v_add_f32 v24, s90, v24
    v_rsq_f32 v24, v24
    ds_write_b32 v22, v31 offset:256
    ds_write_b32 v22, v24
    s_waitcnt lgkmcnt(6)
    v_mfma_f32_16x16x32_bf16 v[64:67], v[112:115], v[208:211], v[64:67]
    ds_read_b128 v[136:139], v10 offset:512
    v_mfma_f32_16x16x32_bf16 v[64:67], v[116:119], v[212:215], v[64:67]
    ds_read_b128 v[140:143], v11 offset:512
    s_waitcnt lgkmcnt(6)
    v_mfma_f32_16x16x32_bf16 v[64:67], v[120:123], v[216:219], v[64:67]
    ds_read_b128 v[112:115], v8 offset:12288
    v_mfma_f32_16x16x32_bf16 v[64:67], v[124:127], v[220:223], v[64:67]
    ds_read_b128 v[116:119], v9 offset:12288
    s_waitcnt lgkmcnt(6)
    v_mfma_f32_16x16x32_bf16 v[64:67], v[128:131], v[224:227], v[64:67]
    ds_read_b128 v[120:123], v10 offset:12288
    v_mfma_f32_16x16x32_bf16 v[64:67], v[132:135], v[228:231], v[64:67]
    ds_read_b128 v[124:127], v11 offset:12288
    s_waitcnt lgkmcnt(4)
    v_mfma_f32_16x16x32_bf16 v[64:67], v[136:139], v[232:235], v[64:67]
    ds_read_b128 v[128:131], v8 offset:12544
    v_mfma_f32_16x16x32_bf16 v[64:67], v[140:143], v[236:239], v[64:67]
    ds_read_b128 v[132:135], v9 offset:12544
    s_barrier
    ds_read_b128 v[96:99], v21
    ds_read_b128 v[100:103], v21 offset:256
    ds_read_b128 v[104:107], v21 offset:64
    ds_read_b128 v[108:111], v21 offset:320
    s_waitcnt lgkmcnt(8)
    v_mfma_f32_16x16x32_bf16 v[68:71], v[112:115], v[192:195], 0
    ds_read_b128 v[136:139], v10 offset:12544
    v_add_u32 v12, 0xfffe4000, v12
    v_mfma_f32_16x16x32_bf16 v[68:71], v[116:119], v[196:199], v[68:71]
    ds_read_b128 v[140:143], v11 offset:12544
    v_add_u32 v13, 0xfffe4000, v13
    s_waitcnt lgkmcnt(8)
    v_mfma_f32_16x16x32_bf16 v[68:71], v[120:123], v[200:203], v[68:71]
    ds_read_b128 v[112:115], v8 offset:12800
    v_add_u32 v14, 0xfffe4000, v14
    v_mfma_f32_16x16x32_bf16 v[68:71], v[124:127], v[204:207], v[68:71]
    ds_read_b128 v[116:119], v9 offset:12800
    v_add_u32 v15, 0xfffe4000, v15
    s_waitcnt lgkmcnt(8)
    v_mfma_f32_16x16x32_bf16 v[68:71], v[128:131], v[208:211], v[68:71]
    ds_read_b128 v[120:123], v10 offset:12800
    v_mfma_f32_16x16x32_bf16 v[68:71], v[132:135], v[212:215], v[68:71]
    ds_read_b128 v[124:127], v11 offset:12800
    s_waitcnt lgkmcnt(4)
    v_mfma_f32_16x16x32_bf16 v[68:71], v[136:139], v[216:219], v[68:71]
    ds_read_b128 v[128:131], v8 offset:24576
    v_mfma_f32_16x16x32_bf16 v[68:71], v[140:143], v[220:223], v[68:71]
    ds_read_b128 v[132:135], v9 offset:24576
    s_waitcnt lgkmcnt(4)
    v_mfma_f32_16x16x32_bf16 v[68:71], v[112:115], v[224:227], v[68:71]
    ds_read_b128 v[136:139], v10 offset:24576
    v_mfma_f32_16x16x32_bf16 v[68:71], v[116:119], v[228:231], v[68:71]
    ds_read_b128 v[140:143], v11 offset:24576
    s_waitcnt lgkmcnt(4)
    v_mfma_f32_16x16x32_bf16 v[68:71], v[120:123], v[232:235], v[68:71]
    ds_read_b128 v[112:115], v8 offset:24832
    v_mfma_f32_16x16x32_bf16 v[68:71], v[124:127], v[236:239], v[68:71]
    ds_read_b128 v[116:119], v9 offset:24832
    v_fma_f32 v100, -v100, v29, v50
    v_fma_f32 v101, -v101, v29, v50
    v_fma_f32 v102, -v102, v29, v50
    v_fma_f32 v103, -v103, v29, v50
    v_add_f32 v100, v100, v64
    v_add_f32 v101, v101, v65
    v_add_f32 v102, v102, v66
    v_add_f32 v103, v103, v67
    v_fma_f32 v100, v100, v96, -v27
    v_fma_f32 v101, v101, v97, -v27
    v_fma_f32 v102, v102, v98, -v27
    v_fma_f32 v103, v103, v99, -v27
    v_exp_f32 v100, v100
    v_exp_f32 v101, v101
    v_exp_f32 v102, v102
    v_exp_f32 v103, v103
    v_mul_f32 v96, v96, v100
    v_mul_f32 v97, v97, v101
    v_mul_f32 v98, v98, v102
    v_mul_f32 v99, v99, v103
    v_add_f32 v100, v100, v101
    v_add_f32 v102, v102, v103
    v_add_f32 v30, v100, v102
    v_cvt_pk_bf16_f32 v102, v96, v97
    v_cvt_pk_bf16_f32 v103, v98, v99
    v_add_f32 v96, v96, v97
    v_add_f32 v98, v98, v99
    ds_write_b64 v16, v[102:103]
    v_add_f32 v32, v96, v98
    ds_read_b128 v[96:99], v21 offset:128
    ds_read_b128 v[100:103], v21 offset:384
    s_waitcnt lgkmcnt(7)
    v_mfma_f32_16x16x32_bf16 v[72:75], v[128:131], v[192:195], 0
    ds_read_b128 v[120:123], v10 offset:24832
    v_mfma_f32_16x16x32_bf16 v[72:75], v[132:135], v[196:199], v[72:75]
    ds_read_b128 v[124:127], v11 offset:24832
    s_waitcnt lgkmcnt(7)
    v_mfma_f32_16x16x32_bf16 v[72:75], v[136:139], v[200:203], v[72:75]
    ds_read_b128 v[128:131], v8 offset:25088
    v_mfma_f32_16x16x32_bf16 v[72:75], v[140:143], v[204:207], v[72:75]
    ds_read_b128 v[132:135], v9 offset:25088
    s_waitcnt lgkmcnt(7)
    v_mfma_f32_16x16x32_bf16 v[72:75], v[112:115], v[208:211], v[72:75]
    ds_read_b128 v[136:139], v10 offset:25088
    v_mfma_f32_16x16x32_bf16 v[72:75], v[116:119], v[212:215], v[72:75]
    ds_read_b128 v[140:143], v11 offset:25088
    s_waitcnt lgkmcnt(4)
    v_mfma_f32_16x16x32_bf16 v[72:75], v[120:123], v[216:219], v[72:75]
    ds_read_b128 v[112:115], v8 offset:36864
    v_mfma_f32_16x16x32_bf16 v[72:75], v[124:127], v[220:223], v[72:75]
    ds_read_b128 v[116:119], v9 offset:36864
    s_waitcnt lgkmcnt(4)
    v_mfma_f32_16x16x32_bf16 v[72:75], v[128:131], v[224:227], v[72:75]
    ds_read_b128 v[120:123], v10 offset:36864
    v_mfma_f32_16x16x32_bf16 v[72:75], v[132:135], v[228:231], v[72:75]
    ds_read_b128 v[124:127], v11 offset:36864
    s_waitcnt lgkmcnt(4)
    v_mfma_f32_16x16x32_bf16 v[72:75], v[136:139], v[232:235], v[72:75]
    ds_read_b128 v[128:131], v8 offset:37120
    v_mfma_f32_16x16x32_bf16 v[72:75], v[140:143], v[236:239], v[72:75]
    ds_read_b128 v[132:135], v9 offset:37120
    v_fma_f32 v108, -v108, v29, v54
    v_fma_f32 v109, -v109, v29, v54
    v_fma_f32 v110, -v110, v29, v54
    v_fma_f32 v111, -v111, v29, v54
    v_add_f32 v108, v108, v68
    v_add_f32 v109, v109, v69
    v_add_f32 v110, v110, v70
    v_add_f32 v111, v111, v71
    v_fma_f32 v108, v108, v104, -v27
    v_fma_f32 v109, v109, v105, -v27
    v_fma_f32 v110, v110, v106, -v27
    v_fma_f32 v111, v111, v107, -v27
    v_exp_f32 v108, v108
    v_exp_f32 v109, v109
    v_exp_f32 v110, v110
    v_exp_f32 v111, v111
    v_mul_f32 v104, v104, v108
    v_mul_f32 v105, v105, v109
    v_mul_f32 v106, v106, v110
    v_mul_f32 v107, v107, v111
    v_add_f32 v108, v108, v109
    v_add_f32 v110, v110, v111
    v_add_f32 v108, v108, v110
    v_add_f32 v30, v30, v108
    v_cvt_pk_bf16_f32 v110, v104, v105
    v_cvt_pk_bf16_f32 v111, v106, v107
    v_add_f32 v104, v104, v105
    v_add_f32 v106, v106, v107
    ds_write_b64 v17, v[110:111]
    v_add_f32 v33, v104, v106
    ds_read_b128 v[104:107], v21 offset:192
    ds_read_b128 v[108:111], v21 offset:448
    s_waitcnt lgkmcnt(7)
    v_mfma_f32_16x16x32_bf16 v[76:79], v[112:115], v[192:195], 0
    ds_read_b128 v[136:139], v10 offset:37120
    v_mfma_f32_16x16x32_bf16 v[76:79], v[116:119], v[196:199], v[76:79]
    ds_read_b128 v[140:143], v11 offset:37120
    s_waitcnt lgkmcnt(7)
    v_mfma_f32_16x16x32_bf16 v[76:79], v[120:123], v[200:203], v[76:79]
    ds_read_b128 v[112:115], v8 offset:37376
    v_mfma_f32_16x16x32_bf16 v[76:79], v[124:127], v[204:207], v[76:79]
    ds_read_b128 v[116:119], v9 offset:37376
    s_waitcnt lgkmcnt(7)
    v_mfma_f32_16x16x32_bf16 v[76:79], v[128:131], v[208:211], v[76:79]
    ds_read_b128 v[120:123], v10 offset:37376
    v_mfma_f32_16x16x32_bf16 v[76:79], v[132:135], v[212:215], v[76:79]
    ds_read_b128 v[124:127], v11 offset:37376
    s_waitcnt lgkmcnt(4)
    v_mfma_f32_16x16x32_bf16 v[76:79], v[136:139], v[216:219], v[76:79]
    v_mfma_f32_16x16x32_bf16 v[76:79], v[140:143], v[220:223], v[76:79]
    v_add_u32 v8, 0xfffe4000, v8
    s_waitcnt lgkmcnt(3)
    v_mfma_f32_16x16x32_bf16 v[76:79], v[112:115], v[224:227], v[76:79]
    v_add_u32 v9, 0xfffe4000, v9
    s_waitcnt lgkmcnt(2)
    v_mfma_f32_16x16x32_bf16 v[76:79], v[116:119], v[228:231], v[76:79]
    v_add_u32 v10, 0xfffe4000, v10
    s_waitcnt lgkmcnt(1)
    v_mfma_f32_16x16x32_bf16 v[76:79], v[120:123], v[232:235], v[76:79]
    v_add_u32 v11, 0xfffe4000, v11
    s_waitcnt lgkmcnt(0)
    v_mfma_f32_16x16x32_bf16 v[76:79], v[124:127], v[236:239], v[76:79]
    v_fma_f32 v100, -v100, v29, v58
    v_fma_f32 v101, -v101, v29, v58
    v_fma_f32 v102, -v102, v29, v58
    v_fma_f32 v103, -v103, v29, v58
    v_add_f32 v100, v100, v72
    v_add_f32 v101, v101, v73
    v_add_f32 v102, v102, v74
    v_add_f32 v103, v103, v75
    v_fma_f32 v100, v100, v96, -v27
    v_fma_f32 v101, v101, v97, -v27
    v_fma_f32 v102, v102, v98, -v27
    v_fma_f32 v103, v103, v99, -v27
    v_exp_f32 v100, v100
    v_exp_f32 v101, v101
    v_exp_f32 v102, v102
    v_exp_f32 v103, v103
    v_mul_f32 v96, v96, v100
    v_mul_f32 v97, v97, v101
    v_mul_f32 v98, v98, v102
    v_mul_f32 v99, v99, v103
    v_add_f32 v100, v100, v101
    v_add_f32 v102, v102, v103
    v_add_f32 v100, v100, v102
    v_add_f32 v30, v30, v100
    v_cvt_pk_bf16_f32 v102, v96, v97
    v_cvt_pk_bf16_f32 v103, v98, v99
    v_add_f32 v96, v96, v97
    v_add_f32 v98, v98, v99
    ds_write_b64 v18, v[102:103]
    v_add_f32 v34, v96, v98
    v_fma_f32 v108, -v108, v29, v62
    v_fma_f32 v109, -v109, v29, v62
    v_fma_f32 v110, -v110, v29, v62
    v_fma_f32 v111, -v111, v29, v62
    v_add_f32 v108, v108, v76
    v_add_f32 v109, v109, v77
    v_add_f32 v110, v110, v78
    v_add_f32 v111, v111, v79
    v_fma_f32 v108, v108, v104, -v27
    v_fma_f32 v109, v109, v105, -v27
    v_fma_f32 v110, v110, v106, -v27
    v_fma_f32 v111, v111, v107, -v27
    v_exp_f32 v108, v108
    v_exp_f32 v109, v109
    v_exp_f32 v110, v110
    v_exp_f32 v111, v111
    v_mul_f32 v104, v104, v108
    v_mul_f32 v105, v105, v109
    v_mul_f32 v106, v106, v110
    v_mul_f32 v107, v107, v111
    v_add_f32 v108, v108, v109
    v_add_f32 v110, v110, v111
    v_add_f32 v108, v108, v110
    v_add_f32 v30, v30, v108
    v_cvt_pk_bf16_f32 v110, v104, v105
    v_cvt_pk_bf16_f32 v111, v106, v107
    v_add_f32 v104, v104, v105
    v_add_f32 v106, v106, v107
    ds_write_b64 v19, v[110:111]
    v_add_f32 v35, v104, v106
    v_cmp_nge_f32 vcc, s91, v30
    v_cvt_pk_bf16_f32 v32, v32, v33
    v_cvt_pk_bf16_f32 v33, v34, v35
    ds_write_b64 v20, v[32:33]
    s_cbranch_vccnz L_rare_18
L_back_19:
    v_add_f32 v28, v28, v30
    s_waitcnt lgkmcnt(0)
    s_barrier
    ds_read_b128 v[112:115], v12
    ds_read_b128 v[116:119], v13
    ds_read_b128 v[120:123], v14
    ds_read_b128 v[124:127], v15
    ds_read_b128 v[128:131], v12 offset:256
    ds_read_b128 v[132:135], v13 offset:256
    s_waitcnt lgkmcnt(4)
    v_mfma_f32_16x16x32_bf16 v[80:83], v[112:115], v[112:115], 0
    ds_read_b128 v[136:139], v14 offset:256
    v_mfma_f32_16x16x32_bf16 v[84:87], v[144:147], v[112:115], 0
    v_mfma_f32_16x16x32_bf16 v[80:83], v[116:119], v[116:119], v[80:83]
    ds_read_b128 v[140:143], v15 offset:256
    v_mfma_f32_16x16x32_bf16 v[84:87], v[148:151], v[116:119], v[84:87]
    s_waitcnt lgkmcnt(4)
    v_mfma_f32_16x16x32_bf16 v[80:83], v[120:123], v[120:123], v[80:83]
    ds_read_b128 v[112:115], v12 offset:512
    v_mfma_f32_16x16x32_bf16 v[84:87], v[152:155], v[120:123], v[84:87]
    v_mfma_f32_16x16x32_bf16 v[80:83], v[124:127], v[124:127], v[80:83]
    ds_read_b128 v[116:119], v13 offset:512
    v_mfma_f32_16x16x32_bf16 v[84:87], v[156:159], v[124:127], v[84:87]
    s_waitcnt lgkmcnt(4)
    v_mfma_f32_16x16x32_bf16 v[80:83], v[128:131], v[128:131], v[80:83]
    ds_read_b128 v[120:123], v14 offset:512
    v_mfma_f32_16x16x32_bf16 v[84:87], v[160:163], v[128:131], v[84:87]
    v_mfma_f32_16x16x32_bf16 v[80:83], v[132:135], v[132:135], v[80:83]
    ds_read_b128 v[124:127], v15 offset:512
    v_mfma_f32_16x16x32_bf16 v[84:87], v[164:167], v[132:135], v[84:87]
    s_waitcnt lgkmcnt(4)
    v_mfma_f32_16x16x32_bf16 v[80:83], v[136:139], v[136:139], v[80:83]
    ds_read_b128 v[128:131], v8
    v_mfma_f32_16x16x32_bf16 v[84:87], v[168:171], v[136:139], v[84:87]
    v_mfma_f32_16x16x32_bf16 v[80:83], v[140:143], v[140:143], v[80:83]
    ds_read_b128 v[132:135], v9
    v_mfma_f32_16x16x32_bf16 v[84:87], v[172:175], v[140:143], v[84:87]
    s_waitcnt lgkmcnt(4)
    v_mfma_f32_16x16x32_bf16 v[80:83], v[112:115], v[112:115], v[80:83]
    ds_read_b128 v[136:139], v10
    v_mfma_f32_16x16x32_bf16 v[84:87], v[176:179], v[112:115], v[84:87]
    v_mfma_f32_16x16x32_bf16 v[80:83], v[116:119], v[116:119], v[80:83]
    ds_read_b128 v[140:143], v11
    v_mfma_f32_16x16x32_bf16 v[84:87], v[180:183], v[116:119], v[84:87]
    s_waitcnt lgkmcnt(4)
    v_mfma_f32_16x16x32_bf16 v[80:83], v[120:123], v[120:123], v[80:83]
    ds_read_b128 v[112:115], v8 offset:256
    v_mfma_f32_16x16x32_bf16 v[84:87], v[184:187], v[120:123], v[84:87]
    v_mfma_f32_16x16x32_bf16 v[80:83], v[124:127], v[124:127], v[80:83]
    ds_read_b128 v[116:119], v9 offset:256
    v_mfma_f32_16x16x32_bf16 v[84:87], v[188:191], v[124:127], v[84:87]
    s_waitcnt lgkmcnt(4)
    v_mfma_f32_16x16x32_bf16 v[64:67], v[128:131], v[192:195], 0
    ds_read_b128 v[120:123], v10 offset:256
    v_mfma_f32_16x16x32_bf16 v[64:67], v[132:135], v[196:199], v[64:67]
    ds_read_b128 v[124:127], v11 offset:256
    s_waitcnt lgkmcnt(4)
    v_mfma_f32_16x16x32_bf16 v[64:67], v[136:139], v[200:203], v[64:67]
    ds_read_b128 v[128:131], v8 offset:512
    v_mfma_f32_16x16x32_bf16 v[64:67], v[140:143], v[204:207], v[64:67]
    ds_read_b128 v[132:135], v9 offset:512
    v_cndmask_b32 v24, v80, v81, s[92:93]
    v_cndmask_b32 v25, v82, v83, s[96:97]
    v_add_f32 v31, v84, v47
    v_cndmask_b32 v24, v24, v25, s[94:95]
    v_mul_f32 v31, s89, v31
    v_fma_f32 v24, v87, 2.0, v24
    v_add_f32 v24, v24, v43
    v_mul_f32 v25, v31, v31
    v_fma_f32 v24, v24, s89, -v25
    v_max_f32 v24, 0, v24
    v_add_f32 v24, s90, v24
    v_rsq_f32 v24, v24
    ds_write_b32 v22, v31 offset:256
    ds_write_b32 v22, v24
    s_waitcnt lgkmcnt(6)
    v_mfma_f32_16x16x32_bf16 v[64:67], v[112:115], v[208:211], v[64:67]
    ds_read_b128 v[136:139], v10 offset:512
    v_mfma_f32_16x16x32_bf16 v[64:67], v[116:119], v[212:215], v[64:67]
    ds_read_b128 v[140:143], v11 offset:512
    s_waitcnt lgkmcnt(6)
    v_mfma_f32_16x16x32_bf16 v[64:67], v[120:123], v[216:219], v[64:67]
    ds_read_b128 v[112:115], v8 offset:12288
    v_mfma_f32_16x16x32_bf16 v[64:67], v[124:127], v[220:223], v[64:67]
    ds_read_b128 v[116:119], v9 offset:12288
    s_waitcnt lgkmcnt(6)
    v_mfma_f32_16x16x32_bf16 v[64:67], v[128:131], v[224:227], v[64:67]
    ds_read_b128 v[120:123], v10 offset:12288
    v_mfma_f32_16x16x32_bf16 v[64:67], v[132:135], v[228:231], v[64:67]
    ds_read_b128 v[124:127], v11 offset:12288
    s_waitcnt lgkmcnt(4)
    v_mfma_f32_16x16x32_bf16 v[64:67], v[136:139], v[232:235], v[64:67]
    ds_read_b128 v[128:131], v8 offset:12544
    v_mfma_f32_16x16x32_bf16 v[64:67], v[140:143], v[236:239], v[64:67]
    ds_read_b128 v[132:135], v9 offset:12544
    s_barrier
    ds_read_b128 v[96:99], v21
    ds_read_b128 v[100:103], v21 offset:256
    ds_read_b128 v[104:107], v21 offset:64
    ds_read_b128 v[108:111], v21 offset:320
    s_waitcnt lgkmcnt(8)
    v_mfma_f32_16x16x32_bf16 v[68:71], v[112:115], v[192:195], 0
    ds_read_b128 v[136:139], v10 offset:12544
    v_mfma_f32_16x16x32_bf16 v[68:71], v[116:119], v[196:199], v[68:71]
    ds_read_b128 v[140:143], v11 offset:12544
    s_waitcnt lgkmcnt(8)
    v_mfma_f32_16x16x32_bf16 v[68:71], v[120:123], v[200:203], v[68:71]
    ds_read_b128 v[112:115], v8 offset:12800
    v_mfma_f32_16x16x32_bf16 v[68:71], v[124:127], v[204:207], v[68:71]
    ds_read_b128 v[116:119], v9 offset:12800
    s_waitcnt lgkmcnt(8)
    v_mfma_f32_16x16x32_bf16 v[68:71], v[128:131], v[208:211], v[68:71]
    ds_read_b128 v[120:123], v10 offset:12800
    v_mfma_f32_16x16x32_bf16 v[68:71], v[132:135], v[212:215], v[68:71]
    ds_read_b128 v[124:127], v11 offset:12800
    s_waitcnt lgkmcnt(4)
    v_mfma_f32_16x16x32_bf16 v[68:71], v[136:139], v[216:219], v[68:71]
    ds_read_b128 v[128:131], v8 offset:24576
    v_mfma_f32_16x16x32_bf16 v[68:71], v[140:143], v[220:223], v[68:71]
    ds_read_b128 v[132:135], v9 offset:24576
    s_waitcnt lgkmcnt(4)
    v_mfma_f32_16x16x32_bf16 v[68:71], v[112:115], v[224:227], v[68:71]
    ds_read_b128 v[136:139], v10 offset:24576
    v_mfma_f32_16x16x32_bf16 v[68:71], v[116:119], v[228:231], v[68:71]
    ds_read_b128 v[140:143], v11 offset:24576
    s_waitcnt lgkmcnt(4)
    v_mfma_f32_16x16x32_bf16 v[68:71], v[120:123], v[232:235], v[68:71]
    ds_read_b128 v[112:115], v8 offset:24832
    v_mfma_f32_16x16x32_bf16 v[68:71], v[124:127], v[236:239], v[68:71]
    ds_read_b128 v[116:119], v9 offset:24832
    v_fma_f32 v100, -v100, v29, v51
    v_fma_f32 v101, -v101, v29, v51
    v_fma_f32 v102, -v102, v29, v51
    v_fma_f32 v103, -v103, v29, v51
    v_add_f32 v100, v100, v64
    s_add_u32 s42, s58, 0x1000
    buffer_load_dwordx4 v[144:147], v23, s[20:23], s42 offen offset:2048
    v_add_f32 v101, v101, v65
    v_add_f32 v102, v102, v66
    v_add_f32 v103, v103, v67
    v_fma_f32 v100, v100, v96, -v27
    v_fma_f32 v101, v101, v97, -v27
    buffer_load_dwordx4 v[148:151], v23, s[20:23], s42 offen offset:3072
    v_fma_f32 v102, v102, v98, -v27
    v_fma_f32 v103, v103, v99, -v27
    v_exp_f32 v100, v100
    v_exp_f32 v101, v101
    v_exp_f32 v102, v102
    s_add_u32 s42, s58, 0x2000
    buffer_load_dwordx4 v[152:155], v23, s[20:23], s42 offen
    v_exp_f32 v103, v103
    v_mul_f32 v96, v96, v100
    v_mul_f32 v97, v97, v101
    v_mul_f32 v98, v98, v102
    v_mul_f32 v99, v99, v103
    buffer_load_dwordx4 v[156:159], v23, s[20:23], s42 offen offset:1024
    v_add_f32 v100, v100, v101
    v_add_f32 v102, v102, v103
    v_add_f32 v30, v100, v102
    v_cvt_pk_bf16_f32 v102, v96, v97
    v_cvt_pk_bf16_f32 v103, v98, v99
    buffer_load_dwordx4 v[160:163], v23, s[20:23], s42 offen offset:2048
    v_add_f32 v96, v96, v97
    v_add_f32 v98, v98, v99
    ds_write_b64 v16, v[102:103]
    v_add_f32 v32, v96, v98
    ds_read_b128 v[96:99], v21 offset:128
    buffer_load_dwordx4 v[164:167], v23, s[20:23], s42 offen offset:3072
    ds_read_b128 v[100:103], v21 offset:384
    s_waitcnt lgkmcnt(7)
    v_mfma_f32_16x16x32_bf16 v[72:75], v[128:131], v[192:195], 0
    ds_read_b128 v[120:123], v10 offset:24832
    v_mfma_f32_16x16x32_bf16 v[72:75], v[132:135], v[196:199], v[72:75]
    ds_read_b128 v[124:127], v11 offset:24832
    s_waitcnt lgkmcnt(7)
    v_mfma_f32_16x16x32_bf16 v[72:75], v[136:139], v[200:203], v[72:75]
    ds_read_b128 v[128:131], v8 offset:25088
    v_mfma_f32_16x16x32_bf16 v[72:75], v[140:143], v[204:207], v[72:75]
    ds_read_b128 v[132:135], v9 offset:25088
    s_waitcnt lgkmcnt(7)
    v_mfma_f32_16x16x32_bf16 v[72:75], v[112:115], v[208:211], v[72:75]
    ds_read_b128 v[136:139], v10 offset:25088
    v_mfma_f32_16x16x32_bf16 v[72:75], v[116:119], v[212:215], v[72:75]
    ds_read_b128 v[140:143], v11 offset:25088
    s_waitcnt lgkmcnt(4)
    v_mfma_f32_16x16x32_bf16 v[72:75], v[120:123], v[216:219], v[72:75]
    ds_read_b128 v[112:115], v8 offset:36864
    v_mfma_f32_16x16x32_bf16 v[72:75], v[124:127], v[220:223], v[72:75]
    ds_read_b128 v[116:119], v9 offset:36864
    s_waitcnt lgkmcnt(4)
    v_mfma_f32_16x16x32_bf16 v[72:75], v[128:131], v[224:227], v[72:75]
    ds_read_b128 v[120:123], v10 offset:36864
    v_mfma_f32_16x16x32_bf16 v[72:75], v[132:135], v[228:231], v[72:75]
    ds_read_b128 v[124:127], v11 offset:36864
    s_waitcnt lgkmcnt(4)
    v_mfma_f32_16x16x32_bf16 v[72:75], v[136:139], v[232:235], v[72:75]
    ds_read_b128 v[128:131], v8 offset:37120
    v_mfma_f32_16x16x32_bf16 v[72:75], v[140:143], v[236:239], v[72:75]
    ds_read_b128 v[132:135], v9 offset:37120
    v_fma_f32 v108, -v108, v29, v55
    v_fma_f32 v109, -v109, v29, v55
    v_fma_f32 v110, -v110, v29, v55
    v_fma_f32 v111, -v111, v29, v55
    v_add_f32 v108, v108, v68
    s_add_u32 s42, s58, 0x3000
    buffer_load_dwordx4 v[168:171], v23, s[20:23], s42 offen
    v_add_f32 v109, v109, v69
    v_add_f32 v110, v110, v70
    v_add_f32 v111, v111, v71
    v_fma_f32 v108, v108, v104, -v27
    v_fma_f32 v109, v109, v105, -v27
    buffer_load_dwordx4 v[172:175], v23, s[20:23], s42 offen offset:1024
    v_fma_f32 v110, v110, v106, -v27
    v_fma_f32 v111, v111, v107, -v27
    v_exp_f32 v108, v108
    v_exp_f32 v109, v109
    v_exp_f32 v110, v110
    buffer_load_dwordx4 v[176:179], v23, s[20:23], s42 offen offset:2048
    v_exp_f32 v111, v111
    v_mul_f32 v104, v104, v108
    v_mul_f32 v105, v105, v109
    v_mul_f32 v106, v106, v110
    v_mul_f32 v107, v107, v111
    buffer_load_dwordx4 v[180:183], v23, s[20:23], s42 offen offset:3072
    v_add_f32 v108, v108, v109
    v_add_f32 v110, v110, v111
    v_add_f32 v108, v108, v110
    v_add_f32 v30, v30, v108
    v_cvt_pk_bf16_f32 v110, v104, v105
    s_add_u32 s42, s58, 0x4000
    buffer_load_dwordx4 v[184:187], v23, s[20:23], s42 offen
    v_cvt_pk_bf16_f32 v111, v106, v107
    v_add_f32 v104, v104, v105
    v_add_f32 v106, v106, v107
    ds_write_b64 v17, v[110:111]
    v_add_f32 v33, v104, v106
    buffer_load_dwordx4 v[188:191], v23, s[20:23], s42 offen offset:1024
    ds_read_b128 v[104:107], v21 offset:192
    ds_read_b128 v[108:111], v21 offset:448
    s_waitcnt lgkmcnt(7)
    v_mfma_f32_16x16x32_bf16 v[76:79], v[112:115], v[192:195], 0
    ds_read_b128 v[136:139], v10 offset:37120
    v_mfma_f32_16x16x32_bf16 v[76:79], v[116:119], v[196:199], v[76:79]
    ds_read_b128 v[140:143], v11 offset:37120
    s_waitcnt lgkmcnt(7)
    v_mfma_f32_16x16x32_bf16 v[76:79], v[120:123], v[200:203], v[76:79]
    ds_read_b128 v[112:115], v8 offset:37376
    v_mfma_f32_16x16x32_bf16 v[76:79], v[124:127], v[204:207], v[76:79]
    ds_read_b128 v[116:119], v9 offset:37376
    s_waitcnt lgkmcnt(7)
    v_mfma_f32_16x16x32_bf16 v[76:79], v[128:131], v[208:211], v[76:79]
    ds_read_b128 v[120:123], v10 offset:37376
    v_mfma_f32_16x16x32_bf16 v[76:79], v[132:135], v[212:215], v[76:79]
    ds_read_b128 v[124:127], v11 offset:37376
    s_waitcnt lgkmcnt(4)
    v_mfma_f32_16x16x32_bf16 v[76:79], v[136:139], v[216:219], v[76:79]
    v_mfma_f32_16x16x32_bf16 v[76:79], v[140:143], v[220:223], v[76:79]
    s_waitcnt lgkmcnt(3)
    v_mfma_f32_16x16x32_bf16 v[76:79], v[112:115], v[224:227], v[76:79]
    s_waitcnt lgkmcnt(2)
    v_mfma_f32_16x16x32_bf16 v[76:79], v[116:119], v[228:231], v[76:79]
    s_waitcnt lgkmcnt(1)
    v_mfma_f32_16x16x32_bf16 v[76:79], v[120:123], v[232:235], v[76:79]
    s_waitcnt lgkmcnt(0)
    v_mfma_f32_16x16x32_bf16 v[76:79], v[124:127], v[236:239], v[76:79]
    v_fma_f32 v100, -v100, v29, v59
    v_fma_f32 v101, -v101, v29, v59
    v_fma_f32 v102, -v102, v29, v59
    v_fma_f32 v103, -v103, v29, v59
    v_add_f32 v100, v100, v72
    v_add_f32 v101, v101, v73
    v_add_f32 v102, v102, v74
    v_add_f32 v103, v103, v75
    v_fma_f32 v100, v100, v96, -v27
    v_fma_f32 v101, v101, v97, -v27
    v_fma_f32 v102, v102, v98, -v27
    v_fma_f32 v103, v103, v99, -v27
    v_exp_f32 v100, v100
    v_exp_f32 v101, v101
    v_exp_f32 v102, v102
    v_exp_f32 v103, v103
    v_mul_f32 v96, v96, v100
    v_mul_f32 v97, v97, v101
    v_mul_f32 v98, v98, v102
    v_mul_f32 v99, v99, v103
    v_add_f32 v100, v100, v101
    v_add_f32 v102, v102, v103
    v_add_f32 v100, v100, v102
    v_add_f32 v30, v30, v100
    v_cvt_pk_bf16_f32 v102, v96, v97
    v_cvt_pk_bf16_f32 v103, v98, v99
    v_add_f32 v96, v96, v97
    v_add_f32 v98, v98, v99
    ds_write_b64 v18, v[102:103]
    v_add_f32 v34, v96, v98
    v_fma_f32 v108, -v108, v29, v63
    v_fma_f32 v109, -v109, v29, v63
    v_fma_f32 v110, -v110, v29, v63
    v_fma_f32 v111, -v111, v29, v63
    v_add_f32 v108, v108, v76
    v_add_f32 v109, v109, v77
    v_add_f32 v110, v110, v78
    v_add_f32 v111, v111, v79
    v_fma_f32 v108, v108, v104, -v27
    v_fma_f32 v109, v109, v105, -v27
    v_fma_f32 v110, v110, v106, -v27
    v_fma_f32 v111, v111, v107, -v27
    v_exp_f32 v108, v108
    v_exp_f32 v109, v109
    v_exp_f32 v110, v110
    v_exp_f32 v111, v111
    v_mul_f32 v104, v104, v108
    v_mul_f32 v105, v105, v109
    v_mul_f32 v106, v106, v110
    v_mul_f32 v107, v107, v111
    v_add_f32 v108, v108, v109
    v_add_f32 v110, v110, v111
    v_add_f32 v108, v108, v110
    v_add_f32 v30, v30, v108
    v_cvt_pk_bf16_f32 v110, v104, v105
    v_cvt_pk_bf16_f32 v111, v106, v107
    v_add_f32 v104, v104, v105
    v_add_f32 v106, v106, v107
    ds_write_b64 v19, v[110:111]
    v_add_f32 v35, v104, v106
    v_cmp_nge_f32 vcc, s91, v30
    v_cvt_pk_bf16_f32 v32, v32, v33
    v_cvt_pk_bf16_f32 v33, v34, v35
    ds_write_b64 v20, v[32:33]
    s_cbranch_vccnz L_rare_20
L_back_21:
    v_add_f32 v28, v28, v30
    s_waitcnt lgkmcnt(0)
    s_barrier
    s_setprio 1
    s_add_u32 s42, s58, 0x7000
    buffer_load_dwordx4 v[192:195], v23, s[20:23], s42 offen offset:2048
    buffer_load_dwordx4 v[196:199], v23, s[20:23], s42 offen offset:3072
    v_mov_b32 v26, v28
    s_nop 1
    v_permlane16_swap_b32 v26, v28
    v_add_f32 v28, v28, v26
    v_mov_b32 v26, v28
    s_nop 1
    v_permlane32_swap_b32 v26, v28
    v_add_f32 v28, v28, v26
    s_add_u32 s42, s58, 0x8000
    buffer_load_dwordx4 v[200:203], v23, s[20:23], s42 offen
    v_and_b32 v24, 15, v1
    v_lshlrev_b32 v24, 2, v24
    s_lshl_b32 s4, s3, 6
    v_add_u32 v24, s4, v24
    ds_write_b32 v24, v27 offset:59392
    ds_write_b32 v24, v28 offset:59648
    v_lshrrev_b32 v16, 4, v1
    v_lshlrev_b32 v24, 4, v16
    buffer_load_dwordx4 v[204:207], v23, s[20:23], s42 offen offset:1024
    v_add_u32 v24, s4, v24
    s_waitcnt lgkmcnt(0)
    ds_read_b128 v[48:51], v24 offset:59392
    ds_read_b128 v[52:55], v24 offset:59648
    v_mov_b32 v2, s45
    v_lshlrev_b32 v25, 16, v2
    v_and_b32 v2, 0xffff0000, v2
    s_mov_b32 s50, 0xaaaaaaaa
    buffer_load_dwordx4 v[208:211], v23, s[20:23], s42 offen offset:2048
    s_mov_b32 s51, 0xaaaaaaaa
    v_cndmask_b32 v2, v25, v2, s[50:51]
    s_waitcnt lgkmcnt(0)
    v_cndmask_b32 v72, v48, v52, s[94:95]
    v_lshrrev_b32 v25, 16, v72
    v_and_b32 v72, 0xffff, v72
    v_cndmask_b32 v72, v25, v72, s[50:51]
    v_or_b32 v72, v72, v2
    v_cndmask_b32 v73, v49, v53, s[94:95]
    buffer_load_dwordx4 v[212:215], v23, s[20:23], s42 offen offset:3072
    v_lshrrev_b32 v25, 16, v73
    v_and_b32 v73, 0xffff, v73
    v_cndmask_b32 v73, v25, v73, s[50:51]
    v_or_b32 v73, v73, v2
    v_cndmask_b32 v74, v50, v54, s[94:95]
    v_lshrrev_b32 v25, 16, v74
    v_and_b32 v74, 0xffff, v74
    v_cndmask_b32 v74, v25, v74, s[50:51]
    s_add_u32 s42, s58, 0x9000
    buffer_load_dwordx4 v[216:219], v23, s[20:23], s42 offen
    v_or_b32 v74, v74, v2
    v_cndmask_b32 v75, v51, v55, s[94:95]
    v_lshrrev_b32 v25, 16, v75
    v_and_b32 v75, 0xffff, v75
    v_cndmask_b32 v75, v25, v75, s[50:51]
    v_or_b32 v75, v75, v2
    v_and_b32 v24, 15, v1
    v_lshrrev_b32 v25, 2, v24
    v_lshrrev_b32 v26, 3, v24
    v_xor_b32 v26, v25, v26
    v_and_b32 v26, 1, v26
    v_lshlrev_b32 v26, 3, v26
    v_and_b32 v25, 1, v25
    v_or_b32 v26, v26, v25
    v_and_b32 v25, 1, v24
    v_lshl_or_b32 v26, v25, 2, v26
    v_and_b32 v25, 2, v24
    v_or_b32 v26, v26, v25
    v_lshrrev_b32 v25, 4, v1
    v_xor_b32 v26, v26, v25
    v_lshlrev_b32 v26, 4, v26
    v_mul_u32_u24 v24, 0x300, v24
    v_add_u32 v24, 0x1c000, v24
    v_xor_b32 v25, 0, v26
    v_add_u32 v18, v24, v25
    v_xor_b32 v25, 64, v26
    v_add_u32 v19, v24, v25
    v_xor_b32 v25, 0x80, v26
    v_add_u32 v20, v24, v25
    v_xor_b32 v25, 0xc0, v26
    v_add_u32 v21, v24, v25
    v_add_u32 v18, s101, v18
    buffer_load_dwordx4 v[220:223], v23, s[20:23], s42 offen offset:1024
    v_add_u32 v19, s101, v19
    v_add_u32 v20, s101, v20
    v_add_u32 v21, s101, v21
    v_add_u32 v22, s101, v23
    v_add_u32 v22, 0x10000, v22
    v_and_b32 v17, 15, v1
    v_lshlrev_b32 v17, 4, v17
    v_lshl_add_u32 v4, v16, 10, v17
    buffer_load_dwordx4 v[224:227], v23, s[20:23], s42 offen offset:2048
    s_lshl_b32 s41, s2, 14
    s_lshl_b32 s4, s3, 12
    s_add_u32 s41, s41, s4
    s_add_u32 s41, s41, 0x100000
    v_lshlrev_b32 v24, 1, v17
    s_lshl_b32 s4, s3, 9
    s_add_u32 s4, s4, 0x78000
    buffer_load_dwordx4 v[12:15], v24, s[20:23], s4 offen
    buffer_load_dwordx4 v[228:231], v23, s[20:23], s42 offen offset:3072
    buffer_load_dwordx2 v[16:17], v24, s[20:23], s4 offen offset:16
    v_mov_b32 v28, 0x3f803f80
    v_mov_b32 v29, 0x3f803f80
    v_mov_b32 v30, 0x3f803f80
    v_mov_b32 v31, 0x3f803f80
    s_add_u32 s42, s58, 0xa000
    buffer_load_dwordx4 v[232:235], v23, s[20:23], s42 offen
    buffer_load_dwordx4 v[236:239], v23, s[20:23], s42 offen offset:1024
    buffer_load_dwordx4 v[112:115], v23, s[20:23], s42 offen offset:2048
    buffer_load_dwordx4 v[116:119], v23, s[20:23], s42 offen offset:3072
    s_add_u32 s42, s58, 0xb000
    buffer_load_dwordx4 v[120:123], v23, s[20:23], s42 offen
    buffer_load_dwordx4 v[124:127], v23, s[20:23], s42 offen offset:1024
    buffer_load_dwordx4 v[128:131], v23, s[20:23], s42 offen offset:2048
    buffer_load_dwordx4 v[132:135], v23, s[20:23], s42 offen offset:3072
    s_add_u32 s42, s58, 0xc000
    buffer_load_dwordx4 v[136:139], v23, s[20:23], s42 offen
    buffer_load_dwordx4 v[140:143], v23, s[20:23], s42 offen offset:1024
    buffer_load_dwordx4 v[96:99], v23, s[20:23], s42 offen offset:2048
    buffer_load_dwordx4 v[100:103], v23, s[20:23], s42 offen offset:3072
    s_add_u32 s42, s58, 0xd000
    buffer_load_dwordx4 v[104:107], v23, s[20:23], s42 offen
    buffer_load_dwordx4 v[108:111], v23, s[20:23], s42 offen offset:1024
    s_barrier
    ds_read_b128 v[32:35], v18
    ds_read_b128 v[36:39], v19
    s_waitcnt vmcnt(38)
    ds_read_b128 v[40:43], v20
    s_waitcnt lgkmcnt(2)
    v_mfma_f32_16x16x32_bf16 v[48:51], v[32:35], v[240:243], 0
    v_mfma_f32_16x16x32_bf16 v[8:11], v[32:35], v[28:31], 0
    ds_read_b128 v[44:47], v21
    s_add_u32 s42, s58, 0xd000
    v_mfma_f32_16x16x32_bf16 v[52:55], v[32:35], v[244:247], 0
    buffer_load_dwordx4 v[240:243], v23, s[20:23], s42 offen offset:2048
    v_mfma_f32_16x16x32_bf16 v[56:59], v[32:35], v[248:251], 0
    v_mfma_f32_16x16x32_bf16 v[60:63], v[32:35], v[252:255], 0
    v_mfma_f32_16x16x32_bf16 v[64:67], v[32:35], v[88:91], 0
    buffer_load_dwordx4 v[244:247], v23, s[20:23], s42 offen offset:3072
    v_mfma_f32_16x16x32_bf16 v[68:71], v[32:35], v[92:95], 0
    s_waitcnt vmcnt(39) lgkmcnt(2)
    v_mfma_f32_16x16x32_bf16 v[48:51], v[36:39], v[144:147], v[48:51]
    v_mfma_f32_16x16x32_bf16 v[8:11], v[36:39], v[28:31], v[8:11]
    ds_read_b128 v[32:35], v18 offset:256
    s_add_u32 s42, s58, 0xe000
    s_waitcnt vmcnt(38)
    v_mfma_f32_16x16x32_bf16 v[52:55], v[36:39], v[148:151], v[52:55]
    buffer_load_dwordx4 v[248:251], v23, s[20:23], s42 offen
    s_waitcnt vmcnt(38)
    v_mfma_f32_16x16x32_bf16 v[56:59], v[36:39], v[152:155], v[56:59]
    s_waitcnt vmcnt(37)
    v_mfma_f32_16x16x32_bf16 v[60:63], v[36:39], v[156:159], v[60:63]
    s_waitcnt vmcnt(36)
    v_mfma_f32_16x16x32_bf16 v[64:67], v[36:39], v[160:163], v[64:67]
    buffer_load_dwordx4 v[252:255], v23, s[20:23], s42 offen offset:1024
    s_waitcnt vmcnt(36)
    v_mfma_f32_16x16x32_bf16 v[68:71], v[36:39], v[164:167], v[68:71]
    s_waitcnt vmcnt(35) lgkmcnt(2)
    v_mfma_f32_16x16x32_bf16 v[48:51], v[40:43], v[168:171], v[48:51]
    v_mfma_f32_16x16x32_bf16 v[8:11], v[40:43], v[28:31], v[8:11]
    ds_read_b128 v[36:39], v19 offset:256
    ds_read_b128 v[76:79], v22
    s_waitcnt vmcnt(34)
    v_mfma_f32_16x16x32_bf16 v[52:55], v[40:43], v[172:175], v[52:55]
    ds_read_b128 v[80:83], v22 offset:1024
    buffer_load_dwordx4 v[88:91], v23, s[20:23], s42 offen offset:2048
    s_waitcnt vmcnt(34)
    v_mfma_f32_16x16x32_bf16 v[56:59], v[40:43], v[176:179], v[56:59]
    ds_read_b128 v[84:87], v22 offset:2048
    s_waitcnt vmcnt(33)
    v_mfma_f32_16x16x32_bf16 v[60:63], v[40:43], v[180:183], v[60:63]
    s_waitcnt vmcnt(32)
    v_mfma_f32_16x16x32_bf16 v[64:67], v[40:43], v[184:187], v[64:67]
    buffer_load_dwordx4 v[92:95], v23, s[20:23], s42 offen offset:3072
    s_waitcnt vmcnt(32)
    v_mfma_f32_16x16x32_bf16 v[68:71], v[40:43], v[188:191], v[68:71]
    s_waitcnt lgkmcnt(2)
    v_mfma_f32_16x16x32_bf16 v[48:51], v[44:47], v[76:79], v[48:51]
    v_mfma_f32_16x16x32_bf16 v[8:11], v[44:47], v[28:31], v[8:11]
    ds_read_b128 v[40:43], v20 offset:256
    ds_read_b128 v[76:79], v22 offset:3072
    s_add_u32 s42, s58, 0xf000
    s_waitcnt lgkmcnt(3)
    v_mfma_f32_16x16x32_bf16 v[52:55], v[44:47], v[80:83], v[52:55]
    ds_read_b128 v[80:83], v22 offset:4096
    buffer_load_dwordx4 v[144:147], v23, s[20:23], s42 offen
    s_waitcnt lgkmcnt(3)
    v_mfma_f32_16x16x32_bf16 v[56:59], v[44:47], v[84:87], v[56:59]
    ds_read_b128 v[84:87], v22 offset:5120
    s_barrier
    s_waitcnt lgkmcnt(2)
    v_mfma_f32_16x16x32_bf16 v[60:63], v[44:47], v[76:79], v[60:63]
    ds_read_b128 v[76:79], v22 offset:6144
    s_waitcnt lgkmcnt(2)
    v_mfma_f32_16x16x32_bf16 v[64:67], v[44:47], v[80:83], v[64:67]
    ds_read_b128 v[80:83], v22 offset:7168
    buffer_load_dwordx4 v[148:151], v23, s[20:23], s42 offen offset:1024
    s_waitcnt lgkmcnt(2)
    v_mfma_f32_16x16x32_bf16 v[68:71], v[44:47], v[84:87], v[68:71]
    ds_read_b128 v[84:87], v22 offset:8192
    s_waitcnt lgkmcnt(2)
    v_mfma_f32_16x16x32_bf16 v[48:51], v[32:35], v[76:79], v[48:51]
    v_mfma_f32_16x16x32_bf16 v[8:11], v[32:35], v[28:31], v[8:11]
    ds_read_b128 v[44:47], v21 offset:256
    ds_read_b128 v[76:79], v22 offset:9216
    s_waitcnt lgkmcnt(3)
    v_mfma_f32_16x16x32_bf16 v[52:55], v[32:35], v[80:83], v[52:55]
    ds_read_b128 v[80:83], v22 offset:10240
    buffer_load_dwordx4 v[152:155], v23, s[20:23], s42 offen offset:2048
    s_waitcnt lgkmcnt(3)
    v_mfma_f32_16x16x32_bf16 v[56:59], v[32:35], v[84:87], v[56:59]
    ds_read_b128 v[84:87], v22 offset:11264
    s_waitcnt lgkmcnt(2)
    v_mfma_f32_16x16x32_bf16 v[60:63], v[32:35], v[76:79], v[60:63]
    s_waitcnt lgkmcnt(1)
    v_mfma_f32_16x16x32_bf16 v[64:67], v[32:35], v[80:83], v[64:67]
    buffer_load_dwordx4 v[156:159], v23, s[20:23], s42 offen offset:3072
    s_waitcnt lgkmcnt(0)
    v_mfma_f32_16x16x32_bf16 v[68:71], v[32:35], v[84:87], v[68:71]
    s_waitcnt vmcnt(35)
    v_mfma_f32_16x16x32_bf16 v[48:51], v[36:39], v[192:195], v[48:51]
    v_mfma_f32_16x16x32_bf16 v[8:11], v[36:39], v[28:31], v[8:11]
    ds_read_b128 v[32:35], v18 offset:512
    s_add_u32 s42, s58, 0x10000
    s_waitcnt vmcnt(34)
    v_mfma_f32_16x16x32_bf16 v[52:55], v[36:39], v[196:199], v[52:55]
    buffer_load_dwordx4 v[160:163], v23, s[20:23], s42 offen
    s_waitcnt vmcnt(34)
    v_mfma_f32_16x16x32_bf16 v[56:59], v[36:39], v[200:203], v[56:59]
    s_waitcnt vmcnt(33)
    v_mfma_f32_16x16x32_bf16 v[60:63], v[36:39], v[204:207], v[60:63]
    s_waitcnt vmcnt(32)
    v_mfma_f32_16x16x32_bf16 v[64:67], v[36:39], v[208:211], v[64:67]
    buffer_load_dwordx4 v[164:167], v23, s[20:23], s42 offen offset:1024
    s_waitcnt vmcnt(32)
    v_mfma_f32_16x16x32_bf16 v[68:71], v[36:39], v[212:215], v[68:71]
    s_waitcnt vmcnt(31)
    v_mfma_f32_16x16x32_bf16 v[48:51], v[40:43], v[216:219], v[48:51]
    v_mfma_f32_16x16x32_bf16 v[8:11], v[40:43], v[28:31], v[8:11]
    ds_read_b128 v[36:39], v19 offset:512
    s_waitcnt vmcnt(30)
    v_mfma_f32_16x16x32_bf16 v[52:55], v[40:43], v[220:223], v[52:55]
    buffer_load_dwordx4 v[168:171], v23, s[20:23], s42 offen offset:2048
    s_waitcnt vmcnt(30)
    v_mfma_f32_16x16x32_bf16 v[56:59], v[40:43], v[224:227], v[56:59]
    s_waitcnt vmcnt(28)
    v_mfma_f32_16x16x32_bf16 v[60:63], v[40:43], v[228:231], v[60:63]
    s_waitcnt vmcnt(26)
    v_mfma_f32_16x16x32_bf16 v[64:67], v[40:43], v[232:235], v[64:67]
    buffer_load_dwordx4 v[172:175], v23, s[20:23], s42 offen offset:3072
    s_barrier
    s_waitcnt vmcnt(26)
    v_mfma_f32_16x16x32_bf16 v[68:71], v[40:43], v[236:239], v[68:71]
    s_waitcnt vmcnt(25)
    v_mfma_f32_16x16x32_bf16 v[48:51], v[44:47], v[112:115], v[48:51]
    v_mfma_f32_16x16x32_bf16 v[8:11], v[44:47], v[28:31], v[8:11]
    ds_read_b128 v[40:43], v20 offset:512
    s_add_u32 s42, s58, 0x11000
    s_waitcnt vmcnt(24)
    v_mfma_f32_16x16x32_bf16 v[52:55], v[44:47], v[116:119], v[52:55]
    buffer_load_dwordx4 v[176:179], v23, s[20:23], s42 offen
    s_waitcnt vmcnt(24)
    v_mfma_f32_16x16x32_bf16 v[56:59], v[44:47], v[120:123], v[56:59]
    s_waitcnt vmcnt(23)
    v_mfma_f32_16x16x32_bf16 v[60:63], v[44:47], v[124:127], v[60:63]
    s_waitcnt vmcnt(22)
    v_mfma_f32_16x16x32_bf16 v[64:67], v[44:47], v[128:131], v[64:67]
    buffer_load_dwordx4 v[180:183], v23, s[20:23], s42 offen offset:1024
    s_waitcnt vmcnt(22)
    v_mfma_f32_16x16x32_bf16 v[68:71], v[44:47], v[132:135], v[68:71]
    s_waitcnt vmcnt(21) lgkmcnt(2)
    v_mfma_f32_16x16x32_bf16 v[48:51], v[32:35], v[136:139], v[48:51]
    v_mfma_f32_16x16x32_bf16 v[8:11], v[32:35], v[28:31], v[8:11]
    ds_read_b128 v[44:47], v21 offset:512
    s_waitcnt vmcnt(20)
    v_mfma_f32_16x16x32_bf16 v[52:55], v[32:35], v[140:143], v[52:55]
    buffer_load_dwordx4 v[184:187], v23, s[20:23], s42 offen offset:2048
    s_waitcnt vmcnt(20)
    v_mfma_f32_16x16x32_bf16 v[56:59], v[32:35], v[96:99], v[56:59]
    s_waitcnt vmcnt(19)
    v_mfma_f32_16x16x32_bf16 v[60:63], v[32:35], v[100:103], v[60:63]
    s_waitcnt vmcnt(18)
    v_mfma_f32_16x16x32_bf16 v[64:67], v[32:35], v[104:107], v[64:67]
    buffer_load_dwordx4 v[188:191], v23, s[20:23], s42 offen offset:3072
    s_waitcnt vmcnt(18)
    v_mfma_f32_16x16x32_bf16 v[68:71], v[32:35], v[108:111], v[68:71]
    s_waitcnt vmcnt(17) lgkmcnt(2)
    v_mfma_f32_16x16x32_bf16 v[48:51], v[36:39], v[240:243], v[48:51]
    v_mfma_f32_16x16x32_bf16 v[8:11], v[36:39], v[28:31], v[8:11]
    s_waitcnt vmcnt(16)
    v_mfma_f32_16x16x32_bf16 v[52:55], v[36:39], v[244:247], v[52:55]
    s_waitcnt vmcnt(15)
    v_mfma_f32_16x16x32_bf16 v[56:59], v[36:39], v[248:251], v[56:59]
    s_waitcnt vmcnt(14)
    v_mfma_f32_16x16x32_bf16 v[60:63], v[36:39], v[252:255], v[60:63]
    s_waitcnt vmcnt(13)
    v_mfma_f32_16x16x32_bf16 v[64:67], v[36:39], v[88:91], v[64:67]
    s_waitcnt vmcnt(12)
    v_mfma_f32_16x16x32_bf16 v[68:71], v[36:39], v[92:95], v[68:71]
    s_waitcnt vmcnt(11) lgkmcnt(1)
    v_mfma_f32_16x16x32_bf16 v[48:51], v[40:43], v[144:147], v[48:51]
    v_mfma_f32_16x16x32_bf16 v[8:11], v[40:43], v[28:31], v[8:11]
    s_waitcnt vmcnt(10)
    v_mfma_f32_16x16x32_bf16 v[52:55], v[40:43], v[148:151], v[52:55]
    s_waitcnt vmcnt(9)
    v_mfma_f32_16x16x32_bf16 v[56:59], v[40:43], v[152:155], v[56:59]
    s_waitcnt vmcnt(8)
    v_mfma_f32_16x16x32_bf16 v[60:63], v[40:43], v[156:159], v[60:63]
    s_waitcnt vmcnt(7)
    v_mfma_f32_16x16x32_bf16 v[64:67], v[40:43], v[160:163], v[64:67]
    s_waitcnt vmcnt(6)
    v_mfma_f32_16x16x32_bf16 v[68:71], v[40:43], v[164:167], v[68:71]
    s_waitcnt vmcnt(5) lgkmcnt(0)
    v_mfma_f32_16x16x32_bf16 v[48:51], v[44:47], v[168:171], v[48:51]
    v_mfma_f32_16x16x32_bf16 v[8:11], v[44:47], v[28:31], v[8:11]
    s_waitcnt vmcnt(4)
    v_mfma_f32_16x16x32_bf16 v[52:55], v[44:47], v[172:175], v[52:55]
    s_waitcnt vmcnt(3)
    v_mfma_f32_16x16x32_bf16 v[56:59], v[44:47], v[176:179], v[56:59]
    s_waitcnt vmcnt(2)
    v_mfma_f32_16x16x32_bf16 v[60:63], v[44:47], v[180:183], v[60:63]
    s_waitcnt vmcnt(1)
    v_mfma_f32_16x16x32_bf16 v[64:67], v[44:47], v[184:187], v[64:67]
    s_waitcnt vmcnt(0)
    v_mfma_f32_16x16x32_bf16 v[68:71], v[44:47], v[188:191], v[68:71]
    v_fma_f32 v48, -v8, v12, v48
    v_fma_f32 v52, -v8, v13, v52
    v_fma_f32 v56, -v8, v14, v56
    s_nop 0
    v_fma_f32 v60, -v8, v15, v60
    s_nop 0
    v_fma_f32 v64, -v8, v16, v64
    s_nop 0
    v_fma_f32 v68, -v8, v17, v68
    v_cvt_pk_bf16_f32 v88, v48, v52
    v_cvt_pk_bf16_f32 v89, v56, v60
    v_cvt_pk_bf16_f32 v90, v64, v68
    v_mov_b32 v91, v72
    buffer_store_dwordx4 v[88:91], v4, s[20:23], s41 offen nt
    v_fma_f32 v49, -v9, v12, v49
    v_fma_f32 v53, -v9, v13, v53
    v_fma_f32 v57, -v9, v14, v57
    v_fma_f32 v61, -v9, v15, v61
    v_fma_f32 v65, -v9, v16, v65
    v_fma_f32 v69, -v9, v17, v69
    v_cvt_pk_bf16_f32 v92, v49, v53
    v_cvt_pk_bf16_f32 v93, v57, v61
    v_cvt_pk_bf16_f32 v94, v65, v69
    v_mov_b32 v95, v73
    buffer_store_dwordx4 v[92:95], v4, s[20:23], s41 offen offset:256 nt
    v_fma_f32 v50, -v10, v12, v50
    v_fma_f32 v54, -v10, v13, v54
    v_fma_f32 v58, -v10, v14, v58
    v_fma_f32 v62, -v10, v15, v62
    v_fma_f32 v66, -v10, v16, v66
    v_fma_f32 v70, -v10, v17, v70
    v_cvt_pk_bf16_f32 v96, v50, v54
    v_cvt_pk_bf16_f32 v97, v58, v62
    v_cvt_pk_bf16_f32 v98, v66, v70
    v_mov_b32 v99, v74
    buffer_store_dwordx4 v[96:99], v4, s[20:23], s41 offen offset:512 nt
    v_fma_f32 v51, -v11, v12, v51
    v_fma_f32 v55, -v11, v13, v55
    v_fma_f32 v59, -v11, v14, v59
    v_fma_f32 v63, -v11, v15, v63
    v_fma_f32 v67, -v11, v16, v67
    v_fma_f32 v71, -v11, v17, v71
    v_cvt_pk_bf16_f32 v100, v51, v55
    v_cvt_pk_bf16_f32 v101, v59, v63
    v_cvt_pk_bf16_f32 v102, v67, v71
    v_mov_b32 v103, v75
    buffer_store_dwordx4 v[100:103], v4, s[20:23], s41 offen offset:768 nt
    s_barrier
    s_endpgm
L_late:
    s_add_u32 m0, s43, 0
    s_add_u32 s41, s98, 0
    buffer_load_dwordx4 v32, s[16:19], s41 offen lds
    buffer_load_dwordx4 v33, s[16:19], s41 offen offset:1024 lds
    buffer_load_dwordx4 v34, s[16:19], s41 offen offset:2048 lds
    s_add_u32 m0, s43, 0xc00
    s_add_u32 s41, s98, 0xc00
    buffer_load_dwordx4 v32, s[16:19], s41 offen lds
    buffer_load_dwordx4 v33, s[16:19], s41 offen offset:1024 lds
    buffer_load_dwordx4 v34, s[16:19], s41 offen offset:2048 lds
    s_add_u32 m0, s43, 0x6000
    s_add_u32 s41, s98, 0x6000
    buffer_load_dwordx4 v32, s[16:19], s41 offen lds
    buffer_load_dwordx4 v33, s[16:19], s41 offen offset:1024 lds
    buffer_load_dwordx4 v34, s[16:19], s41 offen offset:2048 lds
    s_add_u32 m0, s43, 0x6c00
    s_add_u32 s41, s98, 0x6c00
    buffer_load_dwordx4 v32, s[16:19], s41 offen lds
    buffer_load_dwordx4 v33, s[16:19], s41 offen offset:1024 lds
    buffer_load_dwordx4 v34, s[16:19], s41 offen offset:2048 lds
    s_waitcnt vmcnt(6)
L_Lmain3:
    s_barrier
    s_add_u32 m0, s43, 0x10000
    s_add_u32 s41, s98, 0xc000
    buffer_load_dwordx4 v32, s[16:19], s41 offen lds
    buffer_load_dwordx4 v33, s[16:19], s41 offen offset:1024 lds
    buffer_load_dwordx4 v34, s[16:19], s41 offen offset:2048 lds
    s_add_u32 m0, s43, 0x10c00
    s_add_u32 s41, s98, 0xcc00
    buffer_load_dwordx4 v32, s[16:19], s41 offen lds
    buffer_load_dwordx4 v33, s[16:19], s41 offen offset:1024 lds
    buffer_load_dwordx4 v34, s[16:19], s41 offen offset:2048 lds
    s_add_u32 m0, s43, 0x16000
    s_add_u32 s41, s98, 0x12000
    buffer_load_dwordx4 v32, s[16:19], s41 offen lds
    buffer_load_dwordx4 v33, s[16:19], s41 offen offset:1024 lds
    buffer_load_dwordx4 v34, s[16:19], s41 offen offset:2048 lds
    s_add_u32 m0, s43, 0x16c00
    s_add_u32 s41, s98, 0x12c00
    buffer_load_dwordx4 v32, s[16:19], s41 offen lds
    buffer_load_dwordx4 v33, s[16:19], s41 offen offset:1024 lds
    buffer_load_dwordx4 v34, s[16:19], s41 offen offset:2048 lds
    s_waitcnt vmcnt(12)
    s_barrier
    v_mov_b32 v29, 0
    buffer_load_dword v29, v29, s[24:27], 0 offen sc1
    s_add_u32 m0, s43, 0
    s_add_u32 s41, s98, 0x18000
    buffer_load_dwordx4 v32, s[16:19], s41 offen lds
    buffer_load_dwordx4 v33, s[16:19], s41 offen offset:1024 lds
    buffer_load_dwordx4 v34, s[16:19], s41 offen offset:2048 lds
    s_add_u32 m0, s43, 0xc00
    s_add_u32 s41, s98, 0x18c00
    buffer_load_dwordx4 v32, s[16:19], s41 offen lds
    buffer_load_dwordx4 v33, s[16:19], s41 offen offset:1024 lds
    buffer_load_dwordx4 v34, s[16:19], s41 offen offset:2048 lds
    s_waitcnt vmcnt(13)
    s_barrier
    s_add_u32 m0, s43, 0x6000
    s_add_u32 s41, s98, 0x1e000
    buffer_load_dwordx4 v32, s[16:19], s41 offen lds
    buffer_load_dwordx4 v33, s[16:19], s41 offen offset:1024 lds
    buffer_load_dwordx4 v34, s[16:19], s41 offen offset:2048 lds
    s_add_u32 m0, s43, 0x6c00
    s_add_u32 s41, s98, 0x1ec00
    buffer_load_dwordx4 v32, s[16:19], s41 offen lds
    buffer_load_dwordx4 v33, s[16:19], s41 offen offset:1024 lds
    buffer_load_dwordx4 v34, s[16:19], s41 offen offset:2048 lds
    s_waitcnt vmcnt(13)
    s_barrier
    s_waitcnt vmcnt(12)
    v_readfirstlane_b32 s44, v29
    s_nop 0
    s_cmp_eq_u32 s44, 0
    s_cbranch_scc1 L_es_22
L_eb_23:
    s_mul_i32 s45, s44, 0x9e3779b1
    s_getreg_b32 s46, hwreg(HW_REG_XCC_ID)
    s_and_b32 s46, s46, 15
    s_add_u32 m0, s43, 0x10000
    s_add_u32 s41, s98, 0x24000
    buffer_load_dwordx4 v32, s[16:19], s41 offen lds
    buffer_load_dwordx4 v33, s[16:19], s41 offen offset:1024 lds
    buffer_load_dwordx4 v34, s[16:19], s41 offen offset:2048 lds
    s_add_u32 m0, s43, 0x10c00
    s_add_u32 s41, s98, 0x24c00
    buffer_load_dwordx4 v32, s[16:19], s41 offen lds
    buffer_load_dwordx4 v33, s[16:19], s41 offen offset:1024 lds
    buffer_load_dwordx4 v34, s[16:19], s41 offen offset:2048 lds
    s_waitcnt vmcnt(12)
    s_barrier
    s_add_u32 m0, s43, 0x16000
    s_add_u32 s41, s98, 0x2a000
    buffer_load_dwordx4 v32, s[16:19], s41 offen lds
    buffer_load_dwordx4 v33, s[16:19], s41 offen offset:1024 lds
    buffer_load_dwordx4 v34, s[16:19], s41 offen offset:2048 lds
    s_add_u32 m0, s43, 0x16c00
    s_add_u32 s41, s98, 0x2ac00
    buffer_load_dwordx4 v32, s[16:19], s41 offen lds
    buffer_load_dwordx4 v33, s[16:19], s41 offen offset:1024 lds
    buffer_load_dwordx4 v34, s[16:19], s41 offen offset:2048 lds
    s_waitcnt vmcnt(12)
    s_barrier
    s_add_u32 m0, s43, 0
    s_add_u32 s41, s98, 0x30000
    buffer_load_dwordx4 v32, s[16:19], s41 offen lds
    buffer_load_dwordx4 v33, s[16:19], s41 offen offset:1024 lds
    buffer_load_dwordx4 v34, s[16:19], s41 offen offset:2048 lds
    s_add_u32 m0, s43, 0xc00
    s_add_u32 s41, s98, 0x30c00
    buffer_load_dwordx4 v32, s[16:19], s41 offen lds
    buffer_load_dwordx4 v33, s[16:19], s41 offen offset:1024 lds
    buffer_load_dwordx4 v34, s[16:19], s41 offen offset:2048 lds
    s_cmp_eq_u32 s49, 0
    s_cbranch_scc1 L_vs_24
    v_mov_b32 v24, s45
    s_lshl_b32 s4, s49, 7
    s_add_u32 s4, s4, 0x70000
    v_mov_b32 v25, 0
    s_mov_b64 exec, 1
    buffer_store_dword v24, v25, s[20:23], s4 offen sc1
    s_mov_b64 exec, -1
L_vs_24:
    s_waitcnt vmcnt(12)
    s_barrier
    s_add_u32 m0, s43, 0x6000
    s_add_u32 s41, s98, 0x36000
    buffer_load_dwordx4 v32, s[16:19], s41 offen lds
    buffer_load_dwordx4 v33, s[16:19], s41 offen offset:1024 lds
    buffer_load_dwordx4 v34, s[16:19], s41 offen offset:2048 lds
    s_add_u32 m0, s43, 0x6c00
    s_add_u32 s41, s98, 0x36c00
    buffer_load_dwordx4 v32, s[16:19], s41 offen lds
    buffer_load_dwordx4 v33, s[16:19], s41 offen offset:1024 lds
    buffer_load_dwordx4 v34, s[16:19], s41 offen offset:2048 lds
    s_waitcnt vmcnt(12)
    s_barrier
    s_add_u32 m0, s43, 0x10000
    s_add_u32 s41, s98, 0x3c000
    buffer_load_dwordx4 v32, s[16:19], s41 offen lds
    buffer_load_dwordx4 v33, s[16:19], s41 offen offset:1024 lds
    buffer_load_dwordx4 v34, s[16:19], s41 offen offset:2048 lds
    s_add_u32 m0, s43, 0x10c00
    s_add_u32 s41, s98, 0x3cc00
    buffer_load_dwordx4 v32, s[16:19], s41 offen lds
    buffer_load_dwordx4 v33, s[16:19], s41 offen offset:1024 lds
    buffer_load_dwordx4 v34, s[16:19], s41 offen offset:2048 lds
    s_waitcnt vmcnt(12)
    s_barrier
    s_add_u32 m0, s43, 0x16000
    s_add_u32 s41, s98, 0x42000
    buffer_load_dwordx4 v32, s[16:19], s41 offen lds
    buffer_load_dwordx4 v33, s[16:19], s41 offen offset:1024 lds
    buffer_load_dwordx4 v34, s[16:19], s41 offen offset:2048 lds
    s_add_u32 m0, s43, 0x16c00
    s_add_u32 s41, s98, 0x42c00
    buffer_load_dwordx4 v32, s[16:19], s41 offen lds
    buffer_load_dwordx4 v33, s[16:19], s41 offen offset:1024 lds
    buffer_load_dwordx4 v34, s[16:19], s41 offen offset:2048 lds
    s_waitcnt vmcnt(12)
    s_barrier
    s_waitcnt vmcnt(6)
    s_barrier
    v_min_u32 v24, 17, v1
    v_lshlrev_b32 v24, 7, v24
    s_mul_i32 s4, s3, 0x900
    s_add_u32 s4, s4, 0x70000
    buffer_load_dword v27, v24, s[20:23], s4 offen sc1
    s_waitcnt vmcnt(1)
    s_barrier
    s_mov_b32 s47, 2
    s_waitcnt vmcnt(0)
    v_cmp_ne_u32 vcc, s45, v27
    s_nop 0
    s_lshr_b32 s0, vcc_lo, 12
    s_and_b32 s4, vcc_lo, 0xfff
    s_cbranch_scc1 L_ar_25
L_ag_26:
    s_mul_i32 s100, s3, 0x3000
    buffer_load_dwordx4 v[192:195], v23, s[20:23], s100 offen
    buffer_load_dwordx4 v[196:199], v23, s[20:23], s100 offen offset:1024
    buffer_load_dwordx4 v[200:203], v23, s[20:23], s100 offen offset:2048
    buffer_load_dwordx4 v[204:207], v23, s[20:23], s100 offen offset:3072
    s_add_u32 s100, s100, 0x1000
    buffer_load_dwordx4 v[208:211], v23, s[20:23], s100 offen
    buffer_load_dwordx4 v[212:215], v23, s[20:23], s100 offen offset:1024
    buffer_load_dwordx4 v[216:219], v23, s[20:23], s100 offen offset:2048
    buffer_load_dwordx4 v[220:223], v23, s[20:23], s100 offen offset:3072
    s_add_u32 s100, s100, 0x1000
    buffer_load_dwordx4 v[224:227], v23, s[20:23], s100 offen
    buffer_load_dwordx4 v[228:231], v23, s[20:23], s100 offen offset:1024
    buffer_load_dwordx4 v[232:235], v23, s[20:23], s100 offen offset:2048
    buffer_load_dwordx4 v[236:239], v23, s[20:23], s100 offen offset:3072
    v_add_u32 v31, s101, v23
    ds_write_b128 v31, v[64:67]
    ds_write_b128 v31, v[68:71] offset:1024
    ds_write_b128 v31, v[72:75] offset:2048
    ds_write_b128 v31, v[76:79] offset:3072
    ds_write_b128 v31, v[80:83] offset:4096
    ds_write_b128 v31, v[84:87] offset:5120
    ds_write_b128 v31, v[88:91] offset:6144
    ds_write_b128 v31, v[92:95] offset:7168
    ds_write_b128 v31, v[96:99] offset:8192
    ds_write_b128 v31, v[100:103] offset:9216
    ds_write_b128 v31, v[104:107] offset:10240
    ds_write_b128 v31, v[108:111] offset:11264
    v_mov_b32 v92, 0x3f803f80
    v_mov_b32 v93, 0x3f803f80
    v_mov_b32 v94, 0x3f803f80
    v_mov_b32 v95, 0x3f803f80
    s_waitcnt lgkmcnt(0)
    s_barrier
    s_setprio 1
    s_lshl_b32 s4, s3, 6
    v_xor_b32 v96, s4, v36
    v_add_u32 v96, s101, v96
    v_xor_b32 v97, s4, v37
    v_add_u32 v97, s101, v97
    v_xor_b32 v98, s4, v38
    v_add_u32 v98, s101, v98
    v_xor_b32 v99, s4, v39
    v_add_u32 v99, s101, v99
    v_min_u32 v24, 17, v1
    v_lshlrev_b32 v24, 7, v24
    s_mul_i32 s4, s3, 0x900
    s_add_u32 s4, s4, 0x70000
    buffer_load_dword v35, v24, s[20:23], s4 offen sc1
    ds_read_b128 v[112:115], v36
    ds_read_b128 v[116:119], v37
    ds_read_b128 v[120:123], v38
    ds_read_b128 v[124:127], v39
    ds_read_b128 v[128:131], v36 offset:256
    ds_read_b128 v[132:135], v37 offset:256
    s_waitcnt vmcnt(12)
    v_mfma_f32_16x16x32_bf16 v[88:91], v[92:95], v[192:195], 0
    ds_read_b128 v[144:147], v96
    s_waitcnt vmcnt(11)
    v_mfma_f32_16x16x32_bf16 v[88:91], v[92:95], v[196:199], v[88:91]
    ds_read_b128 v[148:151], v97
    s_waitcnt vmcnt(10)
    v_mfma_f32_16x16x32_bf16 v[88:91], v[92:95], v[200:203], v[88:91]
    ds_read_b128 v[152:155], v98
    s_waitcnt vmcnt(9)
    v_mfma_f32_16x16x32_bf16 v[88:91], v[92:95], v[204:207], v[88:91]
    ds_read_b128 v[156:159], v99
    s_waitcnt vmcnt(8)
    v_mfma_f32_16x16x32_bf16 v[88:91], v[92:95], v[208:211], v[88:91]
    ds_read_b128 v[160:163], v96 offset:256
    s_waitcnt vmcnt(7)
    v_mfma_f32_16x16x32_bf16 v[88:91], v[92:95], v[212:215], v[88:91]
    ds_read_b128 v[164:167], v97 offset:256
    s_waitcnt vmcnt(6)
    v_mfma_f32_16x16x32_bf16 v[88:91], v[92:95], v[216:219], v[88:91]
    ds_read_b128 v[168:171], v98 offset:256
    s_waitcnt vmcnt(5)
    v_mfma_f32_16x16x32_bf16 v[88:91], v[92:95], v[220:223], v[88:91]
    ds_read_b128 v[172:175], v99 offset:256
    s_waitcnt vmcnt(4)
    v_mfma_f32_16x16x32_bf16 v[88:91], v[92:95], v[224:227], v[88:91]
    ds_read_b128 v[176:179], v96 offset:512
    s_waitcnt vmcnt(3)
    v_mfma_f32_16x16x32_bf16 v[88:91], v[92:95], v[228:231], v[88:91]
    ds_read_b128 v[180:183], v97 offset:512
    s_waitcnt vmcnt(2)
    v_mfma_f32_16x16x32_bf16 v[88:91], v[92:95], v[232:235], v[88:91]
    ds_read_b128 v[184:187], v98 offset:512
    s_waitcnt vmcnt(1)
    v_mfma_f32_16x16x32_bf16 v[88:91], v[92:95], v[236:239], v[88:91]
    ds_read_b128 v[188:191], v99 offset:512
    s_waitcnt lgkmcnt(15)
    v_mfma_f32_16x16x32_bf16 v[48:51], v[112:115], v[192:195], 0
    ds_read_b128 v[136:139], v38 offset:256
    v_mfma_f32_16x16x32_bf16 v[48:51], v[116:119], v[196:199], v[48:51]
    ds_read_b128 v[140:143], v39 offset:256
    v_mfma_f32_16x16x32_bf16 v[48:51], v[120:123], v[200:203], v[48:51]
    ds_read_b128 v[112:115], v36 offset:512
    s_waitcnt lgkmcnt(15)
    v_mfma_f32_16x16x32_bf16 v[48:51], v[124:127], v[204:207], v[48:51]
    ds_read_b128 v[116:119], v37 offset:512
    v_mfma_f32_16x16x32_bf16 v[48:51], v[128:131], v[208:211], v[48:51]
    ds_read_b128 v[120:123], v38 offset:512
    v_mov_b32 v29, v88
    v_mfma_f32_16x16x32_bf16 v[48:51], v[132:135], v[212:215], v[48:51]
    ds_read_b128 v[124:127], v39 offset:512
    s_waitcnt lgkmcnt(3)
    v_mfma_f32_16x16x32_bf16 v[48:51], v[136:139], v[216:219], v[48:51]
    ds_read_b128 v[128:131], v37 offset:12288
    v_mfma_f32_16x16x32_bf16 v[48:51], v[140:143], v[220:223], v[48:51]
    ds_read_b128 v[132:135], v36 offset:12288
    v_mfma_f32_16x16x32_bf16 v[48:51], v[112:115], v[224:227], v[48:51]
    ds_read_b128 v[136:139], v39 offset:12288
    s_waitcnt lgkmcnt(3)
    v_mfma_f32_16x16x32_bf16 v[48:51], v[116:119], v[228:231], v[48:51]
    ds_read_b128 v[140:143], v38 offset:12288
    v_mfma_f32_16x16x32_bf16 v[48:51], v[120:123], v[232:235], v[48:51]
    ds_read_b128 v[112:115], v37 offset:12544
    v_mfma_f32_16x16x32_bf16 v[48:51], v[124:127], v[236:239], v[48:51]
    ds_read_b128 v[116:119], v36 offset:12544
    s_waitcnt lgkmcnt(3)
    v_mfma_f32_16x16x32_bf16 v[52:55], v[128:131], v[192:195], 0
    ds_read_b128 v[120:123], v39 offset:12544
    v_mfma_f32_16x16x32_bf16 v[52:55], v[132:135], v[196:199], v[52:55]
    ds_read_b128 v[124:127], v38 offset:12544
    v_mfma_f32_16x16x32_bf16 v[52:55], v[136:139], v[200:203], v[52:55]
    ds_read_b128 v[128:131], v37 offset:12800
    s_waitcnt lgkmcnt(3)
    v_mfma_f32_16x16x32_bf16 v[52:55], v[140:143], v[204:207], v[52:55]
    ds_read_b128 v[132:135], v36 offset:12800
    v_mfma_f32_16x16x32_bf16 v[52:55], v[112:115], v[208:211], v[52:55]
    ds_read_b128 v[136:139], v39 offset:12800
    v_mfma_f32_16x16x32_bf16 v[52:55], v[116:119], v[212:215], v[52:55]
    ds_read_b128 v[140:143], v38 offset:12800
    s_waitcnt lgkmcnt(3)
    v_mfma_f32_16x16x32_bf16 v[52:55], v[120:123], v[216:219], v[52:55]
    ds_read_b128 v[112:115], v38 offset:24576
    v_mfma_f32_16x16x32_bf16 v[52:55], v[124:127], v[220:223], v[52:55]
    ds_read_b128 v[116:119], v39 offset:24576
    v_mfma_f32_16x16x32_bf16 v[52:55], v[128:131], v[224:227], v[52:55]
    ds_read_b128 v[120:123], v36 offset:24576
    s_waitcnt lgkmcnt(3)
    v_mfma_f32_16x16x32_bf16 v[52:55], v[132:135], v[228:231], v[52:55]
    ds_read_b128 v[124:127], v37 offset:24576
    v_mfma_f32_16x16x32_bf16 v[52:55], v[136:139], v[232:235], v[52:55]
    ds_read_b128 v[128:131], v38 offset:24832
    v_mfma_f32_16x16x32_bf16 v[52:55], v[140:143], v[236:239], v[52:55]
    ds_read_b128 v[132:135], v39 offset:24832
    s_waitcnt lgkmcnt(3)
    v_mfma_f32_16x16x32_bf16 v[56:59], v[112:115], v[192:195], 0
    ds_read_b128 v[136:139], v36 offset:24832
    v_mfma_f32_16x16x32_bf16 v[56:59], v[116:119], v[196:199], v[56:59]
    ds_read_b128 v[140:143], v37 offset:24832
    v_mfma_f32_16x16x32_bf16 v[56:59], v[120:123], v[200:203], v[56:59]
    ds_read_b128 v[112:115], v38 offset:25088
    s_waitcnt lgkmcnt(3)
    v_mfma_f32_16x16x32_bf16 v[56:59], v[124:127], v[204:207], v[56:59]
    ds_read_b128 v[116:119], v39 offset:25088
    v_mfma_f32_16x16x32_bf16 v[56:59], v[128:131], v[208:211], v[56:59]
    ds_read_b128 v[120:123], v36 offset:25088
    v_mfma_f32_16x16x32_bf16 v[56:59], v[132:135], v[212:215], v[56:59]
    ds_read_b128 v[124:127], v37 offset:25088
    s_waitcnt lgkmcnt(3)
    v_mfma_f32_16x16x32_bf16 v[56:59], v[136:139], v[216:219], v[56:59]
    ds_read_b128 v[128:131], v39 offset:36864
    v_mfma_f32_16x16x32_bf16 v[56:59], v[140:143], v[220:223], v[56:59]
    ds_read_b128 v[132:135], v38 offset:36864
    v_mfma_f32_16x16x32_bf16 v[56:59], v[112:115], v[224:227], v[56:59]
    ds_read_b128 v[136:139], v37 offset:36864
    s_waitcnt lgkmcnt(3)
    v_mfma_f32_16x16x32_bf16 v[56:59], v[116:119], v[228:231], v[56:59]
    ds_read_b128 v[140:143], v36 offset:36864
    v_mfma_f32_16x16x32_bf16 v[56:59], v[120:123], v[232:235], v[56:59]
    ds_read_b128 v[112:115], v39 offset:37120
    v_mfma_f32_16x16x32_bf16 v[56:59], v[124:127], v[236:239], v[56:59]
    ds_read_b128 v[116:119], v38 offset:37120
    s_waitcnt lgkmcnt(3)
    v_mfma_f32_16x16x32_bf16 v[60:63], v[128:131], v[192:195], 0
    ds_read_b128 v[120:123], v37 offset:37120
    v_mfma_f32_16x16x32_bf16 v[60:63], v[132:135], v[196:199], v[60:63]
    ds_read_b128 v[124:127], v36 offset:37120
    v_mfma_f32_16x16x32_bf16 v[60:63], v[136:139], v[200:203], v[60:63]
    ds_read_b128 v[128:131], v39 offset:37376
    s_waitcnt lgkmcnt(3)
    v_mfma_f32_16x16x32_bf16 v[60:63], v[140:143], v[204:207], v[60:63]
    ds_read_b128 v[132:135], v38 offset:37376
    v_mfma_f32_16x16x32_bf16 v[60:63], v[112:115], v[208:211], v[60:63]
    ds_read_b128 v[136:139], v37 offset:37376
    v_mfma_f32_16x16x32_bf16 v[60:63], v[116:119], v[212:215], v[60:63]
    ds_read_b128 v[140:143], v36 offset:37376
    s_waitcnt lgkmcnt(3)
    v_mfma_f32_16x16x32_bf16 v[60:63], v[120:123], v[216:219], v[60:63]
    v_mfma_f32_16x16x32_bf16 v[60:63], v[124:127], v[220:223], v[60:63]
    v_mfma_f32_16x16x32_bf16 v[60:63], v[128:131], v[224:227], v[60:63]
    s_waitcnt lgkmcnt(2)
    v_mfma_f32_16x16x32_bf16 v[60:63], v[132:135], v[228:231], v[60:63]
    s_waitcnt lgkmcnt(1)
    v_mfma_f32_16x16x32_bf16 v[60:63], v[136:139], v[232:235], v[60:63]
    s_waitcnt lgkmcnt(0)
    v_mfma_f32_16x16x32_bf16 v[60:63], v[140:143], v[236:239], v[60:63]
    s_waitcnt vmcnt(0)
    v_cmp_ne_u32 vcc, s45, v35
    s_nop 0
    s_lshr_b32 s0, vcc_lo, 12
    s_and_b32 s4, vcc_lo, 0xfff
    v_mov_b32 v28, 0
    s_cmp_lg_u32 s3, 3
    s_cbranch_scc1 L_ts_27
    s_and_b32 s4, s45, 0xfffffff0
    s_or_b32 s4, s4, s46
    v_mov_b32 v24, s4
    s_lshl_b32 s5, s2, 4
    s_add_u32 s5, s5, 0x60000
    v_mov_b32 v25, 0
    s_mov_b64 exec, 1
    buffer_store_dword v24, v25, s[20:23], s5 offen sc1
    s_mov_b64 exec, -1
L_ts_27:
    s_barrier
    s_lshl_b32 s4, s3, 6
    v_add_u32 v26, s4, v21
    ds_read_b128 v[40:43], v26 offset:768
    ds_read_b128 v[44:47], v26 offset:1024
    ds_read_b128 v[112:115], v12
    ds_read_b128 v[116:119], v13
    ds_read_b128 v[120:123], v14
    ds_read_b128 v[124:127], v15
    ds_read_b128 v[128:131], v12 offset:256
    ds_read_b128 v[132:135], v13 offset:256
    s_waitcnt lgkmcnt(4)
    v_mfma_f32_16x16x32_bf16 v[80:83], v[112:115], v[112:115], 0
    ds_read_b128 v[136:139], v14 offset:256
    v_mfma_f32_16x16x32_bf16 v[84:87], v[144:147], v[112:115], 0
    v_mfma_f32_16x16x32_bf16 v[88:91], v[92:95], v[112:115], 0
    v_mfma_f32_16x16x32_bf16 v[80:83], v[116:119], v[116:119], v[80:83]
    ds_read_b128 v[140:143], v15 offset:256
    v_mfma_f32_16x16x32_bf16 v[84:87], v[148:151], v[116:119], v[84:87]
    v_mfma_f32_16x16x32_bf16 v[88:91], v[92:95], v[116:119], v[88:91]
    s_waitcnt lgkmcnt(4)
    v_mfma_f32_16x16x32_bf16 v[80:83], v[120:123], v[120:123], v[80:83]
    ds_read_b128 v[112:115], v12 offset:512
    v_mfma_f32_16x16x32_bf16 v[84:87], v[152:155], v[120:123], v[84:87]
    v_mfma_f32_16x16x32_bf16 v[88:91], v[92:95], v[120:123], v[88:91]
    v_mfma_f32_16x16x32_bf16 v[80:83], v[124:127], v[124:127], v[80:83]
    ds_read_b128 v[116:119], v13 offset:512
    v_mfma_f32_16x16x32_bf16 v[84:87], v[156:159], v[124:127], v[84:87]
    v_mfma_f32_16x16x32_bf16 v[88:91], v[92:95], v[124:127], v[88:91]
    s_waitcnt lgkmcnt(4)
    v_mfma_f32_16x16x32_bf16 v[80:83], v[128:131], v[128:131], v[80:83]
    ds_read_b128 v[120:123], v14 offset:512
    v_mfma_f32_16x16x32_bf16 v[84:87], v[160:163], v[128:131], v[84:87]
    v_mfma_f32_16x16x32_bf16 v[88:91], v[92:95], v[128:131], v[88:91]
    v_mfma_f32_16x16x32_bf16 v[80:83], v[132:135], v[132:135], v[80:83]
    ds_read_b128 v[124:127], v15 offset:512
    v_mfma_f32_16x16x32_bf16 v[84:87], v[164:167], v[132:135], v[84:87]
    v_mfma_f32_16x16x32_bf16 v[88:91], v[92:95], v[132:135], v[88:91]
    s_waitcnt lgkmcnt(4)
    v_mfma_f32_16x16x32_bf16 v[80:83], v[136:139], v[136:139], v[80:83]
    ds_read_b128 v[128:131], v8
    v_mfma_f32_16x16x32_bf16 v[84:87], v[168:171], v[136:139], v[84:87]
    v_mfma_f32_16x16x32_bf16 v[88:91], v[92:95], v[136:139], v[88:91]
    v_mfma_f32_16x16x32_bf16 v[80:83], v[140:143], v[140:143], v[80:83]
    ds_read_b128 v[132:135], v9
    v_mfma_f32_16x16x32_bf16 v[84:87], v[172:175], v[140:143], v[84:87]
    v_mfma_f32_16x16x32_bf16 v[88:91], v[92:95], v[140:143], v[88:91]
    s_waitcnt lgkmcnt(4)
    v_mfma_f32_16x16x32_bf16 v[80:83], v[112:115], v[112:115], v[80:83]
    ds_read_b128 v[136:139], v10
    v_mfma_f32_16x16x32_bf16 v[84:87], v[176:179], v[112:115], v[84:87]
    v_mfma_f32_16x16x32_bf16 v[88:91], v[92:95], v[112:115], v[88:91]
    v_mfma_f32_16x16x32_bf16 v[80:83], v[116:119], v[116:119], v[80:83]
    ds_read_b128 v[140:143], v11
    v_mfma_f32_16x16x32_bf16 v[84:87], v[180:183], v[116:119], v[84:87]
    v_mfma_f32_16x16x32_bf16 v[88:91], v[92:95], v[116:119], v[88:91]
    s_waitcnt lgkmcnt(4)
    v_mfma_f32_16x16x32_bf16 v[80:83], v[120:123], v[120:123], v[80:83]
    ds_read_b128 v[112:115], v8 offset:256
    v_mfma_f32_16x16x32_bf16 v[84:87], v[184:187], v[120:123], v[84:87]
    v_mfma_f32_16x16x32_bf16 v[88:91], v[92:95], v[120:123], v[88:91]
    v_mfma_f32_16x16x32_bf16 v[80:83], v[124:127], v[124:127], v[80:83]
    ds_read_b128 v[116:119], v9 offset:256
    v_mfma_f32_16x16x32_bf16 v[84:87], v[188:191], v[124:127], v[84:87]
    v_mfma_f32_16x16x32_bf16 v[88:91], v[92:95], v[124:127], v[88:91]
    s_waitcnt lgkmcnt(4)
    v_mfma_f32_16x16x32_bf16 v[64:67], v[128:131], v[192:195], 0
    ds_read_b128 v[120:123], v10 offset:256
    v_mfma_f32_16x16x32_bf16 v[64:67], v[132:135], v[196:199], v[64:67]
    ds_read_b128 v[124:127], v11 offset:256
    s_waitcnt lgkmcnt(4)
    v_mfma_f32_16x16x32_bf16 v[64:67], v[136:139], v[200:203], v[64:67]
    ds_read_b128 v[128:131], v8 offset:512
    v_mfma_f32_16x16x32_bf16 v[64:67], v[140:143], v[204:207], v[64:67]
    ds_read_b128 v[132:135], v9 offset:512
    v_cndmask_b32 v24, v80, v81, s[92:93]
    v_cndmask_b32 v25, v82, v83, s[96:97]
    v_add_f32 v31, v88, v44
    v_cndmask_b32 v24, v24, v25, s[94:95]
    v_mul_f32 v31, s89, v31
    v_fma_f32 v24, v84, 2.0, v24
    v_add_f32 v24, v24, v40
    v_mul_f32 v25, v31, v31
    v_fma_f32 v24, v24, s89, -v25
    v_max_f32 v24, 0, v24
    v_add_f32 v24, s90, v24
    v_rsq_f32 v24, v24
    ds_write_b32 v22, v31 offset:256
    ds_write_b32 v22, v24
    s_waitcnt lgkmcnt(6)
    v_mfma_f32_16x16x32_bf16 v[64:67], v[112:115], v[208:211], v[64:67]
    ds_read_b128 v[136:139], v10 offset:512
    v_mfma_f32_16x16x32_bf16 v[64:67], v[116:119], v[212:215], v[64:67]
    ds_read_b128 v[140:143], v11 offset:512
    s_waitcnt lgkmcnt(6)
    v_mfma_f32_16x16x32_bf16 v[64:67], v[120:123], v[216:219], v[64:67]
    ds_read_b128 v[112:115], v8 offset:12288
    v_mfma_f32_16x16x32_bf16 v[64:67], v[124:127], v[220:223], v[64:67]
    ds_read_b128 v[116:119], v9 offset:12288
    s_waitcnt lgkmcnt(6)
    v_mfma_f32_16x16x32_bf16 v[64:67], v[128:131], v[224:227], v[64:67]
    ds_read_b128 v[120:123], v10 offset:12288
    v_mfma_f32_16x16x32_bf16 v[64:67], v[132:135], v[228:231], v[64:67]
    ds_read_b128 v[124:127], v11 offset:12288
    s_waitcnt lgkmcnt(4)
    v_mfma_f32_16x16x32_bf16 v[64:67], v[136:139], v[232:235], v[64:67]
    ds_read_b128 v[128:131], v8 offset:12544
    v_mfma_f32_16x16x32_bf16 v[64:67], v[140:143], v[236:239], v[64:67]
    ds_read_b128 v[132:135], v9 offset:12544
    s_barrier
    ds_read_b128 v[96:99], v21
    ds_read_b128 v[100:103], v21 offset:256
    ds_read_b128 v[104:107], v21 offset:64
    ds_read_b128 v[108:111], v21 offset:320
    s_mov_b32 exec_lo, 0x11111111
    s_mov_b32 exec_hi, 0x11111111
    v_mov_b64 v[144:145], v[92:93]
    v_mov_b64 v[146:147], v[92:93]
    v_mov_b64 v[148:149], v[92:93]
    v_mov_b64 v[150:151], v[92:93]
    v_mov_b64 v[152:153], v[92:93]
    v_mov_b64 v[154:155], v[92:93]
    v_mov_b64 v[156:157], v[92:93]
    v_mov_b64 v[158:159], v[92:93]
    v_mov_b64 v[160:161], v[92:93]
    v_mov_b64 v[162:163], v[92:93]
    v_mov_b64 v[164:165], v[92:93]
    v_mov_b64 v[166:167], v[92:93]
    v_mov_b64 v[168:169], v[92:93]
    v_mov_b64 v[170:171], v[92:93]
    v_mov_b64 v[172:173], v[92:93]
    v_mov_b64 v[174:175], v[92:93]
    v_mov_b64 v[176:177], v[92:93]
    v_mov_b64 v[178:179], v[92:93]
    v_mov_b64 v[180:181], v[92:93]
    v_mov_b64 v[182:183], v[92:93]
    v_mov_b64 v[184:185], v[92:93]
    v_mov_b64 v[186:187], v[92:93]
    v_mov_b64 v[188:189], v[92:93]
    v_mov_b64 v[190:191], v[92:93]
    s_mov_b64 exec, -1
    s_waitcnt lgkmcnt(8)
    v_mfma_f32_16x16x32_bf16 v[68:71], v[112:115], v[192:195], 0
    ds_read_b128 v[136:139], v10 offset:12544
    v_add_u32 v12, 0x10000, v12
    v_mfma_f32_16x16x32_bf16 v[68:71], v[116:119], v[196:199], v[68:71]
    ds_read_b128 v[140:143], v11 offset:12544
    v_add_u32 v13, 0x10000, v13
    s_waitcnt lgkmcnt(8)
    v_mfma_f32_16x16x32_bf16 v[68:71], v[120:123], v[200:203], v[68:71]
    ds_read_b128 v[112:115], v8 offset:12800
    v_add_u32 v14, 0x10000, v14
    v_mfma_f32_16x16x32_bf16 v[68:71], v[124:127], v[204:207], v[68:71]
    ds_read_b128 v[116:119], v9 offset:12800
    v_add_u32 v15, 0x10000, v15
    s_waitcnt lgkmcnt(8)
    v_mfma_f32_16x16x32_bf16 v[68:71], v[128:131], v[208:211], v[68:71]
    ds_read_b128 v[120:123], v10 offset:12800
    v_mfma_f32_16x16x32_bf16 v[68:71], v[132:135], v[212:215], v[68:71]
    ds_read_b128 v[124:127], v11 offset:12800
    s_waitcnt lgkmcnt(4)
    v_mfma_f32_16x16x32_bf16 v[68:71], v[136:139], v[216:219], v[68:71]
    ds_read_b128 v[128:131], v8 offset:24576
    v_mfma_f32_16x16x32_bf16 v[68:71], v[140:143], v[220:223], v[68:71]
    ds_read_b128 v[132:135], v9 offset:24576
    s_waitcnt lgkmcnt(4)
    v_mfma_f32_16x16x32_bf16 v[68:71], v[112:115], v[224:227], v[68:71]
    ds_read_b128 v[136:139], v10 offset:24576
    v_mfma_f32_16x16x32_bf16 v[68:71], v[116:119], v[228:231], v[68:71]
    ds_read_b128 v[140:143], v11 offset:24576
    s_waitcnt lgkmcnt(4)
    v_mfma_f32_16x16x32_bf16 v[68:71], v[120:123], v[232:235], v[68:71]
    ds_read_b128 v[112:115], v8 offset:24832
    v_mfma_f32_16x16x32_bf16 v[68:71], v[124:127], v[236:239], v[68:71]
    ds_read_b128 v[116:119], v9 offset:24832
    v_fma_f32 v100, -v100, v29, v48
    v_fma_f32 v101, -v101, v29, v48
    v_fma_f32 v102, -v102, v29, v48
    v_fma_f32 v103, -v103, v29, v48
    v_add_f32 v100, v100, v64
    v_add_f32 v101, v101, v65
    v_add_f32 v102, v102, v66
    v_add_f32 v103, v103, v67
    v_mul_f32 v100, v100, v96
    v_mul_f32 v101, v101, v97
    v_mul_f32 v102, v102, v98
    v_mul_f32 v103, v103, v99
    v_max3_f32 v27, v100, v101, v102
    v_max_f32 v27, v27, v103
    v_mov_b32 v26, v27
    s_nop 1
    v_permlane16_swap_b32 v26, v27
    v_max_f32 v27, v27, v26
    v_mov_b32 v26, v27
    s_nop 1
    v_permlane32_swap_b32 v26, v27
    v_max_f32 v27, v27, v26
    v_sub_f32 v100, v100, v27
    v_sub_f32 v101, v101, v27
    v_sub_f32 v102, v102, v27
    v_sub_f32 v103, v103, v27
    v_exp_f32 v100, v100
    v_exp_f32 v101, v101
    v_exp_f32 v102, v102
    v_exp_f32 v103, v103
    v_mul_f32 v96, v96, v100
    v_mul_f32 v97, v97, v101
    v_mul_f32 v98, v98, v102
    v_mul_f32 v99, v99, v103
    v_add_f32 v100, v100, v101
    v_add_f32 v102, v102, v103
    v_add_f32 v30, v100, v102
    v_cvt_pk_bf16_f32 v102, v96, v97
    v_cvt_pk_bf16_f32 v103, v98, v99
    v_add_f32 v96, v96, v97
    v_add_f32 v98, v98, v99
    ds_write_b64 v16, v[102:103]
    v_add_f32 v32, v96, v98
    ds_read_b128 v[96:99], v21 offset:128
    ds_read_b128 v[100:103], v21 offset:384
    s_waitcnt lgkmcnt(7)
    v_mfma_f32_16x16x32_bf16 v[72:75], v[128:131], v[192:195], 0
    ds_read_b128 v[120:123], v10 offset:24832
    v_mfma_f32_16x16x32_bf16 v[72:75], v[132:135], v[196:199], v[72:75]
    ds_read_b128 v[124:127], v11 offset:24832
    s_waitcnt lgkmcnt(7)
    v_mfma_f32_16x16x32_bf16 v[72:75], v[136:139], v[200:203], v[72:75]
    ds_read_b128 v[128:131], v8 offset:25088
    v_mfma_f32_16x16x32_bf16 v[72:75], v[140:143], v[204:207], v[72:75]
    ds_read_b128 v[132:135], v9 offset:25088
    s_waitcnt lgkmcnt(7)
    v_mfma_f32_16x16x32_bf16 v[72:75], v[112:115], v[208:211], v[72:75]
    ds_read_b128 v[136:139], v10 offset:25088
    v_mfma_f32_16x16x32_bf16 v[72:75], v[116:119], v[212:215], v[72:75]
    ds_read_b128 v[140:143], v11 offset:25088
    s_waitcnt lgkmcnt(4)
    v_mfma_f32_16x16x32_bf16 v[72:75], v[120:123], v[216:219], v[72:75]
    ds_read_b128 v[112:115], v8 offset:36864
    v_mfma_f32_16x16x32_bf16 v[72:75], v[124:127], v[220:223], v[72:75]
    ds_read_b128 v[116:119], v9 offset:36864
    s_waitcnt lgkmcnt(4)
    v_mfma_f32_16x16x32_bf16 v[72:75], v[128:131], v[224:227], v[72:75]
    ds_read_b128 v[120:123], v10 offset:36864
    v_mfma_f32_16x16x32_bf16 v[72:75], v[132:135], v[228:231], v[72:75]
    ds_read_b128 v[124:127], v11 offset:36864
    s_waitcnt lgkmcnt(4)
    v_mfma_f32_16x16x32_bf16 v[72:75], v[136:139], v[232:235], v[72:75]
    ds_read_b128 v[128:131], v8 offset:37120
    v_mfma_f32_16x16x32_bf16 v[72:75], v[140:143], v[236:239], v[72:75]
    ds_read_b128 v[132:135], v9 offset:37120
    v_fma_f32 v108, -v108, v29, v52
    v_fma_f32 v109, -v109, v29, v52
    v_fma_f32 v110, -v110, v29, v52
    v_fma_f32 v111, -v111, v29, v52
    v_add_f32 v108, v108, v68
    v_add_f32 v109, v109, v69
    v_add_f32 v110, v110, v70
    v_add_f32 v111, v111, v71
    v_fma_f32 v108, v108, v104, -v27
    v_fma_f32 v109, v109, v105, -v27
    v_fma_f32 v110, v110, v106, -v27
    v_fma_f32 v111, v111, v107, -v27
    v_exp_f32 v108, v108
    v_exp_f32 v109, v109
    v_exp_f32 v110, v110
    v_exp_f32 v111, v111
    v_mul_f32 v104, v104, v108
    v_mul_f32 v105, v105, v109
    v_mul_f32 v106, v106, v110
    v_mul_f32 v107, v107, v111
    v_add_f32 v108, v108, v109
    v_add_f32 v110, v110, v111
    v_add_f32 v108, v108, v110
    v_add_f32 v30, v30, v108
    v_cvt_pk_bf16_f32 v110, v104, v105
    v_cvt_pk_bf16_f32 v111, v106, v107
    v_add_f32 v104, v104, v105
    v_add_f32 v106, v106, v107
    ds_write_b64 v17, v[110:111]
    v_add_f32 v33, v104, v106
    ds_read_b128 v[104:107], v21 offset:192
    ds_read_b128 v[108:111], v21 offset:448
    s_waitcnt lgkmcnt(7)
    v_mfma_f32_16x16x32_bf16 v[76:79], v[112:115], v[192:195], 0
    ds_read_b128 v[136:139], v10 offset:37120
    v_mfma_f32_16x16x32_bf16 v[76:79], v[116:119], v[196:199], v[76:79]
    ds_read_b128 v[140:143], v11 offset:37120
    s_waitcnt lgkmcnt(7)
    v_mfma_f32_16x16x32_bf16 v[76:79], v[120:123], v[200:203], v[76:79]
    ds_read_b128 v[112:115], v8 offset:37376
    v_mfma_f32_16x16x32_bf16 v[76:79], v[124:127], v[204:207], v[76:79]
    ds_read_b128 v[116:119], v9 offset:37376
    s_waitcnt lgkmcnt(7)
    v_mfma_f32_16x16x32_bf16 v[76:79], v[128:131], v[208:211], v[76:79]
    ds_read_b128 v[120:123], v10 offset:37376
    v_mfma_f32_16x16x32_bf16 v[76:79], v[132:135], v[212:215], v[76:79]
    ds_read_b128 v[124:127], v11 offset:37376
    s_waitcnt lgkmcnt(4)
    v_mfma_f32_16x16x32_bf16 v[76:79], v[136:139], v[216:219], v[76:79]
    v_mfma_f32_16x16x32_bf16 v[76:79], v[140:143], v[220:223], v[76:79]
    v_add_u32 v8, 0x10000, v8
    s_waitcnt lgkmcnt(3)
    v_mfma_f32_16x16x32_bf16 v[76:79], v[112:115], v[224:227], v[76:79]
    v_add_u32 v9, 0x10000, v9
    s_waitcnt lgkmcnt(2)
    v_mfma_f32_16x16x32_bf16 v[76:79], v[116:119], v[228:231], v[76:79]
    v_add_u32 v10, 0x10000, v10
    s_waitcnt lgkmcnt(1)
    v_mfma_f32_16x16x32_bf16 v[76:79], v[120:123], v[232:235], v[76:79]
    v_add_u32 v11, 0x10000, v11
    s_waitcnt lgkmcnt(0)
    v_mfma_f32_16x16x32_bf16 v[76:79], v[124:127], v[236:239], v[76:79]
    v_fma_f32 v100, -v100, v29, v56
    v_fma_f32 v101, -v101, v29, v56
    v_fma_f32 v102, -v102, v29, v56
    v_fma_f32 v103, -v103, v29, v56
    v_add_f32 v100, v100, v72
    v_add_f32 v101, v101, v73
    v_add_f32 v102, v102, v74
    v_add_f32 v103, v103, v75
    v_fma_f32 v100, v100, v96, -v27
    v_fma_f32 v101, v101, v97, -v27
    v_fma_f32 v102, v102, v98, -v27
    v_fma_f32 v103, v103, v99, -v27
    v_exp_f32 v100, v100
    v_exp_f32 v101, v101
    v_exp_f32 v102, v102
    v_exp_f32 v103, v103
    v_mul_f32 v96, v96, v100
    v_mul_f32 v97, v97, v101
    v_mul_f32 v98, v98, v102
    v_mul_f32 v99, v99, v103
    v_add_f32 v100, v100, v101
    v_add_f32 v102, v102, v103
    v_add_f32 v100, v100, v102
    v_add_f32 v30, v30, v100
    v_cvt_pk_bf16_f32 v102, v96, v97
    v_cvt_pk_bf16_f32 v103, v98, v99
    v_add_f32 v96, v96, v97
    v_add_f32 v98, v98, v99
    ds_write_b64 v18, v[102:103]
    v_add_f32 v34, v96, v98
    v_fma_f32 v108, -v108, v29, v60
    v_fma_f32 v109, -v109, v29, v60
    v_fma_f32 v110, -v110, v29, v60
    v_fma_f32 v111, -v111, v29, v60
    v_add_f32 v108, v108, v76
    v_add_f32 v109, v109, v77
    v_add_f32 v110, v110, v78
    v_add_f32 v111, v111, v79
    v_fma_f32 v108, v108, v104, -v27
    v_fma_f32 v109, v109, v105, -v27
    v_fma_f32 v110, v110, v106, -v27
    v_fma_f32 v111, v111, v107, -v27
    v_exp_f32 v108, v108
    v_exp_f32 v109, v109
    v_exp_f32 v110, v110
    v_exp_f32 v111, v111
    v_mul_f32 v104, v104, v108
    v_mul_f32 v105, v105, v109
    v_mul_f32 v106, v106, v110
    v_mul_f32 v107, v107, v111
    v_add_f32 v108, v108, v109
    v_add_f32 v110, v110, v111
    v_add_f32 v108, v108, v110
    v_add_f32 v30, v30, v108
    v_cvt_pk_bf16_f32 v110, v104, v105
    v_cvt_pk_bf16_f32 v111, v106, v107
    v_add_f32 v104, v104, v105
    v_add_f32 v106, v106, v107
    ds_write_b64 v19, v[110:111]
    v_add_f32 v35, v104, v106
    v_cmp_nge_f32 vcc, s91, v30
    v_cvt_pk_bf16_f32 v32, v32, v33
    v_cvt_pk_bf16_f32 v33, v34, v35
    ds_write_b64 v20, v[32:33]
    s_cbranch_vccnz L_rare_28
L_back_29:
    v_add_f32 v28, v28, v30
    s_waitcnt lgkmcnt(0)
    s_barrier
    ds_read_b128 v[112:115], v12
    ds_read_b128 v[116:119], v13
    ds_read_b128 v[120:123], v14
    ds_read_b128 v[124:127], v15
    ds_read_b128 v[128:131], v12 offset:256
    ds_read_b128 v[132:135], v13 offset:256
    s_waitcnt lgkmcnt(4)
    v_mfma_f32_16x16x32_bf16 v[80:83], v[112:115], v[112:115], 0
    ds_read_b128 v[136:139], v14 offset:256
    v_mfma_f32_16x16x32_bf16 v[84:87], v[144:147], v[112:115], 0
    v_mfma_f32_16x16x32_bf16 v[80:83], v[116:119], v[116:119], v[80:83]
    ds_read_b128 v[140:143], v15 offset:256
    v_mfma_f32_16x16x32_bf16 v[84:87], v[148:151], v[116:119], v[84:87]
    s_waitcnt lgkmcnt(4)
    v_mfma_f32_16x16x32_bf16 v[80:83], v[120:123], v[120:123], v[80:83]
    ds_read_b128 v[112:115], v12 offset:512
    v_mfma_f32_16x16x32_bf16 v[84:87], v[152:155], v[120:123], v[84:87]
    v_mfma_f32_16x16x32_bf16 v[80:83], v[124:127], v[124:127], v[80:83]
    ds_read_b128 v[116:119], v13 offset:512
    v_mfma_f32_16x16x32_bf16 v[84:87], v[156:159], v[124:127], v[84:87]
    s_waitcnt lgkmcnt(4)
    v_mfma_f32_16x16x32_bf16 v[80:83], v[128:131], v[128:131], v[80:83]
    ds_read_b128 v[120:123], v14 offset:512
    v_mfma_f32_16x16x32_bf16 v[84:87], v[160:163], v[128:131], v[84:87]
    v_mfma_f32_16x16x32_bf16 v[80:83], v[132:135], v[132:135], v[80:83]
    ds_read_b128 v[124:127], v15 offset:512
    v_mfma_f32_16x16x32_bf16 v[84:87], v[164:167], v[132:135], v[84:87]
    s_waitcnt lgkmcnt(4)
    v_mfma_f32_16x16x32_bf16 v[80:83], v[136:139], v[136:139], v[80:83]
    ds_read_b128 v[128:131], v8
    v_mfma_f32_16x16x32_bf16 v[84:87], v[168:171], v[136:139], v[84:87]
    v_mfma_f32_16x16x32_bf16 v[80:83], v[140:143], v[140:143], v[80:83]
    ds_read_b128 v[132:135], v9
    v_mfma_f32_16x16x32_bf16 v[84:87], v[172:175], v[140:143], v[84:87]
    s_waitcnt lgkmcnt(4)
    v_mfma_f32_16x16x32_bf16 v[80:83], v[112:115], v[112:115], v[80:83]
    ds_read_b128 v[136:139], v10
    v_mfma_f32_16x16x32_bf16 v[84:87], v[176:179], v[112:115], v[84:87]
    v_mfma_f32_16x16x32_bf16 v[80:83], v[116:119], v[116:119], v[80:83]
    ds_read_b128 v[140:143], v11
    v_mfma_f32_16x16x32_bf16 v[84:87], v[180:183], v[116:119], v[84:87]
    s_waitcnt lgkmcnt(4)
    v_mfma_f32_16x16x32_bf16 v[80:83], v[120:123], v[120:123], v[80:83]
    ds_read_b128 v[112:115], v8 offset:256
    v_mfma_f32_16x16x32_bf16 v[84:87], v[184:187], v[120:123], v[84:87]
    v_mfma_f32_16x16x32_bf16 v[80:83], v[124:127], v[124:127], v[80:83]
    ds_read_b128 v[116:119], v9 offset:256
    v_mfma_f32_16x16x32_bf16 v[84:87], v[188:191], v[124:127], v[84:87]
    s_waitcnt lgkmcnt(4)
    v_mfma_f32_16x16x32_bf16 v[64:67], v[128:131], v[192:195], 0
    ds_read_b128 v[120:123], v10 offset:256
    v_mfma_f32_16x16x32_bf16 v[64:67], v[132:135], v[196:199], v[64:67]
    ds_read_b128 v[124:127], v11 offset:256
    s_waitcnt lgkmcnt(4)
    v_mfma_f32_16x16x32_bf16 v[64:67], v[136:139], v[200:203], v[64:67]
    ds_read_b128 v[128:131], v8 offset:512
    v_mfma_f32_16x16x32_bf16 v[64:67], v[140:143], v[204:207], v[64:67]
    ds_read_b128 v[132:135], v9 offset:512
    v_cndmask_b32 v24, v80, v81, s[92:93]
    v_cndmask_b32 v25, v82, v83, s[96:97]
    v_add_f32 v31, v84, v45
    v_cndmask_b32 v24, v24, v25, s[94:95]
    v_mul_f32 v31, s89, v31
    v_fma_f32 v24, v85, 2.0, v24
    v_add_f32 v24, v24, v41
    v_mul_f32 v25, v31, v31
    v_fma_f32 v24, v24, s89, -v25
    v_max_f32 v24, 0, v24
    v_add_f32 v24, s90, v24
    v_rsq_f32 v24, v24
    ds_write_b32 v22, v31 offset:256
    ds_write_b32 v22, v24
    s_waitcnt lgkmcnt(6)
    v_mfma_f32_16x16x32_bf16 v[64:67], v[112:115], v[208:211], v[64:67]
    ds_read_b128 v[136:139], v10 offset:512
    v_mfma_f32_16x16x32_bf16 v[64:67], v[116:119], v[212:215], v[64:67]
    ds_read_b128 v[140:143], v11 offset:512
    s_waitcnt lgkmcnt(6)
    v_mfma_f32_16x16x32_bf16 v[64:67], v[120:123], v[216:219], v[64:67]
    ds_read_b128 v[112:115], v8 offset:12288
    v_mfma_f32_16x16x32_bf16 v[64:67], v[124:127], v[220:223], v[64:67]
    ds_read_b128 v[116:119], v9 offset:12288
    s_waitcnt lgkmcnt(6)
    v_mfma_f32_16x16x32_bf16 v[64:67], v[128:131], v[224:227], v[64:67]
    ds_read_b128 v[120:123], v10 offset:12288
    v_mfma_f32_16x16x32_bf16 v[64:67], v[132:135], v[228:231], v[64:67]
    ds_read_b128 v[124:127], v11 offset:12288
    s_waitcnt lgkmcnt(4)
    v_mfma_f32_16x16x32_bf16 v[64:67], v[136:139], v[232:235], v[64:67]
    ds_read_b128 v[128:131], v8 offset:12544
    v_mfma_f32_16x16x32_bf16 v[64:67], v[140:143], v[236:239], v[64:67]
    ds_read_b128 v[132:135], v9 offset:12544
    s_barrier
    ds_read_b128 v[96:99], v21
    ds_read_b128 v[100:103], v21 offset:256
    ds_read_b128 v[104:107], v21 offset:64
    ds_read_b128 v[108:111], v21 offset:320
    s_waitcnt lgkmcnt(8)
    v_mfma_f32_16x16x32_bf16 v[68:71], v[112:115], v[192:195], 0
    ds_read_b128 v[136:139], v10 offset:12544
    v_add_u32 v12, 0xc000, v12
    v_mfma_f32_16x16x32_bf16 v[68:71], v[116:119], v[196:199], v[68:71]
    ds_read_b128 v[140:143], v11 offset:12544
    v_add_u32 v13, 0xc000, v13
    s_waitcnt lgkmcnt(8)
    v_mfma_f32_16x16x32_bf16 v[68:71], v[120:123], v[200:203], v[68:71]
    ds_read_b128 v[112:115], v8 offset:12800
    v_add_u32 v14, 0xc000, v14
    v_mfma_f32_16x16x32_bf16 v[68:71], v[124:127], v[204:207], v[68:71]
    ds_read_b128 v[116:119], v9 offset:12800
    v_add_u32 v15, 0xc000, v15
    s_waitcnt lgkmcnt(8)
    v_mfma_f32_16x16x32_bf16 v[68:71], v[128:131], v[208:211], v[68:71]
    ds_read_b128 v[120:123], v10 offset:12800
    v_mfma_f32_16x16x32_bf16 v[68:71], v[132:135], v[212:215], v[68:71]
    ds_read_b128 v[124:127], v11 offset:12800
    s_waitcnt lgkmcnt(4)
    v_mfma_f32_16x16x32_bf16 v[68:71], v[136:139], v[216:219], v[68:71]
    ds_read_b128 v[128:131], v8 offset:24576
    v_mfma_f32_16x16x32_bf16 v[68:71], v[140:143], v[220:223], v[68:71]
    ds_read_b128 v[132:135], v9 offset:24576
    s_waitcnt lgkmcnt(4)
    v_mfma_f32_16x16x32_bf16 v[68:71], v[112:115], v[224:227], v[68:71]
    ds_read_b128 v[136:139], v10 offset:24576
    v_mfma_f32_16x16x32_bf16 v[68:71], v[116:119], v[228:231], v[68:71]
    ds_read_b128 v[140:143], v11 offset:24576
    s_waitcnt lgkmcnt(4)
    v_mfma_f32_16x16x32_bf16 v[68:71], v[120:123], v[232:235], v[68:71]
    ds_read_b128 v[112:115], v8 offset:24832
    v_mfma_f32_16x16x32_bf16 v[68:71], v[124:127], v[236:239], v[68:71]
    ds_read_b128 v[116:119], v9 offset:24832
    v_fma_f32 v100, -v100, v29, v49
    v_fma_f32 v101, -v101, v29, v49
    v_fma_f32 v102, -v102, v29, v49
    v_fma_f32 v103, -v103, v29, v49
    v_add_f32 v100, v100, v64
    s_cmp_lg_u32 s0, 0
    s_cbranch_scc1 L_fv_30
L_fvb_31:
    v_add_f32 v101, v101, v65
    v_add_f32 v102, v102, v66
    v_add_f32 v103, v103, v67
    v_fma_f32 v100, v100, v96, -v27
    v_fma_f32 v101, v101, v97, -v27
    s_add_u32 s42, s58, 0
    buffer_load_dwordx4 v[240:243], v23, s[20:23], s42 offen
    v_fma_f32 v102, v102, v98, -v27
    v_fma_f32 v103, v103, v99, -v27
    v_exp_f32 v100, v100
    v_exp_f32 v101, v101
    v_exp_f32 v102, v102
    buffer_load_dwordx4 v[244:247], v23, s[20:23], s42 offen offset:1024
    v_exp_f32 v103, v103
    v_mul_f32 v96, v96, v100
    v_mul_f32 v97, v97, v101
    v_mul_f32 v98, v98, v102
    v_mul_f32 v99, v99, v103
    buffer_load_dwordx4 v[248:251], v23, s[20:23], s42 offen offset:2048
    v_add_f32 v100, v100, v101
    v_add_f32 v102, v102, v103
    v_add_f32 v30, v100, v102
    v_cvt_pk_bf16_f32 v102, v96, v97
    v_cvt_pk_bf16_f32 v103, v98, v99
    v_add_f32 v96, v96, v97
    v_add_f32 v98, v98, v99
    ds_write_b64 v16, v[102:103]
    v_add_f32 v32, v96, v98
    ds_read_b128 v[96:99], v21 offset:128
    ds_read_b128 v[100:103], v21 offset:384
    s_waitcnt lgkmcnt(7)
    v_mfma_f32_16x16x32_bf16 v[72:75], v[128:131], v[192:195], 0
    ds_read_b128 v[120:123], v10 offset:24832
    v_mfma_f32_16x16x32_bf16 v[72:75], v[132:135], v[196:199], v[72:75]
    ds_read_b128 v[124:127], v11 offset:24832
    s_waitcnt lgkmcnt(7)
    v_mfma_f32_16x16x32_bf16 v[72:75], v[136:139], v[200:203], v[72:75]
    ds_read_b128 v[128:131], v8 offset:25088
    v_mfma_f32_16x16x32_bf16 v[72:75], v[140:143], v[204:207], v[72:75]
    ds_read_b128 v[132:135], v9 offset:25088
    s_waitcnt lgkmcnt(7)
    v_mfma_f32_16x16x32_bf16 v[72:75], v[112:115], v[208:211], v[72:75]
    ds_read_b128 v[136:139], v10 offset:25088
    v_mfma_f32_16x16x32_bf16 v[72:75], v[116:119], v[212:215], v[72:75]
    ds_read_b128 v[140:143], v11 offset:25088
    s_waitcnt lgkmcnt(4)
    v_mfma_f32_16x16x32_bf16 v[72:75], v[120:123], v[216:219], v[72:75]
    ds_read_b128 v[112:115], v8 offset:36864
    v_mfma_f32_16x16x32_bf16 v[72:75], v[124:127], v[220:223], v[72:75]
    ds_read_b128 v[116:119], v9 offset:36864
    s_waitcnt lgkmcnt(4)
    v_mfma_f32_16x16x32_bf16 v[72:75], v[128:131], v[224:227], v[72:75]
    ds_read_b128 v[120:123], v10 offset:36864
    v_mfma_f32_16x16x32_bf16 v[72:75], v[132:135], v[228:231], v[72:75]
    ds_read_b128 v[124:127], v11 offset:36864
    s_waitcnt lgkmcnt(4)
    v_mfma_f32_16x16x32_bf16 v[72:75], v[136:139], v[232:235], v[72:75]
    ds_read_b128 v[128:131], v8 offset:37120
    v_mfma_f32_16x16x32_bf16 v[72:75], v[140:143], v[236:239], v[72:75]
    ds_read_b128 v[132:135], v9 offset:37120
    v_fma_f32 v108, -v108, v29, v53
    v_fma_f32 v109, -v109, v29, v53
    v_fma_f32 v110, -v110, v29, v53
    v_fma_f32 v111, -v111, v29, v53
    v_add_f32 v108, v108, v68
    buffer_load_dwordx4 v[252:255], v23, s[20:23], s42 offen offset:3072
    v_add_f32 v109, v109, v69
    v_add_f32 v110, v110, v70
    v_add_f32 v111, v111, v71
    v_fma_f32 v108, v108, v104, -v27
    v_fma_f32 v109, v109, v105, -v27
    s_add_u32 s42, s58, 0x1000
    buffer_load_dwordx4 v[88:91], v23, s[20:23], s42 offen
    v_fma_f32 v110, v110, v106, -v27
    v_fma_f32 v111, v111, v107, -v27
    v_exp_f32 v108, v108
    v_exp_f32 v109, v109
    v_exp_f32 v110, v110
    buffer_load_dwordx4 v[92:95], v23, s[20:23], s42 offen offset:1024
    v_exp_f32 v111, v111
    v_mul_f32 v104, v104, v108
    v_mul_f32 v105, v105, v109
    v_mul_f32 v106, v106, v110
    v_mul_f32 v107, v107, v111
    s_mov_b32 s28, s78
    s_and_b32 s29, s79, 0xffff
    s_mov_b32 s30, 0x48000
    s_mov_b32 s31, 0x20000
    v_min_u32 v26, 17, v1
    s_mul_i32 s4, s3, 18
    v_add_u32 v26, s4, v26
    v_lshlrev_b32 v26, 7, v26
    s_lshr_b32 s4, s2, 3
    s_mul_i32 s4, s4, 0x2400
    buffer_load_dword v40, v26, s[28:31], s4 offen
    v_add_f32 v108, v108, v109
    v_add_f32 v110, v110, v111
    v_add_f32 v108, v108, v110
    v_add_f32 v30, v30, v108
    v_cvt_pk_bf16_f32 v110, v104, v105
    v_cvt_pk_bf16_f32 v111, v106, v107
    v_add_f32 v104, v104, v105
    v_add_f32 v106, v106, v107
    ds_write_b64 v17, v[110:111]
    v_add_f32 v33, v104, v106
    ds_read_b128 v[104:107], v21 offset:192
    ds_read_b128 v[108:111], v21 offset:448
    s_waitcnt lgkmcnt(7)
    v_mfma_f32_16x16x32_bf16 v[76:79], v[112:115], v[192:195], 0
    ds_read_b128 v[136:139], v10 offset:37120
    v_mfma_f32_16x16x32_bf16 v[76:79], v[116:119], v[196:199], v[76:79]
    ds_read_b128 v[140:143], v11 offset:37120
    s_waitcnt lgkmcnt(7)
    v_mfma_f32_16x16x32_bf16 v[76:79], v[120:123], v[200:203], v[76:79]
    ds_read_b128 v[112:115], v8 offset:37376
    v_mfma_f32_16x16x32_bf16 v[76:79], v[124:127], v[204:207], v[76:79]
    ds_read_b128 v[116:119], v9 offset:37376
    s_waitcnt lgkmcnt(7)
    v_mfma_f32_16x16x32_bf16 v[76:79], v[128:131], v[208:211], v[76:79]
    ds_read_b128 v[120:123], v10 offset:37376
    v_mfma_f32_16x16x32_bf16 v[76:79], v[132:135], v[212:215], v[76:79]
    ds_read_b128 v[124:127], v11 offset:37376
    s_waitcnt lgkmcnt(4)
    v_mfma_f32_16x16x32_bf16 v[76:79], v[136:139], v[216:219], v[76:79]
    v_mfma_f32_16x16x32_bf16 v[76:79], v[140:143], v[220:223], v[76:79]
    v_add_u32 v8, 0xc000, v8
    s_waitcnt lgkmcnt(3)
    v_mfma_f32_16x16x32_bf16 v[76:79], v[112:115], v[224:227], v[76:79]
    v_add_u32 v9, 0xc000, v9
    s_waitcnt lgkmcnt(2)
    v_mfma_f32_16x16x32_bf16 v[76:79], v[116:119], v[228:231], v[76:79]
    v_add_u32 v10, 0xc000, v10
    s_waitcnt lgkmcnt(1)
    v_mfma_f32_16x16x32_bf16 v[76:79], v[120:123], v[232:235], v[76:79]
    v_add_u32 v11, 0xc000, v11
    s_waitcnt lgkmcnt(0)
    v_mfma_f32_16x16x32_bf16 v[76:79], v[124:127], v[236:239], v[76:79]
    v_fma_f32 v100, -v100, v29, v57
    v_fma_f32 v101, -v101, v29, v57
    v_fma_f32 v102, -v102, v29, v57
    v_fma_f32 v103, -v103, v29, v57
    v_add_f32 v100, v100, v72
    v_add_f32 v101, v101, v73
    v_add_f32 v102, v102, v74
    v_add_f32 v103, v103, v75
    v_fma_f32 v100, v100, v96, -v27
    v_fma_f32 v101, v101, v97, -v27
    v_fma_f32 v102, v102, v98, -v27
    v_fma_f32 v103, v103, v99, -v27
    v_exp_f32 v100, v100
    v_exp_f32 v101, v101
    v_exp_f32 v102, v102
    v_exp_f32 v103, v103
    v_mul_f32 v96, v96, v100
    v_mul_f32 v97, v97, v101
    v_mul_f32 v98, v98, v102
    v_mul_f32 v99, v99, v103
    v_add_f32 v100, v100, v101
    v_add_f32 v102, v102, v103
    v_add_f32 v100, v100, v102
    v_add_f32 v30, v30, v100
    v_cvt_pk_bf16_f32 v102, v96, v97
    v_cvt_pk_bf16_f32 v103, v98, v99
    v_add_f32 v96, v96, v97
    v_add_f32 v98, v98, v99
    ds_write_b64 v18, v[102:103]
    v_add_f32 v34, v96, v98
    v_fma_f32 v108, -v108, v29, v61
    v_fma_f32 v109, -v109, v29, v61
    v_fma_f32 v110, -v110, v29, v61
    v_fma_f32 v111, -v111, v29, v61
    v_add_f32 v108, v108, v76
    v_add_f32 v109, v109, v77
    v_add_f32 v110, v110, v78
    v_add_f32 v111, v111, v79
    v_fma_f32 v108, v108, v104, -v27
    v_fma_f32 v109, v109, v105, -v27
    v_fma_f32 v110, v110, v106, -v27
    v_fma_f32 v111, v111, v107, -v27
    v_exp_f32 v108, v108
    v_exp_f32 v109, v109
    v_exp_f32 v110, v110
    v_exp_f32 v111, v111
    v_mul_f32 v104, v104, v108
    v_mul_f32 v105, v105, v109
    v_mul_f32 v106, v106, v110
    v_mul_f32 v107, v107, v111
    v_add_f32 v108, v108, v109
    v_add_f32 v110, v110, v111
    v_add_f32 v108, v108, v110
    v_add_f32 v30, v30, v108
    v_cvt_pk_bf16_f32 v110, v104, v105
    v_cvt_pk_bf16_f32 v111, v106, v107
    v_add_f32 v104, v104, v105
    v_add_f32 v106, v106, v107
    ds_write_b64 v19, v[110:111]
    v_add_f32 v35, v104, v106
    v_cmp_nge_f32 vcc, s91, v30
    v_cvt_pk_bf16_f32 v32, v32, v33
    v_cvt_pk_bf16_f32 v33, v34, v35
    ds_write_b64 v20, v[32:33]
    s_cbranch_vccnz L_rare_32
L_back_33:
    v_add_f32 v28, v28, v30
    s_waitcnt lgkmcnt(0)
    s_barrier
    ds_read_b128 v[112:115], v12
    ds_read_b128 v[116:119], v13
    ds_read_b128 v[120:123], v14
    ds_read_b128 v[124:127], v15
    ds_read_b128 v[128:131], v12 offset:256
    ds_read_b128 v[132:135], v13 offset:256
    s_waitcnt lgkmcnt(4)
    v_mfma_f32_16x16x32_bf16 v[80:83], v[112:115], v[112:115], 0
    ds_read_b128 v[136:139], v14 offset:256
    v_mfma_f32_16x16x32_bf16 v[84:87], v[144:147], v[112:115], 0
    v_mfma_f32_16x16x32_bf16 v[80:83], v[116:119], v[116:119], v[80:83]
    ds_read_b128 v[140:143], v15 offset:256
    v_mfma_f32_16x16x32_bf16 v[84:87], v[148:151], v[116:119], v[84:87]
    s_waitcnt lgkmcnt(4)
    v_mfma_f32_16x16x32_bf16 v[80:83], v[120:123], v[120:123], v[80:83]
    ds_read_b128 v[112:115], v12 offset:512
    v_mfma_f32_16x16x32_bf16 v[84:87], v[152:155], v[120:123], v[84:87]
    v_mfma_f32_16x16x32_bf16 v[80:83], v[124:127], v[124:127], v[80:83]
    ds_read_b128 v[116:119], v13 offset:512
    v_mfma_f32_16x16x32_bf16 v[84:87], v[156:159], v[124:127], v[84:87]
    s_waitcnt lgkmcnt(4)
    v_mfma_f32_16x16x32_bf16 v[80:83], v[128:131], v[128:131], v[80:83]
    ds_read_b128 v[120:123], v14 offset:512
    v_mfma_f32_16x16x32_bf16 v[84:87], v[160:163], v[128:131], v[84:87]
    v_mfma_f32_16x16x32_bf16 v[80:83], v[132:135], v[132:135], v[80:83]
    ds_read_b128 v[124:127], v15 offset:512
    v_mfma_f32_16x16x32_bf16 v[84:87], v[164:167], v[132:135], v[84:87]
    s_waitcnt lgkmcnt(4)
    v_mfma_f32_16x16x32_bf16 v[80:83], v[136:139], v[136:139], v[80:83]
    ds_read_b128 v[128:131], v8
    v_mfma_f32_16x16x32_bf16 v[84:87], v[168:171], v[136:139], v[84:87]
    v_mfma_f32_16x16x32_bf16 v[80:83], v[140:143], v[140:143], v[80:83]
    ds_read_b128 v[132:135], v9
    v_mfma_f32_16x16x32_bf16 v[84:87], v[172:175], v[140:143], v[84:87]
    s_waitcnt lgkmcnt(4)
    v_mfma_f32_16x16x32_bf16 v[80:83], v[112:115], v[112:115], v[80:83]
    ds_read_b128 v[136:139], v10
    v_mfma_f32_16x16x32_bf16 v[84:87], v[176:179], v[112:115], v[84:87]
    v_mfma_f32_16x16x32_bf16 v[80:83], v[116:119], v[116:119], v[80:83]
    ds_read_b128 v[140:143], v11
    v_mfma_f32_16x16x32_bf16 v[84:87], v[180:183], v[116:119], v[84:87]
    s_waitcnt lgkmcnt(4)
    v_mfma_f32_16x16x32_bf16 v[80:83], v[120:123], v[120:123], v[80:83]
    ds_read_b128 v[112:115], v8 offset:256
    v_mfma_f32_16x16x32_bf16 v[84:87], v[184:187], v[120:123], v[84:87]
    v_mfma_f32_16x16x32_bf16 v[80:83], v[124:127], v[124:127], v[80:83]
    ds_read_b128 v[116:119], v9 offset:256
    v_mfma_f32_16x16x32_bf16 v[84:87], v[188:191], v[124:127], v[84:87]
    s_waitcnt lgkmcnt(4)
    v_mfma_f32_16x16x32_bf16 v[64:67], v[128:131], v[192:195], 0
    ds_read_b128 v[120:123], v10 offset:256
    v_mfma_f32_16x16x32_bf16 v[64:67], v[132:135], v[196:199], v[64:67]
    ds_read_b128 v[124:127], v11 offset:256
    s_waitcnt lgkmcnt(4)
    v_mfma_f32_16x16x32_bf16 v[64:67], v[136:139], v[200:203], v[64:67]
    ds_read_b128 v[128:131], v8 offset:512
    v_mfma_f32_16x16x32_bf16 v[64:67], v[140:143], v[204:207], v[64:67]
    ds_read_b128 v[132:135], v9 offset:512
    v_cndmask_b32 v24, v80, v81, s[92:93]
    v_cndmask_b32 v25, v82, v83, s[96:97]
    v_add_f32 v31, v84, v46
    v_cndmask_b32 v24, v24, v25, s[94:95]
    v_mul_f32 v31, s89, v31
    v_fma_f32 v24, v86, 2.0, v24
    v_add_f32 v24, v24, v42
    v_mul_f32 v25, v31, v31
    v_fma_f32 v24, v24, s89, -v25
    v_max_f32 v24, 0, v24
    v_add_f32 v24, s90, v24
    v_rsq_f32 v24, v24
    ds_write_b32 v22, v31 offset:256
    ds_write_b32 v22, v24
    s_waitcnt lgkmcnt(6)
    v_mfma_f32_16x16x32_bf16 v[64:67], v[112:115], v[208:211], v[64:67]
    ds_read_b128 v[136:139], v10 offset:512
    v_mfma_f32_16x16x32_bf16 v[64:67], v[116:119], v[212:215], v[64:67]
    ds_read_b128 v[140:143], v11 offset:512
    s_waitcnt lgkmcnt(6)
    v_mfma_f32_16x16x32_bf16 v[64:67], v[120:123], v[216:219], v[64:67]
    ds_read_b128 v[112:115], v8 offset:12288
    v_mfma_f32_16x16x32_bf16 v[64:67], v[124:127], v[220:223], v[64:67]
    ds_read_b128 v[116:119], v9 offset:12288
    s_waitcnt lgkmcnt(6)
    v_mfma_f32_16x16x32_bf16 v[64:67], v[128:131], v[224:227], v[64:67]
    ds_read_b128 v[120:123], v10 offset:12288
    v_mfma_f32_16x16x32_bf16 v[64:67], v[132:135], v[228:231], v[64:67]
    ds_read_b128 v[124:127], v11 offset:12288
    s_waitcnt lgkmcnt(4)
    v_mfma_f32_16x16x32_bf16 v[64:67], v[136:139], v[232:235], v[64:67]
    ds_read_b128 v[128:131], v8 offset:12544
    v_mfma_f32_16x16x32_bf16 v[64:67], v[140:143], v[236:239], v[64:67]
    ds_read_b128 v[132:135], v9 offset:12544
    s_barrier
    ds_read_b128 v[96:99], v21
    ds_read_b128 v[100:103], v21 offset:256
    ds_read_b128 v[104:107], v21 offset:64
    ds_read_b128 v[108:111], v21 offset:320
    s_waitcnt lgkmcnt(8)
    v_mfma_f32_16x16x32_bf16 v[68:71], v[112:115], v[192:195], 0
    ds_read_b128 v[136:139], v10 offset:12544
    v_add_u32 v12, 0xfffe4000, v12
    v_mfma_f32_16x16x32_bf16 v[68:71], v[116:119], v[196:199], v[68:71]
    ds_read_b128 v[140:143], v11 offset:12544
    v_add_u32 v13, 0xfffe4000, v13
    s_waitcnt lgkmcnt(8)
    v_mfma_f32_16x16x32_bf16 v[68:71], v[120:123], v[200:203], v[68:71]
    ds_read_b128 v[112:115], v8 offset:12800
    v_add_u32 v14, 0xfffe4000, v14
    v_mfma_f32_16x16x32_bf16 v[68:71], v[124:127], v[204:207], v[68:71]
    ds_read_b128 v[116:119], v9 offset:12800
    v_add_u32 v15, 0xfffe4000, v15
    s_waitcnt lgkmcnt(8)
    v_mfma_f32_16x16x32_bf16 v[68:71], v[128:131], v[208:211], v[68:71]
    ds_read_b128 v[120:123], v10 offset:12800
    v_mfma_f32_16x16x32_bf16 v[68:71], v[132:135], v[212:215], v[68:71]
    ds_read_b128 v[124:127], v11 offset:12800
    s_waitcnt lgkmcnt(4)
    v_mfma_f32_16x16x32_bf16 v[68:71], v[136:139], v[216:219], v[68:71]
    ds_read_b128 v[128:131], v8 offset:24576
    v_mfma_f32_16x16x32_bf16 v[68:71], v[140:143], v[220:223], v[68:71]
    ds_read_b128 v[132:135], v9 offset:24576
    s_waitcnt lgkmcnt(4)
    v_mfma_f32_16x16x32_bf16 v[68:71], v[112:115], v[224:227], v[68:71]
    ds_read_b128 v[136:139], v10 offset:24576
    v_mfma_f32_16x16x32_bf16 v[68:71], v[116:119], v[228:231], v[68:71]
    ds_read_b128 v[140:143], v11 offset:24576
    s_waitcnt lgkmcnt(4)
    v_mfma_f32_16x16x32_bf16 v[68:71], v[120:123], v[232:235], v[68:71]
    ds_read_b128 v[112:115], v8 offset:24832
    v_mfma_f32_16x16x32_bf16 v[68:71], v[124:127], v[236:239], v[68:71]
    ds_read_b128 v[116:119], v9 offset:24832
    v_fma_f32 v100, -v100, v29, v50
    v_fma_f32 v101, -v101, v29, v50
    v_fma_f32 v102, -v102, v29, v50
    v_fma_f32 v103, -v103, v29, v50
    v_add_f32 v100, v100, v64
    v_add_f32 v101, v101, v65
    v_add_f32 v102, v102, v66
    v_add_f32 v103, v103, v67
    v_fma_f32 v100, v100, v96, -v27
    v_fma_f32 v101, v101, v97, -v27
    v_fma_f32 v102, v102, v98, -v27
    v_fma_f32 v103, v103, v99, -v27
    v_exp_f32 v100, v100
    v_exp_f32 v101, v101
    v_exp_f32 v102, v102
    v_exp_f32 v103, v103
    v_mul_f32 v96, v96, v100
    v_mul_f32 v97, v97, v101
    v_mul_f32 v98, v98, v102
    v_mul_f32 v99, v99, v103
    v_add_f32 v100, v100, v101
    v_add_f32 v102, v102, v103
    v_add_f32 v30, v100, v102
    v_cvt_pk_bf16_f32 v102, v96, v97
    v_cvt_pk_bf16_f32 v103, v98, v99
    v_add_f32 v96, v96, v97
    v_add_f32 v98, v98, v99
    ds_write_b64 v16, v[102:103]
    v_add_f32 v32, v96, v98
    ds_read_b128 v[96:99], v21 offset:128
    ds_read_b128 v[100:103], v21 offset:384
    s_waitcnt lgkmcnt(7)
    v_mfma_f32_16x16x32_bf16 v[72:75], v[128:131], v[192:195], 0
    ds_read_b128 v[120:123], v10 offset:24832
    v_mfma_f32_16x16x32_bf16 v[72:75], v[132:135], v[196:199], v[72:75]
    ds_read_b128 v[124:127], v11 offset:24832
    s_waitcnt lgkmcnt(7)
    v_mfma_f32_16x16x32_bf16 v[72:75], v[136:139], v[200:203], v[72:75]
    ds_read_b128 v[128:131], v8 offset:25088
    v_mfma_f32_16x16x32_bf16 v[72:75], v[140:143], v[204:207], v[72:75]
    ds_read_b128 v[132:135], v9 offset:25088
    s_waitcnt lgkmcnt(7)
    v_mfma_f32_16x16x32_bf16 v[72:75], v[112:115], v[208:211], v[72:75]
    ds_read_b128 v[136:139], v10 offset:25088
    v_mfma_f32_16x16x32_bf16 v[72:75], v[116:119], v[212:215], v[72:75]
    ds_read_b128 v[140:143], v11 offset:25088
    s_waitcnt lgkmcnt(4)
    v_mfma_f32_16x16x32_bf16 v[72:75], v[120:123], v[216:219], v[72:75]
    ds_read_b128 v[112:115], v8 offset:36864
    v_mfma_f32_16x16x32_bf16 v[72:75], v[124:127], v[220:223], v[72:75]
    ds_read_b128 v[116:119], v9 offset:36864
    s_waitcnt lgkmcnt(4)
    v_mfma_f32_16x16x32_bf16 v[72:75], v[128:131], v[224:227], v[72:75]
    ds_read_b128 v[120:123], v10 offset:36864
    v_mfma_f32_16x16x32_bf16 v[72:75], v[132:135], v[228:231], v[72:75]
    ds_read_b128 v[124:127], v11 offset:36864
    s_waitcnt lgkmcnt(4)
    v_mfma_f32_16x16x32_bf16 v[72:75], v[136:139], v[232:235], v[72:75]
    ds_read_b128 v[128:131], v8 offset:37120
    v_mfma_f32_16x16x32_bf16 v[72:75], v[140:143], v[236:239], v[72:75]
    ds_read_b128 v[132:135], v9 offset:37120
    v_fma_f32 v108, -v108, v29, v54
    v_fma_f32 v109, -v109, v29, v54
    v_fma_f32 v110, -v110, v29, v54
    v_fma_f32 v111, -v111, v29, v54
    v_add_f32 v108, v108, v68
    v_add_f32 v109, v109, v69
    v_add_f32 v110, v110, v70
    v_add_f32 v111, v111, v71
    v_fma_f32 v108, v108, v104, -v27
    v_fma_f32 v109, v109, v105, -v27
    v_fma_f32 v110, v110, v106, -v27
    v_fma_f32 v111, v111, v107, -v27
    v_exp_f32 v108, v108
    v_exp_f32 v109, v109
    v_exp_f32 v110, v110
    v_exp_f32 v111, v111
    v_mul_f32 v104, v104, v108
    v_mul_f32 v105, v105, v109
    v_mul_f32 v106, v106, v110
    v_mul_f32 v107, v107, v111
    v_add_f32 v108, v108, v109
    v_add_f32 v110, v110, v111
    v_add_f32 v108, v108, v110
    v_add_f32 v30, v30, v108
    v_cvt_pk_bf16_f32 v110, v104, v105
    v_cvt_pk_bf16_f32 v111, v106, v107
    v_add_f32 v104, v104, v105
    v_add_f32 v106, v106, v107
    ds_write_b64 v17, v[110:111]
    v_add_f32 v33, v104, v106
    ds_read_b128 v[104:107], v21 offset:192
    ds_read_b128 v[108:111], v21 offset:448
    s_waitcnt lgkmcnt(7)
    v_mfma_f32_16x16x32_bf16 v[76:79], v[112:115], v[192:195], 0
    ds_read_b128 v[136:139], v10 offset:37120
    v_mfma_f32_16x16x32_bf16 v[76:79], v[116:119], v[196:199], v[76:79]
    ds_read_b128 v[140:143], v11 offset:37120
    s_waitcnt lgkmcnt(7)
    v_mfma_f32_16x16x32_bf16 v[76:79], v[120:123], v[200:203], v[76:79]
    ds_read_b128 v[112:115], v8 offset:37376
    v_mfma_f32_16x16x32_bf16 v[76:79], v[124:127], v[204:207], v[76:79]
    ds_read_b128 v[116:119], v9 offset:37376
    s_waitcnt lgkmcnt(7)
    v_mfma_f32_16x16x32_bf16 v[76:79], v[128:131], v[208:211], v[76:79]
    ds_read_b128 v[120:123], v10 offset:37376
    v_mfma_f32_16x16x32_bf16 v[76:79], v[132:135], v[212:215], v[76:79]
    ds_read_b128 v[124:127], v11 offset:37376
    s_waitcnt lgkmcnt(4)
    v_mfma_f32_16x16x32_bf16 v[76:79], v[136:139], v[216:219], v[76:79]
    v_mfma_f32_16x16x32_bf16 v[76:79], v[140:143], v[220:223], v[76:79]
    v_add_u32 v8, 0xfffe4000, v8
    s_waitcnt lgkmcnt(3)
    v_mfma_f32_16x16x32_bf16 v[76:79], v[112:115], v[224:227], v[76:79]
    v_add_u32 v9, 0xfffe4000, v9
    s_waitcnt lgkmcnt(2)
    v_mfma_f32_16x16x32_bf16 v[76:79], v[116:119], v[228:231], v[76:79]
    v_add_u32 v10, 0xfffe4000, v10
    s_waitcnt lgkmcnt(1)
    v_mfma_f32_16x16x32_bf16 v[76:79], v[120:123], v[232:235], v[76:79]
    v_add_u32 v11, 0xfffe4000, v11
    s_waitcnt lgkmcnt(0)
    v_mfma_f32_16x16x32_bf16 v[76:79], v[124:127], v[236:239], v[76:79]
    v_fma_f32 v100, -v100, v29, v58
    v_fma_f32 v101, -v101, v29, v58
    v_fma_f32 v102, -v102, v29, v58
    v_fma_f32 v103, -v103, v29, v58
    v_add_f32 v100, v100, v72
    v_add_f32 v101, v101, v73
    v_add_f32 v102, v102, v74
    v_add_f32 v103, v103, v75
    v_fma_f32 v100, v100, v96, -v27
    v_fma_f32 v101, v101, v97, -v27
    v_fma_f32 v102, v102, v98, -v27
    v_fma_f32 v103, v103, v99, -v27
    v_exp_f32 v100, v100
    v_exp_f32 v101, v101
    v_exp_f32 v102, v102
    v_exp_f32 v103, v103
    v_mul_f32 v96, v96, v100
    v_mul_f32 v97, v97, v101
    v_mul_f32 v98, v98, v102
    v_mul_f32 v99, v99, v103
    v_add_f32 v100, v100, v101
    v_add_f32 v102, v102, v103
    v_add_f32 v100, v100, v102
    v_add_f32 v30, v30, v100
    v_cvt_pk_bf16_f32 v102, v96, v97
    v_cvt_pk_bf16_f32 v103, v98, v99
    v_add_f32 v96, v96, v97
    v_add_f32 v98, v98, v99
    ds_write_b64 v18, v[102:103]
    v_add_f32 v34, v96, v98
    v_fma_f32 v108, -v108, v29, v62
    v_fma_f32 v109, -v109, v29, v62
    v_fma_f32 v110, -v110, v29, v62
    v_fma_f32 v111, -v111, v29, v62
    v_add_f32 v108, v108, v76
    v_add_f32 v109, v109, v77
    v_add_f32 v110, v110, v78
    v_add_f32 v111, v111, v79
    v_fma_f32 v108, v108, v104, -v27
    v_fma_f32 v109, v109, v105, -v27
    v_fma_f32 v110, v110, v106, -v27
    v_fma_f32 v111, v111, v107, -v27
    v_exp_f32 v108, v108
    v_exp_f32 v109, v109
    v_exp_f32 v110, v110
    v_exp_f32 v111, v111
    v_mul_f32 v104, v104, v108
    v_mul_f32 v105, v105, v109
    v_mul_f32 v106, v106, v110
    v_mul_f32 v107, v107, v111
    v_add_f32 v108, v108, v109
    v_add_f32 v110, v110, v111
    v_add_f32 v108, v108, v110
    v_add_f32 v30, v30, v108
    v_cvt_pk_bf16_f32 v110, v104, v105
    v_cvt_pk_bf16_f32 v111, v106, v107
    v_add_f32 v104, v104, v105
    v_add_f32 v106, v106, v107
    ds_write_b64 v19, v[110:111]
    v_add_f32 v35, v104, v106
    v_cmp_nge_f32 vcc, s91, v30
    v_cvt_pk_bf16_f32 v32, v32, v33
    v_cvt_pk_bf16_f32 v33, v34, v35
    ds_write_b64 v20, v[32:33]
    s_cbranch_vccnz L_rare_34
L_back_35:
    v_add_f32 v28, v28, v30
    s_waitcnt lgkmcnt(0)
    s_barrier
    ds_read_b128 v[112:115], v12
    ds_read_b128 v[116:119], v13
    ds_read_b128 v[120:123], v14
    ds_read_b128 v[124:127], v15
    ds_read_b128 v[128:131], v12 offset:256
    ds_read_b128 v[132:135], v13 offset:256
    s_waitcnt lgkmcnt(4)
    v_mfma_f32_16x16x32_bf16 v[80:83], v[112:115], v[112:115], 0
    ds_read_b128 v[136:139], v14 offset:256
    v_mfma_f32_16x16x32_bf16 v[84:87], v[144:147], v[112:115], 0
    v_mfma_f32_16x16x32_bf16 v[80:83], v[116:119], v[116:119], v[80:83]
    ds_read_b128 v[140:143], v15 offset:256
    v_mfma_f32_16x16x32_bf16 v[84:87], v[148:151], v[116:119], v[84:87]
    s_waitcnt lgkmcnt(4)
    v_mfma_f32_16x16x32_bf16 v[80:83], v[120:123], v[120:123], v[80:83]
    ds_read_b128 v[112:115], v12 offset:512
    v_mfma_f32_16x16x32_bf16 v[84:87], v[152:155], v[120:123], v[84:87]
    v_mfma_f32_16x16x32_bf16 v[80:83], v[124:127], v[124:127], v[80:83]
    ds_read_b128 v[116:119], v13 offset:512
    v_mfma_f32_16x16x32_bf16 v[84:87], v[156:159], v[124:127], v[84:87]
    s_waitcnt lgkmcnt(4)
    v_mfma_f32_16x16x32_bf16 v[80:83], v[128:131], v[128:131], v[80:83]
    ds_read_b128 v[120:123], v14 offset:512
    v_mfma_f32_16x16x32_bf16 v[84:87], v[160:163], v[128:131], v[84:87]
    v_mfma_f32_16x16x32_bf16 v[80:83], v[132:135], v[132:135], v[80:83]
    ds_read_b128 v[124:127], v15 offset:512
    v_mfma_f32_16x16x32_bf16 v[84:87], v[164:167], v[132:135], v[84:87]
    s_waitcnt lgkmcnt(4)
    v_mfma_f32_16x16x32_bf16 v[80:83], v[136:139], v[136:139], v[80:83]
    ds_read_b128 v[128:131], v8
    v_mfma_f32_16x16x32_bf16 v[84:87], v[168:171], v[136:139], v[84:87]
    v_mfma_f32_16x16x32_bf16 v[80:83], v[140:143], v[140:143], v[80:83]
    ds_read_b128 v[132:135], v9
    v_mfma_f32_16x16x32_bf16 v[84:87], v[172:175], v[140:143], v[84:87]
    s_waitcnt lgkmcnt(4)
    v_mfma_f32_16x16x32_bf16 v[80:83], v[112:115], v[112:115], v[80:83]
    ds_read_b128 v[136:139], v10
    v_mfma_f32_16x16x32_bf16 v[84:87], v[176:179], v[112:115], v[84:87]
    v_mfma_f32_16x16x32_bf16 v[80:83], v[116:119], v[116:119], v[80:83]
    ds_read_b128 v[140:143], v11
    v_mfma_f32_16x16x32_bf16 v[84:87], v[180:183], v[116:119], v[84:87]
    s_waitcnt lgkmcnt(4)
    v_mfma_f32_16x16x32_bf16 v[80:83], v[120:123], v[120:123], v[80:83]
    ds_read_b128 v[112:115], v8 offset:256
    v_mfma_f32_16x16x32_bf16 v[84:87], v[184:187], v[120:123], v[84:87]
    v_mfma_f32_16x16x32_bf16 v[80:83], v[124:127], v[124:127], v[80:83]
    ds_read_b128 v[116:119], v9 offset:256
    v_mfma_f32_16x16x32_bf16 v[84:87], v[188:191], v[124:127], v[84:87]
    s_waitcnt lgkmcnt(4)
    v_mfma_f32_16x16x32_bf16 v[64:67], v[128:131], v[192:195], 0
    ds_read_b128 v[120:123], v10 offset:256
    v_mfma_f32_16x16x32_bf16 v[64:67], v[132:135], v[196:199], v[64:67]
    ds_read_b128 v[124:127], v11 offset:256
    s_waitcnt lgkmcnt(4)
    v_mfma_f32_16x16x32_bf16 v[64:67], v[136:139], v[200:203], v[64:67]
    ds_read_b128 v[128:131], v8 offset:512
    v_mfma_f32_16x16x32_bf16 v[64:67], v[140:143], v[204:207], v[64:67]
    ds_read_b128 v[132:135], v9 offset:512
    v_cndmask_b32 v24, v80, v81, s[92:93]
    v_cndmask_b32 v25, v82, v83, s[96:97]
    v_add_f32 v31, v84, v47
    v_cndmask_b32 v24, v24, v25, s[94:95]
    v_mul_f32 v31, s89, v31
    v_fma_f32 v24, v87, 2.0, v24
    v_add_f32 v24, v24, v43
    v_mul_f32 v25, v31, v31
    v_fma_f32 v24, v24, s89, -v25
    v_max_f32 v24, 0, v24
    v_add_f32 v24, s90, v24
    v_rsq_f32 v24, v24
    ds_write_b32 v22, v31 offset:256
    ds_write_b32 v22, v24
    s_waitcnt lgkmcnt(6)
    v_mfma_f32_16x16x32_bf16 v[64:67], v[112:115], v[208:211], v[64:67]
    ds_read_b128 v[136:139], v10 offset:512
    v_mfma_f32_16x16x32_bf16 v[64:67], v[116:119], v[212:215], v[64:67]
    ds_read_b128 v[140:143], v11 offset:512
    s_waitcnt lgkmcnt(6)
    v_mfma_f32_16x16x32_bf16 v[64:67], v[120:123], v[216:219], v[64:67]
    ds_read_b128 v[112:115], v8 offset:12288
    v_mfma_f32_16x16x32_bf16 v[64:67], v[124:127], v[220:223], v[64:67]
    ds_read_b128 v[116:119], v9 offset:12288
    s_waitcnt lgkmcnt(6)
    v_mfma_f32_16x16x32_bf16 v[64:67], v[128:131], v[224:227], v[64:67]
    ds_read_b128 v[120:123], v10 offset:12288
    v_mfma_f32_16x16x32_bf16 v[64:67], v[132:135], v[228:231], v[64:67]
    ds_read_b128 v[124:127], v11 offset:12288
    s_waitcnt lgkmcnt(4)
    v_mfma_f32_16x16x32_bf16 v[64:67], v[136:139], v[232:235], v[64:67]
    ds_read_b128 v[128:131], v8 offset:12544
    v_mfma_f32_16x16x32_bf16 v[64:67], v[140:143], v[236:239], v[64:67]
    ds_read_b128 v[132:135], v9 offset:12544
    s_barrier
    ds_read_b128 v[96:99], v21
    ds_read_b128 v[100:103], v21 offset:256
    ds_read_b128 v[104:107], v21 offset:64
    ds_read_b128 v[108:111], v21 offset:320
    s_waitcnt lgkmcnt(8)
    v_mfma_f32_16x16x32_bf16 v[68:71], v[112:115], v[192:195], 0
    ds_read_b128 v[136:139], v10 offset:12544
    v_mfma_f32_16x16x32_bf16 v[68:71], v[116:119], v[196:199], v[68:71]
    ds_read_b128 v[140:143], v11 offset:12544
    s_waitcnt lgkmcnt(8)
    v_mfma_f32_16x16x32_bf16 v[68:71], v[120:123], v[200:203], v[68:71]
    ds_read_b128 v[112:115], v8 offset:12800
    v_mfma_f32_16x16x32_bf16 v[68:71], v[124:127], v[204:207], v[68:71]
    ds_read_b128 v[116:119], v9 offset:12800
    s_waitcnt lgkmcnt(8)
    v_mfma_f32_16x16x32_bf16 v[68:71], v[128:131], v[208:211], v[68:71]
    ds_read_b128 v[120:123], v10 offset:12800
    v_mfma_f32_16x16x32_bf16 v[68:71], v[132:135], v[212:215], v[68:71]
    ds_read_b128 v[124:127], v11 offset:12800
    s_waitcnt lgkmcnt(4)
    v_mfma_f32_16x16x32_bf16 v[68:71], v[136:139], v[216:219], v[68:71]
    ds_read_b128 v[128:131], v8 offset:24576
    v_mfma_f32_16x16x32_bf16 v[68:71], v[140:143], v[220:223], v[68:71]
    ds_read_b128 v[132:135], v9 offset:24576
    s_waitcnt lgkmcnt(4)
    v_mfma_f32_16x16x32_bf16 v[68:71], v[112:115], v[224:227], v[68:71]
    ds_read_b128 v[136:139], v10 offset:24576
    v_mfma_f32_16x16x32_bf16 v[68:71], v[116:119], v[228:231], v[68:71]
    ds_read_b128 v[140:143], v11 offset:24576
    s_waitcnt lgkmcnt(4)
    v_mfma_f32_16x16x32_bf16 v[68:71], v[120:123], v[232:235], v[68:71]
    ds_read_b128 v[112:115], v8 offset:24832
    v_mfma_f32_16x16x32_bf16 v[68:71], v[124:127], v[236:239], v[68:71]
    ds_read_b128 v[116:119], v9 offset:24832
    v_fma_f32 v100, -v100, v29, v51
    v_fma_f32 v101, -v101, v29, v51
    v_fma_f32 v102, -v102, v29, v51
    v_fma_f32 v103, -v103, v29, v51
    v_add_f32 v100, v100, v64
    s_add_u32 s42, s58, 0x1000
    buffer_load_dwordx4 v[144:147], v23, s[20:23], s42 offen offset:2048
    v_add_f32 v101, v101, v65
    v_add_f32 v102, v102, v66
    v_add_f32 v103, v103, v67
    v_fma_f32 v100, v100, v96, -v27
    v_fma_f32 v101, v101, v97, -v27
    buffer_load_dwordx4 v[148:151], v23, s[20:23], s42 offen offset:3072
    v_fma_f32 v102, v102, v98, -v27
    v_fma_f32 v103, v103, v99, -v27
    v_exp_f32 v100, v100
    v_exp_f32 v101, v101
    v_exp_f32 v102, v102
    s_add_u32 s42, s58, 0x2000
    buffer_load_dwordx4 v[152:155], v23, s[20:23], s42 offen
    v_exp_f32 v103, v103
    v_mul_f32 v96, v96, v100
    v_mul_f32 v97, v97, v101
    v_mul_f32 v98, v98, v102
    v_mul_f32 v99, v99, v103
    buffer_load_dwordx4 v[156:159], v23, s[20:23], s42 offen offset:1024
    v_add_f32 v100, v100, v101
    v_add_f32 v102, v102, v103
    v_add_f32 v30, v100, v102
    v_cvt_pk_bf16_f32 v102, v96, v97
    v_cvt_pk_bf16_f32 v103, v98, v99
    buffer_load_dwordx4 v[160:163], v23, s[20:23], s42 offen offset:2048
    v_add_f32 v96, v96, v97
    v_add_f32 v98, v98, v99
    ds_write_b64 v16, v[102:103]
    v_add_f32 v32, v96, v98
    ds_read_b128 v[96:99], v21 offset:128
    buffer_load_dwordx4 v[164:167], v23, s[20:23], s42 offen offset:3072
    ds_read_b128 v[100:103], v21 offset:384
    s_waitcnt lgkmcnt(7)
    v_mfma_f32_16x16x32_bf16 v[72:75], v[128:131], v[192:195], 0
    ds_read_b128 v[120:123], v10 offset:24832
    v_mfma_f32_16x16x32_bf16 v[72:75], v[132:135], v[196:199], v[72:75]
    ds_read_b128 v[124:127], v11 offset:24832
    s_waitcnt lgkmcnt(7)
    v_mfma_f32_16x16x32_bf16 v[72:75], v[136:139], v[200:203], v[72:75]
    ds_read_b128 v[128:131], v8 offset:25088
    v_mfma_f32_16x16x32_bf16 v[72:75], v[140:143], v[204:207], v[72:75]
    ds_read_b128 v[132:135], v9 offset:25088
    s_waitcnt lgkmcnt(7)
    v_mfma_f32_16x16x32_bf16 v[72:75], v[112:115], v[208:211], v[72:75]
    ds_read_b128 v[136:139], v10 offset:25088
    v_mfma_f32_16x16x32_bf16 v[72:75], v[116:119], v[212:215], v[72:75]
    ds_read_b128 v[140:143], v11 offset:25088
    s_waitcnt lgkmcnt(4)
    v_mfma_f32_16x16x32_bf16 v[72:75], v[120:123], v[216:219], v[72:75]
    ds_read_b128 v[112:115], v8 offset:36864
    v_mfma_f32_16x16x32_bf16 v[72:75], v[124:127], v[220:223], v[72:75]
    ds_read_b128 v[116:119], v9 offset:36864
    s_waitcnt lgkmcnt(4)
    v_mfma_f32_16x16x32_bf16 v[72:75], v[128:131], v[224:227], v[72:75]
    ds_read_b128 v[120:123], v10 offset:36864
    v_mfma_f32_16x16x32_bf16 v[72:75], v[132:135], v[228:231], v[72:75]
    ds_read_b128 v[124:127], v11 offset:36864
    s_waitcnt lgkmcnt(4)
    v_mfma_f32_16x16x32_bf16 v[72:75], v[136:139], v[232:235], v[72:75]
    ds_read_b128 v[128:131], v8 offset:37120
    v_mfma_f32_16x16x32_bf16 v[72:75], v[140:143], v[236:239], v[72:75]
    ds_read_b128 v[132:135], v9 offset:37120
    v_fma_f32 v108, -v108, v29, v55
    v_fma_f32 v109, -v109, v29, v55
    v_fma_f32 v110, -v110, v29, v55
    v_fma_f32 v111, -v111, v29, v55
    v_add_f32 v108, v108, v68
    s_add_u32 s42, s58, 0x3000
    buffer_load_dwordx4 v[168:171], v23, s[20:23], s42 offen
    v_add_f32 v109, v109, v69
    v_add_f32 v110, v110, v70
    v_add_f32 v111, v111, v71
    v_fma_f32 v108, v108, v104, -v27
    v_fma_f32 v109, v109, v105, -v27
    buffer_load_dwordx4 v[172:175], v23, s[20:23], s42 offen offset:1024
    v_fma_f32 v110, v110, v106, -v27
    v_fma_f32 v111, v111, v107, -v27
    v_exp_f32 v108, v108
    v_exp_f32 v109, v109
    v_exp_f32 v110, v110
    buffer_load_dwordx4 v[176:179], v23, s[20:23], s42 offen offset:2048
    v_exp_f32 v111, v111
    v_mul_f32 v104, v104, v108
    v_mul_f32 v105, v105, v109
    v_mul_f32 v106, v106, v110
    v_mul_f32 v107, v107, v111
    buffer_load_dwordx4 v[180:183], v23, s[20:23], s42 offen offset:3072
    v_add_f32 v108, v108, v109
    v_add_f32 v110, v110, v111
    v_add_f32 v108, v108, v110
    v_add_f32 v30, v30, v108
    v_cvt_pk_bf16_f32 v110, v104, v105
    s_add_u32 s42, s58, 0x4000
    buffer_load_dwordx4 v[184:187], v23, s[20:23], s42 offen
    v_cvt_pk_bf16_f32 v111, v106, v107
    v_add_f32 v104, v104, v105
    v_add_f32 v106, v106, v107
    ds_write_b64 v17, v[110:111]
    v_add_f32 v33, v104, v106
    buffer_load_dwordx4 v[188:191], v23, s[20:23], s42 offen offset:1024
    ds_read_b128 v[104:107], v21 offset:192
    ds_read_b128 v[108:111], v21 offset:448
    s_waitcnt lgkmcnt(7)
    v_mfma_f32_16x16x32_bf16 v[76:79], v[112:115], v[192:195], 0
    ds_read_b128 v[136:139], v10 offset:37120
    v_mfma_f32_16x16x32_bf16 v[76:79], v[116:119], v[196:199], v[76:79]
    ds_read_b128 v[140:143], v11 offset:37120
    s_waitcnt lgkmcnt(7)
    v_mfma_f32_16x16x32_bf16 v[76:79], v[120:123], v[200:203], v[76:79]
    ds_read_b128 v[112:115], v8 offset:37376
    v_mfma_f32_16x16x32_bf16 v[76:79], v[124:127], v[204:207], v[76:79]
    ds_read_b128 v[116:119], v9 offset:37376
    s_waitcnt lgkmcnt(7)
    v_mfma_f32_16x16x32_bf16 v[76:79], v[128:131], v[208:211], v[76:79]
    ds_read_b128 v[120:123], v10 offset:37376
    v_mfma_f32_16x16x32_bf16 v[76:79], v[132:135], v[212:215], v[76:79]
    ds_read_b128 v[124:127], v11 offset:37376
    s_waitcnt lgkmcnt(4)
    v_mfma_f32_16x16x32_bf16 v[76:79], v[136:139], v[216:219], v[76:79]
    v_mfma_f32_16x16x32_bf16 v[76:79], v[140:143], v[220:223], v[76:79]
    s_waitcnt lgkmcnt(3)
    v_mfma_f32_16x16x32_bf16 v[76:79], v[112:115], v[224:227], v[76:79]
    s_waitcnt lgkmcnt(2)
    v_mfma_f32_16x16x32_bf16 v[76:79], v[116:119], v[228:231], v[76:79]
    s_waitcnt lgkmcnt(1)
    v_mfma_f32_16x16x32_bf16 v[76:79], v[120:123], v[232:235], v[76:79]
    s_waitcnt lgkmcnt(0)
    v_mfma_f32_16x16x32_bf16 v[76:79], v[124:127], v[236:239], v[76:79]
    v_fma_f32 v100, -v100, v29, v59
    v_fma_f32 v101, -v101, v29, v59
    v_fma_f32 v102, -v102, v29, v59
    v_fma_f32 v103, -v103, v29, v59
    v_add_f32 v100, v100, v72
    v_add_f32 v101, v101, v73
    v_add_f32 v102, v102, v74
    v_add_f32 v103, v103, v75
    v_fma_f32 v100, v100, v96, -v27
    v_fma_f32 v101, v101, v97, -v27
    v_fma_f32 v102, v102, v98, -v27
    v_fma_f32 v103, v103, v99, -v27
    v_exp_f32 v100, v100
    v_exp_f32 v101, v101
    v_exp_f32 v102, v102
    v_exp_f32 v103, v103
    v_mul_f32 v96, v96, v100
    v_mul_f32 v97, v97, v101
    v_mul_f32 v98, v98, v102
    v_mul_f32 v99, v99, v103
    v_add_f32 v100, v100, v101
    v_add_f32 v102, v102, v103
    v_add_f32 v100, v100, v102
    v_add_f32 v30, v30, v100
    v_cvt_pk_bf16_f32 v102, v96, v97
    v_cvt_pk_bf16_f32 v103, v98, v99
    v_add_f32 v96, v96, v97
    v_add_f32 v98, v98, v99
    ds_write_b64 v18, v[102:103]
    v_add_f32 v34, v96, v98
    v_fma_f32 v108, -v108, v29, v63
    v_fma_f32 v109, -v109, v29, v63
    v_fma_f32 v110, -v110, v29, v63
    v_fma_f32 v111, -v111, v29, v63
    v_add_f32 v108, v108, v76
    v_add_f32 v109, v109, v77
    v_add_f32 v110, v110, v78
    v_add_f32 v111, v111, v79
    v_fma_f32 v108, v108, v104, -v27
    v_fma_f32 v109, v109, v105, -v27
    v_fma_f32 v110, v110, v106, -v27
    v_fma_f32 v111, v111, v107, -v27
    v_exp_f32 v108, v108
    v_exp_f32 v109, v109
    v_exp_f32 v110, v110
    v_exp_f32 v111, v111
    v_mul_f32 v104, v104, v108
    v_mul_f32 v105, v105, v109
    v_mul_f32 v106, v106, v110
    v_mul_f32 v107, v107, v111
    v_add_f32 v108, v108, v109
    v_add_f32 v110, v110, v111
    v_add_f32 v108, v108, v110
    v_add_f32 v30, v30, v108
    v_cvt_pk_bf16_f32 v110, v104, v105
    v_cvt_pk_bf16_f32 v111, v106, v107
    v_add_f32 v104, v104, v105
    v_add_f32 v106, v106, v107
    ds_write_b64 v19, v[110:111]
    v_add_f32 v35, v104, v106
    v_cmp_nge_f32 vcc, s91, v30
    v_cvt_pk_bf16_f32 v32, v32, v33
    v_cvt_pk_bf16_f32 v33, v34, v35
    ds_write_b64 v20, v[32:33]
    s_cbranch_vccnz L_rare_36
L_back_37:
    v_add_f32 v28, v28, v30
    s_waitcnt lgkmcnt(0)
    s_barrier
    s_setprio 1
    s_add_u32 s42, s58, 0x7000
    buffer_load_dwordx4 v[192:195], v23, s[20:23], s42 offen offset:2048
    buffer_load_dwordx4 v[196:199], v23, s[20:23], s42 offen offset:3072
    v_mov_b32 v26, v28
    s_nop 1
    v_permlane16_swap_b32 v26, v28
    v_add_f32 v28, v28, v26
    v_mov_b32 v26, v28
    s_nop 1
    v_permlane32_swap_b32 v26, v28
    v_add_f32 v28, v28, v26
    s_add_u32 s42, s58, 0x8000
    buffer_load_dwordx4 v[200:203], v23, s[20:23], s42 offen
    v_and_b32 v24, 15, v1
    v_lshlrev_b32 v24, 2, v24
    s_lshl_b32 s4, s3, 6
    v_add_u32 v24, s4, v24
    ds_write_b32 v24, v27 offset:59392
    ds_write_b32 v24, v28 offset:59648
    v_lshrrev_b32 v16, 4, v1
    v_lshlrev_b32 v24, 4, v16
    buffer_load_dwordx4 v[204:207], v23, s[20:23], s42 offen offset:1024
    v_add_u32 v24, s4, v24
    s_waitcnt lgkmcnt(0)
    ds_read_b128 v[48:51], v24 offset:59392
    ds_read_b128 v[52:55], v24 offset:59648
    v_mov_b32 v2, s45
    v_lshlrev_b32 v25, 16, v2
    v_and_b32 v2, 0xffff0000, v2
    s_mov_b32 s50, 0xaaaaaaaa
    buffer_load_dwordx4 v[208:211], v23, s[20:23], s42 offen offset:2048
    s_mov_b32 s51, 0xaaaaaaaa
    v_cndmask_b32 v2, v25, v2, s[50:51]
    s_waitcnt lgkmcnt(0)
    v_cndmask_b32 v72, v48, v52, s[94:95]
    v_lshrrev_b32 v25, 16, v72
    v_and_b32 v72, 0xffff, v72
    v_cndmask_b32 v72, v25, v72, s[50:51]
    v_or_b32 v72, v72, v2
    v_cndmask_b32 v73, v49, v53, s[94:95]
    buffer_load_dwordx4 v[212:215], v23, s[20:23], s42 offen offset:3072
    v_lshrrev_b32 v25, 16, v73
    v_and_b32 v73, 0xffff, v73
    v_cndmask_b32 v73, v25, v73, s[50:51]
    v_or_b32 v73, v73, v2
    v_cndmask_b32 v74, v50, v54, s[94:95]
    v_lshrrev_b32 v25, 16, v74
    v_and_b32 v74, 0xffff, v74
    v_cndmask_b32 v74, v25, v74, s[50:51]
    s_add_u32 s42, s58, 0x9000
    buffer_load_dwordx4 v[216:219], v23, s[20:23], s42 offen
    v_or_b32 v74, v74, v2
    v_cndmask_b32 v75, v51, v55, s[94:95]
    v_lshrrev_b32 v25, 16, v75
    v_and_b32 v75, 0xffff, v75
    v_cndmask_b32 v75, v25, v75, s[50:51]
    v_or_b32 v75, v75, v2
    v_and_b32 v24, 15, v1
    v_lshrrev_b32 v25, 2, v24
    v_lshrrev_b32 v26, 3, v24
    v_xor_b32 v26, v25, v26
    v_and_b32 v26, 1, v26
    v_lshlrev_b32 v26, 3, v26
    v_and_b32 v25, 1, v25
    v_or_b32 v26, v26, v25
    v_and_b32 v25, 1, v24
    v_lshl_or_b32 v26, v25, 2, v26
    v_and_b32 v25, 2, v24
    v_or_b32 v26, v26, v25
    v_lshrrev_b32 v25, 4, v1
    v_xor_b32 v26, v26, v25
    v_lshlrev_b32 v26, 4, v26
    v_mul_u32_u24 v24, 0x300, v24
    v_add_u32 v24, 0x1c000, v24
    v_xor_b32 v25, 0, v26
    v_add_u32 v18, v24, v25
    v_xor_b32 v25, 64, v26
    v_add_u32 v19, v24, v25
    v_xor_b32 v25, 0x80, v26
    v_add_u32 v20, v24, v25
    v_xor_b32 v25, 0xc0, v26
    v_add_u32 v21, v24, v25
    v_add_u32 v18, s101, v18
    buffer_load_dwordx4 v[220:223], v23, s[20:23], s42 offen offset:1024
    v_add_u32 v19, s101, v19
    v_add_u32 v20, s101, v20
    v_add_u32 v21, s101, v21
    v_add_u32 v22, s101, v23
    v_add_u32 v22, 0x10000, v22
    v_and_b32 v17, 15, v1
    v_lshlrev_b32 v17, 4, v17
    v_lshl_add_u32 v4, v16, 10, v17
    buffer_load_dwordx4 v[224:227], v23, s[20:23], s42 offen offset:2048
    s_lshl_b32 s41, s2, 14
    s_lshl_b32 s4, s3, 12
    s_add_u32 s41, s41, s4
    s_add_u32 s41, s41, 0x100000
    v_lshlrev_b32 v24, 1, v17
    s_lshl_b32 s4, s3, 9
    s_add_u32 s4, s4, 0x78000
    buffer_load_dwordx4 v[12:15], v24, s[20:23], s4 offen
    buffer_load_dwordx4 v[228:231], v23, s[20:23], s42 offen offset:3072
    buffer_load_dwordx2 v[16:17], v24, s[20:23], s4 offen offset:16
    v_mov_b32 v28, 0x3f803f80
    v_mov_b32 v29, 0x3f803f80
    v_mov_b32 v30, 0x3f803f80
    v_mov_b32 v31, 0x3f803f80
    s_add_u32 s42, s58, 0xa000
    buffer_load_dwordx4 v[232:235], v23, s[20:23], s42 offen
    buffer_load_dwordx4 v[236:239], v23, s[20:23], s42 offen offset:1024
    buffer_load_dwordx4 v[112:115], v23, s[20:23], s42 offen offset:2048
    buffer_load_dwordx4 v[116:119], v23, s[20:23], s42 offen offset:3072
    s_add_u32 s42, s58, 0xb000
    buffer_load_dwordx4 v[120:123], v23, s[20:23], s42 offen
    buffer_load_dwordx4 v[124:127], v23, s[20:23], s42 offen offset:1024
    buffer_load_dwordx4 v[128:131], v23, s[20:23], s42 offen offset:2048
    buffer_load_dwordx4 v[132:135], v23, s[20:23], s42 offen offset:3072
    s_add_u32 s42, s58, 0xc000
    buffer_load_dwordx4 v[136:139], v23, s[20:23], s42 offen
    buffer_load_dwordx4 v[140:143], v23, s[20:23], s42 offen offset:1024
    buffer_load_dwordx4 v[96:99], v23, s[20:23], s42 offen offset:2048
    buffer_load_dwordx4 v[100:103], v23, s[20:23], s42 offen offset:3072
    s_add_u32 s42, s58, 0xd000
    buffer_load_dwordx4 v[104:107], v23, s[20:23], s42 offen
    buffer_load_dwordx4 v[108:111], v23, s[20:23], s42 offen offset:1024
    s_barrier
    ds_read_b128 v[32:35], v18
    ds_read_b128 v[36:39], v19
    s_waitcnt vmcnt(38)
    ds_read_b128 v[40:43], v20
    s_waitcnt lgkmcnt(2)
    v_mfma_f32_16x16x32_bf16 v[48:51], v[32:35], v[240:243], 0
    v_mfma_f32_16x16x32_bf16 v[8:11], v[32:35], v[28:31], 0
    ds_read_b128 v[44:47], v21
    s_add_u32 s42, s58, 0xd000
    v_mfma_f32_16x16x32_bf16 v[52:55], v[32:35], v[244:247], 0
    buffer_load_dwordx4 v[240:243], v23, s[20:23], s42 offen offset:2048
    v_mfma_f32_16x16x32_bf16 v[56:59], v[32:35], v[248:251], 0
    v_mfma_f32_16x16x32_bf16 v[60:63], v[32:35], v[252:255], 0
    v_mfma_f32_16x16x32_bf16 v[64:67], v[32:35], v[88:91], 0
    buffer_load_dwordx4 v[244:247], v23, s[20:23], s42 offen offset:3072
    v_mfma_f32_16x16x32_bf16 v[68:71], v[32:35], v[92:95], 0
    s_waitcnt vmcnt(39) lgkmcnt(2)
    v_mfma_f32_16x16x32_bf16 v[48:51], v[36:39], v[144:147], v[48:51]
    v_mfma_f32_16x16x32_bf16 v[8:11], v[36:39], v[28:31], v[8:11]
    ds_read_b128 v[32:35], v18 offset:256
    s_add_u32 s42, s58, 0xe000
    s_waitcnt vmcnt(38)
    v_mfma_f32_16x16x32_bf16 v[52:55], v[36:39], v[148:151], v[52:55]
    buffer_load_dwordx4 v[248:251], v23, s[20:23], s42 offen
    s_waitcnt vmcnt(38)
    v_mfma_f32_16x16x32_bf16 v[56:59], v[36:39], v[152:155], v[56:59]
    s_waitcnt vmcnt(37)
    v_mfma_f32_16x16x32_bf16 v[60:63], v[36:39], v[156:159], v[60:63]
    s_waitcnt vmcnt(36)
    v_mfma_f32_16x16x32_bf16 v[64:67], v[36:39], v[160:163], v[64:67]
    buffer_load_dwordx4 v[252:255], v23, s[20:23], s42 offen offset:1024
    s_waitcnt vmcnt(36)
    v_mfma_f32_16x16x32_bf16 v[68:71], v[36:39], v[164:167], v[68:71]
    s_waitcnt vmcnt(35) lgkmcnt(2)
    v_mfma_f32_16x16x32_bf16 v[48:51], v[40:43], v[168:171], v[48:51]
    v_mfma_f32_16x16x32_bf16 v[8:11], v[40:43], v[28:31], v[8:11]
    ds_read_b128 v[36:39], v19 offset:256
    ds_read_b128 v[76:79], v22
    s_waitcnt vmcnt(34)
    v_mfma_f32_16x16x32_bf16 v[52:55], v[40:43], v[172:175], v[52:55]
    ds_read_b128 v[80:83], v22 offset:1024
    buffer_load_dwordx4 v[88:91], v23, s[20:23], s42 offen offset:2048
    s_waitcnt vmcnt(34)
    v_mfma_f32_16x16x32_bf16 v[56:59], v[40:43], v[176:179], v[56:59]
    ds_read_b128 v[84:87], v22 offset:2048
    s_waitcnt vmcnt(33)
    v_mfma_f32_16x16x32_bf16 v[60:63], v[40:43], v[180:183], v[60:63]
    s_waitcnt vmcnt(32)
    v_mfma_f32_16x16x32_bf16 v[64:67], v[40:43], v[184:187], v[64:67]
    buffer_load_dwordx4 v[92:95], v23, s[20:23], s42 offen offset:3072
    s_waitcnt vmcnt(32)
    v_mfma_f32_16x16x32_bf16 v[68:71], v[40:43], v[188:191], v[68:71]
    s_waitcnt lgkmcnt(2)
    v_mfma_f32_16x16x32_bf16 v[48:51], v[44:47], v[76:79], v[48:51]
    v_mfma_f32_16x16x32_bf16 v[8:11], v[44:47], v[28:31], v[8:11]
    ds_read_b128 v[40:43], v20 offset:256
    ds_read_b128 v[76:79], v22 offset:3072
    s_add_u32 s42, s58, 0xf000
    s_waitcnt lgkmcnt(3)
    v_mfma_f32_16x16x32_bf16 v[52:55], v[44:47], v[80:83], v[52:55]
    ds_read_b128 v[80:83], v22 offset:4096
    buffer_load_dwordx4 v[144:147], v23, s[20:23], s42 offen
    s_waitcnt lgkmcnt(3)
    v_mfma_f32_16x16x32_bf16 v[56:59], v[44:47], v[84:87], v[56:59]
    ds_read_b128 v[84:87], v22 offset:5120
    s_barrier
    s_waitcnt lgkmcnt(2)
    v_mfma_f32_16x16x32_bf16 v[60:63], v[44:47], v[76:79], v[60:63]
    ds_read_b128 v[76:79], v22 offset:6144
    s_waitcnt lgkmcnt(2)
    v_mfma_f32_16x16x32_bf16 v[64:67], v[44:47], v[80:83], v[64:67]
    ds_read_b128 v[80:83], v22 offset:7168
    buffer_load_dwordx4 v[148:151], v23, s[20:23], s42 offen offset:1024
    s_waitcnt lgkmcnt(2)
    v_mfma_f32_16x16x32_bf16 v[68:71], v[44:47], v[84:87], v[68:71]
    ds_read_b128 v[84:87], v22 offset:8192
    s_waitcnt lgkmcnt(2)
    v_mfma_f32_16x16x32_bf16 v[48:51], v[32:35], v[76:79], v[48:51]
    v_mfma_f32_16x16x32_bf16 v[8:11], v[32:35], v[28:31], v[8:11]
    ds_read_b128 v[44:47], v21 offset:256
    ds_read_b128 v[76:79], v22 offset:9216
    s_waitcnt lgkmcnt(3)
    v_mfma_f32_16x16x32_bf16 v[52:55], v[32:35], v[80:83], v[52:55]
    ds_read_b128 v[80:83], v22 offset:10240
    buffer_load_dwordx4 v[152:155], v23, s[20:23], s42 offen offset:2048
    s_waitcnt lgkmcnt(3)
    v_mfma_f32_16x16x32_bf16 v[56:59], v[32:35], v[84:87], v[56:59]
    ds_read_b128 v[84:87], v22 offset:11264
    s_waitcnt lgkmcnt(2)
    v_mfma_f32_16x16x32_bf16 v[60:63], v[32:35], v[76:79], v[60:63]
    s_waitcnt lgkmcnt(1)
    v_mfma_f32_16x16x32_bf16 v[64:67], v[32:35], v[80:83], v[64:67]
    buffer_load_dwordx4 v[156:159], v23, s[20:23], s42 offen offset:3072
    s_waitcnt lgkmcnt(0)
    v_mfma_f32_16x16x32_bf16 v[68:71], v[32:35], v[84:87], v[68:71]
    s_waitcnt vmcnt(35)
    v_mfma_f32_16x16x32_bf16 v[48:51], v[36:39], v[192:195], v[48:51]
    v_mfma_f32_16x16x32_bf16 v[8:11], v[36:39], v[28:31], v[8:11]
    ds_read_b128 v[32:35], v18 offset:512
    s_add_u32 s42, s58, 0x10000
    s_waitcnt vmcnt(34)
    v_mfma_f32_16x16x32_bf16 v[52:55], v[36:39], v[196:199], v[52:55]
    buffer_load_dwordx4 v[160:163], v23, s[20:23], s42 offen
    s_waitcnt vmcnt(34)
    v_mfma_f32_16x16x32_bf16 v[56:59], v[36:39], v[200:203], v[56:59]
    s_waitcnt vmcnt(33)
    v_mfma_f32_16x16x32_bf16 v[60:63], v[36:39], v[204:207], v[60:63]
    s_waitcnt vmcnt(32)
    v_mfma_f32_16x16x32_bf16 v[64:67], v[36:39], v[208:211], v[64:67]
    buffer_load_dwordx4 v[164:167], v23, s[20:23], s42 offen offset:1024
    s_waitcnt vmcnt(32)
    v_mfma_f32_16x16x32_bf16 v[68:71], v[36:39], v[212:215], v[68:71]
    s_waitcnt vmcnt(31)
    v_mfma_f32_16x16x32_bf16 v[48:51], v[40:43], v[216:219], v[48:51]
    v_mfma_f32_16x16x32_bf16 v[8:11], v[40:43], v[28:31], v[8:11]
    ds_read_b128 v[36:39], v19 offset:512
    s_waitcnt vmcnt(30)
    v_mfma_f32_16x16x32_bf16 v[52:55], v[40:43], v[220:223], v[52:55]
    buffer_load_dwordx4 v[168:171], v23, s[20:23], s42 offen offset:2048
    s_waitcnt vmcnt(30)
    v_mfma_f32_16x16x32_bf16 v[56:59], v[40:43], v[224:227], v[56:59]
    s_waitcnt vmcnt(28)
    v_mfma_f32_16x16x32_bf16 v[60:63], v[40:43], v[228:231], v[60:63]
    s_waitcnt vmcnt(26)
    v_mfma_f32_16x16x32_bf16 v[64:67], v[40:43], v[232:235], v[64:67]
    buffer_load_dwordx4 v[172:175], v23, s[20:23], s42 offen offset:3072
    s_barrier
    s_waitcnt vmcnt(26)
    v_mfma_f32_16x16x32_bf16 v[68:71], v[40:43], v[236:239], v[68:71]
    s_waitcnt vmcnt(25)
    v_mfma_f32_16x16x32_bf16 v[48:51], v[44:47], v[112:115], v[48:51]
    v_mfma_f32_16x16x32_bf16 v[8:11], v[44:47], v[28:31], v[8:11]
    ds_read_b128 v[40:43], v20 offset:512
    s_add_u32 s42, s58, 0x11000
    s_waitcnt vmcnt(24)
    v_mfma_f32_16x16x32_bf16 v[52:55], v[44:47], v[116:119], v[52:55]
    buffer_load_dwordx4 v[176:179], v23, s[20:23], s42 offen
    s_waitcnt vmcnt(24)
    v_mfma_f32_16x16x32_bf16 v[56:59], v[44:47], v[120:123], v[56:59]
    s_waitcnt vmcnt(23)
    v_mfma_f32_16x16x32_bf16 v[60:63], v[44:47], v[124:127], v[60:63]
    s_waitcnt vmcnt(22)
    v_mfma_f32_16x16x32_bf16 v[64:67], v[44:47], v[128:131], v[64:67]
    buffer_load_dwordx4 v[180:183], v23, s[20:23], s42 offen offset:1024
    s_waitcnt vmcnt(22)
    v_mfma_f32_16x16x32_bf16 v[68:71], v[44:47], v[132:135], v[68:71]
    s_waitcnt vmcnt(21) lgkmcnt(2)
    v_mfma_f32_16x16x32_bf16 v[48:51], v[32:35], v[136:139], v[48:51]
    v_mfma_f32_16x16x32_bf16 v[8:11], v[32:35], v[28:31], v[8:11]
    ds_read_b128 v[44:47], v21 offset:512
    s_waitcnt vmcnt(20)
    v_mfma_f32_16x16x32_bf16 v[52:55], v[32:35], v[140:143], v[52:55]
    buffer_load_dwordx4 v[184:187], v23, s[20:23], s42 offen offset:2048
    s_waitcnt vmcnt(20)
    v_mfma_f32_16x16x32_bf16 v[56:59], v[32:35], v[96:99], v[56:59]
    s_waitcnt vmcnt(19)
    v_mfma_f32_16x16x32_bf16 v[60:63], v[32:35], v[100:103], v[60:63]
    s_waitcnt vmcnt(18)
    v_mfma_f32_16x16x32_bf16 v[64:67], v[32:35], v[104:107], v[64:67]
    buffer_load_dwordx4 v[188:191], v23, s[20:23], s42 offen offset:3072
    s_waitcnt vmcnt(18)
    v_mfma_f32_16x16x32_bf16 v[68:71], v[32:35], v[108:111], v[68:71]
    s_waitcnt vmcnt(17) lgkmcnt(2)
    v_mfma_f32_16x16x32_bf16 v[48:51], v[36:39], v[240:243], v[48:51]
    v_mfma_f32_16x16x32_bf16 v[8:11], v[36:39], v[28:31], v[8:11]
    s_waitcnt vmcnt(16)
    v_mfma_f32_16x16x32_bf16 v[52:55], v[36:39], v[244:247], v[52:55]
    s_waitcnt vmcnt(15)
    v_mfma_f32_16x16x32_bf16 v[56:59], v[36:39], v[248:251], v[56:59]
    s_waitcnt vmcnt(14)
    v_mfma_f32_16x16x32_bf16 v[60:63], v[36:39], v[252:255], v[60:63]
    s_waitcnt vmcnt(13)
    v_mfma_f32_16x16x32_bf16 v[64:67], v[36:39], v[88:91], v[64:67]
    s_waitcnt vmcnt(12)
    v_mfma_f32_16x16x32_bf16 v[68:71], v[36:39], v[92:95], v[68:71]
    s_waitcnt vmcnt(11) lgkmcnt(1)
    v_mfma_f32_16x16x32_bf16 v[48:51], v[40:43], v[144:147], v[48:51]
    v_mfma_f32_16x16x32_bf16 v[8:11], v[40:43], v[28:31], v[8:11]
    s_waitcnt vmcnt(10)
    v_mfma_f32_16x16x32_bf16 v[52:55], v[40:43], v[148:151], v[52:55]
    s_waitcnt vmcnt(9)
    v_mfma_f32_16x16x32_bf16 v[56:59], v[40:43], v[152:155], v[56:59]
    s_waitcnt vmcnt(8)
    v_mfma_f32_16x16x32_bf16 v[60:63], v[40:43], v[156:159], v[60:63]
    s_waitcnt vmcnt(7)
    v_mfma_f32_16x16x32_bf16 v[64:67], v[40:43], v[160:163], v[64:67]
    s_waitcnt vmcnt(6)
    v_mfma_f32_16x16x32_bf16 v[68:71], v[40:43], v[164:167], v[68:71]
    s_waitcnt vmcnt(5) lgkmcnt(0)
    v_mfma_f32_16x16x32_bf16 v[48:51], v[44:47], v[168:171], v[48:51]
    v_mfma_f32_16x16x32_bf16 v[8:11], v[44:47], v[28:31], v[8:11]
    s_waitcnt vmcnt(4)
    v_mfma_f32_16x16x32_bf16 v[52:55], v[44:47], v[172:175], v[52:55]
    s_waitcnt vmcnt(3)
    v_mfma_f32_16x16x32_bf16 v[56:59], v[44:47], v[176:179], v[56:59]
    s_waitcnt vmcnt(2)
    v_mfma_f32_16x16x32_bf16 v[60:63], v[44:47], v[180:183], v[60:63]
    s_waitcnt vmcnt(1)
    v_mfma_f32_16x16x32_bf16 v[64:67], v[44:47], v[184:187], v[64:67]
    s_waitcnt vmcnt(0)
    v_mfma_f32_16x16x32_bf16 v[68:71], v[44:47], v[188:191], v[68:71]
    v_fma_f32 v48, -v8, v12, v48
    v_fma_f32 v52, -v8, v13, v52
    v_fma_f32 v56, -v8, v14, v56
    s_nop 0
    v_fma_f32 v60, -v8, v15, v60
    s_nop 0
    v_fma_f32 v64, -v8, v16, v64
    s_nop 0
    v_fma_f32 v68, -v8, v17, v68
    v_cvt_pk_bf16_f32 v88, v48, v52
    v_cvt_pk_bf16_f32 v89, v56, v60
    v_cvt_pk_bf16_f32 v90, v64, v68
    v_mov_b32 v91, v72
    buffer_store_dwordx4 v[88:91], v4, s[20:23], s41 offen nt
    v_fma_f32 v49, -v9, v12, v49
    v_fma_f32 v53, -v9, v13, v53
    v_fma_f32 v57, -v9, v14, v57
    v_fma_f32 v61, -v9, v15, v61
    v_fma_f32 v65, -v9, v16, v65
    v_fma_f32 v69, -v9, v17, v69
    v_cvt_pk_bf16_f32 v92, v49, v53
    v_cvt_pk_bf16_f32 v93, v57, v61
    v_cvt_pk_bf16_f32 v94, v65, v69
    v_mov_b32 v95, v73
    buffer_store_dwordx4 v[92:95], v4, s[20:23], s41 offen offset:256 nt
    v_fma_f32 v50, -v10, v12, v50
    v_fma_f32 v54, -v10, v13, v54
    v_fma_f32 v58, -v10, v14, v58
    v_fma_f32 v62, -v10, v15, v62
    v_fma_f32 v66, -v10, v16, v66
    v_fma_f32 v70, -v10, v17, v70
    v_cvt_pk_bf16_f32 v96, v50, v54
    v_cvt_pk_bf16_f32 v97, v58, v62
    v_cvt_pk_bf16_f32 v98, v66, v70
    v_mov_b32 v99, v74
    buffer_store_dwordx4 v[96:99], v4, s[20:23], s41 offen offset:512 nt
    v_fma_f32 v51, -v11, v12, v51
    v_fma_f32 v55, -v11, v13, v55
    v_fma_f32 v59, -v11, v14, v59
    v_fma_f32 v63, -v11, v15, v63
    v_fma_f32 v67, -v11, v16, v67
    v_fma_f32 v71, -v11, v17, v71
    v_cvt_pk_bf16_f32 v100, v51, v55
    v_cvt_pk_bf16_f32 v101, v59, v63
    v_cvt_pk_bf16_f32 v102, v67, v71
    v_mov_b32 v103, v75
    buffer_store_dwordx4 v[100:103], v4, s[20:23], s41 offen offset:768 nt
    s_barrier
    s_endpgm
L_uwave:
    s_and_b32 s4, s2, 8
    s_add_u32 s4, s4, s3
    s_cmp_lg_u32 s4, 10
    s_cbranch_scc1 L_cp_38
    s_getpc_b64 s[4:5]
L_pc:
    s_sub_u32 s4, s4, L_pc-standalone__detection_seg_mask2former__vision_kernel
    s_subb_u32 s5, s5, 0
    s_lshr_b32 s6, s2, 4
    s_mul_i32 s6, s6, 30
    v_min_u32 v56, 29, v1
    v_add_u32 v56, s6, v56
    v_lshlrev_b32 v56, 7, v56
    v_min_u32 v56, L_codeend-standalone__detection_seg_mask2former__vision_kernel, v56
    v_mov_b32 v57, s5
    v_add_co_u32 v56, vcc, s4, v56
    s_nop 1
    v_addc_co_u32 v57, vcc, 0, v57, vcc
    global_load_dword v21, v[56:57], off
L_cp_38:
    s_waitcnt lgkmcnt(0)
    s_mov_b32 s12, s68
    s_and_b32 s13, s69, 0xffff
    s_mov_b32 s14, 0xc00000
    s_mov_b32 s15, 0x20000
    s_cmp_lt_u32 s57, 6
    s_cselect_b32 s49, 1, 0
    s_cbranch_scc1 L_upa_39
    s_cmp_lt_u32 s57, 9
    s_cbranch_scc1 L_upv_40
    s_mov_b32 s32, s80
    s_and_b32 s33, s81, 0xffff
    s_mov_b32 s34, 0x48000
    s_mov_b32 s35, 0x20000
    s_mov_b32 s28, s74
    s_and_b32 s29, s75, 0xffff
    s_mov_b32 s30, 0x48000
    s_mov_b32 s31, 0x20000
    s_mov_b32 s36, s64
    s_and_b32 s37, s65, 0xffff
    s_mov_b32 s38, 0x3000
    s_mov_b32 s39, 0x20000
    s_sub_u32 s4, s57, 9
    s_mul_i32 s5, s4, 0xa5
    v_min_u32 v24, 0xa4, v0
    v_add_u32 v24, s5, v24
    v_mul_u32_u24 v25, 0x5556, v24
    v_lshrrev_b32 v25, 16, v25
    v_mul_u32_u24 v25, 0x180, v25
    v_lshl_add_u32 v24, v24, 7, v25
    s_and_b32 s6, s2, 1
    s_mul_i32 s5, s6, 0x180
    s_cmp_eq_u32 s3, 3
    s_cbranch_scc1 L_pt_41
    buffer_load_dword v21, v24, s[32:35], s5 offen
    s_branch L_pt_42
L_pt_41:
    s_mul_i32 s5, s58, 0x12000
    s_mul_i32 s6, s6, 0x9000
    s_add_u32 s5, s5, s6
    s_mul_i32 s6, s4, 0x1500
    s_add_u32 s5, s5, s6
    s_mul_i32 s6, s4, 0x700
    v_min_u32 v24, 41, v1
    v_lshlrev_b32 v24, 7, v24
    v_min_u32 v25, 13, v1
    v_lshlrev_b32 v25, 7, v25
    buffer_load_dword v21, v24, s[28:31], s5 offen
    buffer_load_dword v22, v25, s[36:39], s6 offen
    s_mov_b32 s28, s76
    s_and_b32 s29, s77, 0xffff
    s_mov_b32 s30, 0x48000
    s_mov_b32 s31, 0x20000
    s_mul_i32 s5, s58, 0x12000
    s_mul_i32 s6, s4, 0x2980
    s_add_u32 s5, s5, s6
    v_lshlrev_b32 v24, 7, v1
    v_min_u32 v25, 18, v1
    v_lshlrev_b32 v25, 7, v25
    s_add_u32 s6, s5, 0x2000
    buffer_load_dword v21, v24, s[28:31], s5 offen
    buffer_load_dword v22, v25, s[28:31], s6 offen
L_pt_42:
L_upv_40:
    s_mov_b32 s16, s70
    s_and_b32 s17, s71, 0xffff
    s_mov_b32 s18, 0x48000
    s_mov_b32 s19, 0x20000
    s_sub_u32 s4, s57, 6
    s_lshl_b32 s4, s4, 2
    s_add_u32 s4, s4, s3
    s_mul_i32 s4, s4, 0xa00
    v_min_u32 v24, 19, v1
    v_lshlrev_b32 v24, 7, v24
    buffer_load_dword v22, v24, s[16:19], s4 offen
    s_mul_i32 s6, s2, 0xc000
    s_mul_i32 s4, s3, 0xc00
    s_add_u32 s6, s6, s4
    s_mul_i32 s5, s3, 0x3000
    s_add_u32 m0, s5, 0x1c000
    s_lshl_b32 s4, s3, 6
    v_xor_b32 v28, s4, v23
    s_mov_b32 s7, 0x901090
    s_mov_b32 exec_hi, 0xffff
    v_xor_b32 v29, 64, v28
    v_xor_b32 v30, 32, v28
    v_xor_b32 v31, 0x60, v28
L_fo_43:
    s_add_u32 s41, s6, 0
    buffer_load_dwordx4 v28, s[12:15], s41 offen nt lds
    s_add_u32 m0, m0, 0x300
    s_add_u32 s41, s6, 0x3000
    buffer_load_dwordx4 v29, s[12:15], s41 offen nt lds
    s_add_u32 m0, m0, 0x300
    s_add_u32 s41, s6, 0x6000
    buffer_load_dwordx4 v30, s[12:15], s41 offen nt lds
    s_add_u32 m0, m0, 0x300
    s_add_u32 s41, s6, 0x9000
    buffer_load_dwordx4 v31, s[12:15], s41 offen nt lds
    s_and_b32 s4, s7, 0xff
    s_add_u32 m0, m0, 0x300
    s_add_u32 s6, s6, 0x300
    v_xor_b32 v28, s4, v28
    v_xor_b32 v29, s4, v29
    v_xor_b32 v30, s4, v30
    v_xor_b32 v31, s4, v31
    s_lshr_b32 s7, s7, 8
    s_cmp_lg_u32 s4, 0
    s_cbranch_scc1 L_fo_43
    s_mov_b32 exec_hi, -1
    s_branch L_urest
L_upa_39:
    s_cmp_lg_u32 s3, 3
    s_cbranch_scc1 L_urest
    s_mov_b32 s28, s74
    s_and_b32 s29, s75, 0xffff
    s_mov_b32 s30, 0x48000
    s_mov_b32 s31, 0x20000
    s_and_b32 s4, s2, 1
    s_mul_i32 s59, s4, 6
    s_add_u32 s59, s59, s57
    v_bfe_u32 v24, v1, 2, 2
    v_lshlrev_b32 v24, 3, v24
    v_and_b32 v25, 3, v1
    v_add_u32 v24, v24, v25
    v_mul_u32_u24 v24, 0xc0, v24
    v_lshrrev_b32 v25, 4, v1
    v_lshl_add_u32 v24, v25, 3, v24
    s_mul_i32 s41, s58, 0x12000
    s_mul_i32 s4, s59, 0x1800
    s_add_u32 s41, s41, s4
    s_mul_i32 s47, s58, 12
    s_add_u32 s47, s47, s59
    s_lshl_b32 s47, s47, 10
    s_mul_i32 s48, s58, 18
    s_add_u32 s48, s48, s59
    buffer_load_dwordx2 v[232:233], v24, s[28:31], s41 offen
    buffer_load_dwordx2 v[234:235], v24, s[28:31], s41 offen offset:32
    buffer_load_dwordx2 v[236:237], v24, s[28:31], s41 offen offset:64
    buffer_load_dwordx2 v[238:239], v24, s[28:31], s41 offen offset:96
    buffer_load_dwordx2 v[240:241], v24, s[28:31], s41 offen offset:128
    buffer_load_dwordx2 v[242:243], v24, s[28:31], s41 offen offset:160
    buffer_load_dwordx2 v[244:245], v24, s[28:31], s41 offen offset:768
    buffer_load_dwordx2 v[246:247], v24, s[28:31], s41 offen offset:800
    buffer_load_dwordx2 v[248:249], v24, s[28:31], s41 offen offset:832
    buffer_load_dwordx2 v[250:251], v24, s[28:31], s41 offen offset:864
    buffer_load_dwordx2 v[252:253], v24, s[28:31], s41 offen offset:896
    buffer_load_dwordx2 v[254:255], v24, s[28:31], s41 offen offset:928
L_urest:
    s_mov_b32 s8, s66
    s_and_b32 s9, s67, 0xffff
    s_mov_b32 s10, 0x3000000
    s_mov_b32 s11, 0x20000
    s_mov_b32 s20, s86
    s_and_b32 s21, s87, 0xffff
    s_mov_b32 s22, 0x10000000
    s_mov_b32 s23, 0x20000
    s_mov_b32 s88, 0x30000
    v_add_u32 v24, 0, v1
    v_mul_u32_u24 v25, 0x556, v24
    v_lshrrev_b32 v60, 16, v25
    v_mul_u32_u24 v25, 48, v60
    v_sub_u32 v24, v24, v25
    v_lshlrev_b32 v25, 2, v60
    v_xor_b32 v24, v24, v25
    v_lshlrev_b32 v24, 4, v24
    v_and_b32 v25, 1, v60
    v_mul_u32_u24 v25, 0x300, v25
    v_add_u32 v24, v24, v25
    v_lshrrev_b32 v25, 1, v60
    v_mul_lo_u32 v25, v25, s88
    v_add_u32 v2, v24, v25
    v_xor_b32 v5, 32, v2
    v_add_u32 v24, 64, v1
    v_mul_u32_u24 v25, 0x556, v24
    v_lshrrev_b32 v60, 16, v25
    v_mul_u32_u24 v25, 48, v60
    v_sub_u32 v24, v24, v25
    v_lshlrev_b32 v25, 2, v60
    v_xor_b32 v24, v24, v25
    v_lshlrev_b32 v24, 4, v24
    v_and_b32 v25, 1, v60
    v_mul_u32_u24 v25, 0x300, v25
    v_add_u32 v24, v24, v25
    v_lshrrev_b32 v25, 1, v60
    v_mul_lo_u32 v25, v25, s88
    v_add_u32 v3, v24, v25
    v_subrev_u32 v3, 0x400, v3
    v_xor_b32 v6, 32, v3
    v_add_u32 v24, 0x80, v1
    v_mul_u32_u24 v25, 0x556, v24
    v_lshrrev_b32 v60, 16, v25
    v_mul_u32_u24 v25, 48, v60
    v_sub_u32 v24, v24, v25
    v_lshlrev_b32 v25, 2, v60
    v_xor_b32 v24, v24, v25
    v_lshlrev_b32 v24, 4, v24
    v_and_b32 v25, 1, v60
    v_mul_u32_u24 v25, 0x300, v25
    v_add_u32 v24, v24, v25
    v_lshrrev_b32 v25, 1, v60
    v_mul_lo_u32 v25, v25, s88
    v_add_u32 v4, v24, v25
    v_subrev_u32 v4, 0x800, v4
    v_xor_b32 v7, 32, v4
    s_lshr_b32 s4, s2, 1
    s_mul_i32 s40, s4, 0x60000
    s_and_b32 s4, s2, 1
    s_mul_i32 s4, s4, 0x18000
    s_add_u32 s40, s40, s4
    s_mul_i32 s4, s3, 0x1800
    s_add_u32 s40, s40, s4
    s_mul_i32 s101, s3, 0x3000
    v_lshrrev_b32 v56, 4, v1
    v_and_b32 v57, 15, v1
    v_lshrrev_b32 v59, 5, v1
    v_and_b32 v24, 1, v56
    v_lshlrev_b32 v24, 1, v24
    v_and_b32 v25, 1, v1
    v_or_b32 v60, v24, v25
    v_lshrrev_b32 v61, 2, v57
    v_and_b32 v24, 2, v1
    v_lshlrev_b32 v62, 2, v24
    s_mul_i32 s4, s3, 3
    s_add_u32 s4, s4, 0
    s_lshr_b32 s5, s4, 2
    s_lshl_b32 s5, s5, 8
    s_and_b32 s4, s4, 3
    s_lshl_b32 s4, s4, 2
    v_lshlrev_b32 v24, 2, v61
    v_xor_b32 v24, v24, v60
    v_xor_b32 v24, s4, v24
    v_lshl_add_u32 v24, v24, 4, v62
    v_add_u32 v24, s5, v24
    v_lshl_add_u32 v25, v59, 3, v61
    v_add_u32 v25, 0, v25
    v_mul_u32_u24 v25, 0x300, v25
    v_add_u32 v8, v24, v25
    v_lshlrev_b32 v24, 2, v61
    v_xor_b32 v24, v24, v60
    v_xor_b32 v24, s4, v24
    v_xor_b32 v24, 2, v24
    v_lshl_add_u32 v24, v24, 4, v62
    v_add_u32 v24, s5, v24
    v_lshl_add_u32 v25, v59, 3, v61
    v_add_u32 v25, 4, v25
    v_mul_u32_u24 v25, 0x300, v25
    v_add_u32 v9, v24, v25
    v_lshlrev_b32 v25, 4, v61
    v_lshl_add_u32 v25, v59, 3, v25
    v_add_u32 v25, 0, v25
    v_mul_u32_u24 v25, 0x300, v25
    v_lshlrev_b32 v24, 3, v59
    v_xor_b32 v24, 0, v24
    v_xor_b32 v24, v24, v60
    v_xor_b32 v24, s4, v24
    v_lshlrev_b32 v26, 2, v61
    v_xor_b32 v24, v24, v26
    v_lshl_add_u32 v24, v24, 4, v62
    v_add3_u32 v24, v24, v25, s5
    v_add_u32 v100, 0x1c000, v24
    v_lshlrev_b32 v25, 4, v61
    v_lshl_add_u32 v25, v59, 3, v25
    v_add_u32 v25, 4, v25
    v_mul_u32_u24 v25, 0x300, v25
    v_lshlrev_b32 v24, 3, v59
    v_xor_b32 v24, 9, v24
    v_xor_b32 v24, v24, v60
    v_xor_b32 v24, s4, v24
    v_lshlrev_b32 v26, 2, v61
    v_xor_b32 v24, v24, v26
    v_lshl_add_u32 v24, v24, 4, v62
    v_add3_u32 v24, v24, v25, s5
    v_add_u32 v101, 0x1c000, v24
    s_mul_i32 s4, s3, 3
    s_add_u32 s4, s4, 1
    s_lshr_b32 s5, s4, 2
    s_lshl_b32 s5, s5, 8
    s_and_b32 s4, s4, 3
    s_lshl_b32 s4, s4, 2
    v_lshlrev_b32 v24, 2, v61
    v_xor_b32 v24, v24, v60
    v_xor_b32 v24, s4, v24
    v_lshl_add_u32 v24, v24, 4, v62
    v_add_u32 v24, s5, v24
    v_lshl_add_u32 v25, v59, 3, v61
    v_add_u32 v25, 0, v25
    v_mul_u32_u24 v25, 0x300, v25
    v_add_u32 v10, v24, v25
    v_lshlrev_b32 v24, 2, v61
    v_xor_b32 v24, v24, v60
    v_xor_b32 v24, s4, v24
    v_xor_b32 v24, 2, v24
    v_lshl_add_u32 v24, v24, 4, v62
    v_add_u32 v24, s5, v24
    v_lshl_add_u32 v25, v59, 3, v61
    v_add_u32 v25, 4, v25
    v_mul_u32_u24 v25, 0x300, v25
    v_add_u32 v11, v24, v25
    v_lshlrev_b32 v25, 4, v61
    v_lshl_add_u32 v25, v59, 3, v25
    v_add_u32 v25, 0, v25
    v_mul_u32_u24 v25, 0x300, v25
    v_lshlrev_b32 v24, 3, v59
    v_xor_b32 v24, 0, v24
    v_xor_b32 v24, v24, v60
    v_xor_b32 v24, s4, v24
    v_lshlrev_b32 v26, 2, v61
    v_xor_b32 v24, v24, v26
    v_lshl_add_u32 v24, v24, 4, v62
    v_add3_u32 v24, v24, v25, s5
    v_add_u32 v102, 0x1c000, v24
    v_lshlrev_b32 v25, 4, v61
    v_lshl_add_u32 v25, v59, 3, v25
    v_add_u32 v25, 4, v25
    v_mul_u32_u24 v25, 0x300, v25
    v_lshlrev_b32 v24, 3, v59
    v_xor_b32 v24, 9, v24
    v_xor_b32 v24, v24, v60
    v_xor_b32 v24, s4, v24
    v_lshlrev_b32 v26, 2, v61
    v_xor_b32 v24, v24, v26
    v_lshl_add_u32 v24, v24, 4, v62
    v_add3_u32 v24, v24, v25, s5
    v_add_u32 v103, 0x1c000, v24
    s_mul_i32 s4, s3, 3
    s_add_u32 s4, s4, 2
    s_lshr_b32 s5, s4, 2
    s_lshl_b32 s5, s5, 8
    s_and_b32 s4, s4, 3
    s_lshl_b32 s4, s4, 2
    v_lshlrev_b32 v24, 2, v61
    v_xor_b32 v24, v24, v60
    v_xor_b32 v24, s4, v24
    v_lshl_add_u32 v24, v24, 4, v62
    v_add_u32 v24, s5, v24
    v_lshl_add_u32 v25, v59, 3, v61
    v_add_u32 v25, 0, v25
    v_mul_u32_u24 v25, 0x300, v25
    v_add_u32 v12, v24, v25
    v_lshlrev_b32 v24, 2, v61
    v_xor_b32 v24, v24, v60
    v_xor_b32 v24, s4, v24
    v_xor_b32 v24, 2, v24
    v_lshl_add_u32 v24, v24, 4, v62
    v_add_u32 v24, s5, v24
    v_lshl_add_u32 v25, v59, 3, v61
    v_add_u32 v25, 4, v25
    v_mul_u32_u24 v25, 0x300, v25
    v_add_u32 v13, v24, v25
    v_lshlrev_b32 v25, 4, v61
    v_lshl_add_u32 v25, v59, 3, v25
    v_add_u32 v25, 0, v25
    v_mul_u32_u24 v25, 0x300, v25
    v_lshlrev_b32 v24, 3, v59
    v_xor_b32 v24, 0, v24
    v_xor_b32 v24, v24, v60
    v_xor_b32 v24, s4, v24
    v_lshlrev_b32 v26, 2, v61
    v_xor_b32 v24, v24, v26
    v_lshl_add_u32 v24, v24, 4, v62
    v_add3_u32 v24, v24, v25, s5
    v_add_u32 v104, 0x1c000, v24
    v_lshlrev_b32 v25, 4, v61
    v_lshl_add_u32 v25, v59, 3, v25
    v_add_u32 v25, 4, v25
    v_mul_u32_u24 v25, 0x300, v25
    v_lshlrev_b32 v24, 3, v59
    v_xor_b32 v24, 9, v24
    v_xor_b32 v24, v24, v60
    v_xor_b32 v24, s4, v24
    v_lshlrev_b32 v26, 2, v61
    v_xor_b32 v24, v24, v26
    v_lshl_add_u32 v24, v24, 4, v62
    v_add3_u32 v24, v24, v25, s5
    v_add_u32 v105, 0x1c000, v24
    v_bfe_u32 v24, v1, 1, 3
    v_xor_b32 v24, v24, v59
    v_lshlrev_b32 v24, 4, v24
    v_and_b32 v25, 31, v1
    v_lshlrev_b32 v25, 7, v25
    v_add_u32 v25, 0xc000, v25
    v_xor_b32 v26, 0, v24
    v_add_u32 v14, v25, v26
    v_xor_b32 v26, 32, v24
    v_add_u32 v15, v25, v26
    v_xor_b32 v26, 64, v24
    v_add_u32 v16, v25, v26
    v_xor_b32 v26, 0x60, v24
    v_add_u32 v17, v25, v26
    v_and_b32 v24, 3, v57
    v_lshlrev_b32 v24, 2, v24
    v_lshrrev_b32 v25, 1, v57
    v_and_b32 v25, 2, v25
    v_or_b32 v24, v24, v25
    v_xor_b32 v24, v24, v56
    v_lshlrev_b32 v19, 4, v24
    v_mul_u32_u24 v25, 0x300, v57
    s_mul_i32 s4, s3, 0x3000
    v_add_u32 v18, s4, v25
    s_lshl_b32 s4, s3, 6
    s_add_u32 s4, s4, 0xe800
    v_lshlrev_b32 v24, 2, v57
    v_add_u32 v24, s4, v24
    v_lshlrev_b32 v25, 2, v1
    v_add_u32 v25, 0xf100, v25
    v_cmp_eq_u32 vcc, v61, v56
    s_nop 1
    v_cndmask_b32 v27, v25, v24, vcc
    s_mov_b32 s92, 0x22222222
    s_mov_b32 s93, 0x22222222
    s_mov_b32 s94, 0xcccccccc
    s_mov_b32 s95, 0xcccccccc
    s_mov_b32 s96, 0x88888888
    s_mov_b32 s97, 0x88888888
    s_mov_b32 s88, 0x3f803f80
    v_and_b32 v24, 31, v1
    v_lshlrev_b32 v24, 5, v24
    v_bfe_u32 v25, v1, 3, 1
    v_xor_b32 v25, v25, v59
    v_lshl_add_u32 v24, v25, 4, v24
    v_add_u32 v107, 0xe000, v24
    v_mov_b32 v20, 0xf000
    v_lshrrev_b32 v24, 4, v1
    v_bfe_u32 v25, v1, 2, 2
    v_lshl_add_u32 v62, v24, 3, v25
    v_mul_u32_u24 v62, 0x300, v62
    v_and_b32 v26, 1, v1
    v_lshl_add_u32 v62, v26, 3, v62
    v_and_b32 v24, 1, v24
    v_lshlrev_b32 v24, 3, v24
    v_lshl_or_b32 v61, v25, 1, v24
    v_bfe_u32 v26, v1, 1, 1
    s_mul_i32 s4, s3, 12
    v_add_u32 v26, s4, v26
    v_add_u32 v24, 0, v26
    v_xor_b32 v24, v24, v61
    v_lshl_add_u32 v144, v24, 4, v62
    v_add_u32 v24, 2, v26
    v_xor_b32 v24, v24, v61
    v_lshl_add_u32 v145, v24, 4, v62
    v_add_u32 v24, 4, v26
    v_xor_b32 v24, v24, v61
    v_lshl_add_u32 v146, v24, 4, v62
    v_add_u32 v24, 6, v26
    v_xor_b32 v24, v24, v61
    v_lshl_add_u32 v147, v24, 4, v62
    v_add_u32 v24, 8, v26
    v_xor_b32 v24, v24, v61
    v_lshl_add_u32 v148, v24, 4, v62
    v_add_u32 v24, 10, v26
    v_xor_b32 v24, v24, v61
    v_lshl_add_u32 v149, v24, 4, v62
    v_and_b32 v24, 15, v1
    v_lshrrev_b32 v25, 2, v24
    v_lshrrev_b32 v26, 3, v24
    v_xor_b32 v26, v25, v26
    v_and_b32 v26, 1, v26
    v_lshlrev_b32 v26, 3, v26
    v_and_b32 v25, 1, v25
    v_or_b32 v26, v26, v25
    v_and_b32 v25, 1, v24
    v_lshl_or_b32 v26, v25, 2, v26
    v_and_b32 v25, 2, v24
    v_or_b32 v26, v26, v25
    v_lshrrev_b32 v25, 4, v1
    v_xor_b32 v26, v26, v25
    v_lshlrev_b32 v26, 4, v26
    v_mul_u32_u24 v24, 0x300, v24
    v_add_u32 v24, 0x1c000, v24
    v_xor_b32 v25, 0, v26
    v_add_u32 v150, v24, v25
    v_xor_b32 v25, 64, v26
    v_add_u32 v151, v24, v25
    v_xor_b32 v25, 0x80, v26
    v_add_u32 v152, v24, v25
    v_xor_b32 v25, 0xc0, v26
    v_add_u32 v153, v24, v25
    v_and_b32 v24, 15, v1
    v_lshrrev_b32 v25, 2, v24
    v_lshrrev_b32 v157, 3, v24
    v_xor_b32 v157, v25, v157
    v_and_b32 v157, 1, v157
    v_lshlrev_b32 v157, 3, v157
    v_and_b32 v25, 1, v25
    v_or_b32 v157, v157, v25
    v_and_b32 v25, 1, v24
    v_lshl_or_b32 v157, v25, 2, v157
    v_and_b32 v25, 2, v24
    v_or_b32 v157, v157, v25
    v_mul_u32_u24 v24, 0x300, v24
    v_add_u32 v158, 0x1c000, v24
    v_bfe_u32 v24, v1, 4, 1
    v_lshlrev_b32 v24, 1, v24
    v_lshrrev_b32 v25, 5, v1
    v_add_u32 v24, v24, v25
    s_mul_i32 s4, s3, 12
    v_add_u32 v24, s4, v24
    v_add_u32 v25, 0, v24
    v_xor_b32 v25, v25, v157
    v_lshl_add_u32 v154, v25, 4, v158
    v_add_u32 v25, 4, v24
    v_xor_b32 v25, v25, v157
    v_lshl_add_u32 v155, v25, 4, v158
    v_add_u32 v25, 8, v24
    v_xor_b32 v25, v25, v157
    v_lshl_add_u32 v156, v25, 4, v158
    s_mul_i32 s58, s3, 0x12000
    s_add_u32 s58, s58, 0x10000
    s_bitcmp1_b32 s2, 3
    s_cbranch_scc0 L_nb_44
    s_cmp_lt_u32 s57, 9
    s_cbranch_scc0 L_nb_44
    s_barrier
    s_cmp_lg_u32 s49, 0
    s_cbranch_scc1 L_ub_45
    s_branch L_nb_44
L_ub_45:
    s_mov_b32 s24, s84
    s_and_b32 s25, s85, 0xffff
    s_mov_b32 s26, 0x100
    s_mov_b32 s27, 0x20000
    v_mov_b32 v199, 0
    buffer_load_dword v199, v199, s[24:27], 0 offen sc1
    s_mul_i32 s6, s2, 0xc000
    s_mul_i32 s4, s3, 0xc00
    s_add_u32 s6, s6, s4
    s_mul_i32 s5, s3, 0x3000
    s_add_u32 s5, s5, 0x1c000
    s_lshl_b32 s4, s3, 6
    v_xor_b32 v25, s4, v23
    s_mov_b32 exec_hi, 0xffff
    s_add_u32 m0, s5, 0
    s_add_u32 s41, s6, 0
    buffer_load_dwordx4 v25, s[12:15], s41 offen nt lds
    s_add_u32 m0, s5, 0x300
    s_add_u32 s41, s6, 0x3000
    v_xor_b32 v24, 64, v25
    buffer_load_dwordx4 v24, s[12:15], s41 offen nt lds
    s_add_u32 m0, s5, 0x600
    s_add_u32 s41, s6, 0x6000
    v_xor_b32 v24, 32, v25
    buffer_load_dwordx4 v24, s[12:15], s41 offen nt lds
    s_add_u32 m0, s5, 0x900
    s_add_u32 s41, s6, 0x9000
    v_xor_b32 v24, 0x60, v25
    buffer_load_dwordx4 v24, s[12:15], s41 offen nt lds
    s_add_u32 m0, s5, 0xc00
    s_add_u32 s41, s6, 0x300
    v_xor_b32 v24, 0x90, v25
    buffer_load_dwordx4 v24, s[12:15], s41 offen nt lds
    s_add_u32 m0, s5, 0xf00
    s_add_u32 s41, s6, 0x3300
    v_xor_b32 v24, 0xd0, v25
    buffer_load_dwordx4 v24, s[12:15], s41 offen nt lds
    s_mov_b32 exec_hi, -1
    s_barrier
    s_mul_i32 s6, s2, 0xc000
    s_mul_i32 s4, s3, 0xc00
    s_add_u32 s6, s6, s4
    s_mul_i32 s5, s3, 0x3000
    s_add_u32 s5, s5, 0x1c000
    s_lshl_b32 s4, s3, 6
    v_xor_b32 v25, s4, v23
    s_mov_b32 exec_hi, 0xffff
    s_add_u32 m0, s5, 0x1200
    s_add_u32 s41, s6, 0x6300
    v_xor_b32 v24, 0xb0, v25
    buffer_load_dwordx4 v24, s[12:15], s41 offen nt lds
    s_add_u32 m0, s5, 0x1500
    s_add_u32 s41, s6, 0x9300
    v_xor_b32 v24, 0xf0, v25
    buffer_load_dwordx4 v24, s[12:15], s41 offen nt lds
    s_add_u32 m0, s5, 0x1800
    s_add_u32 s41, s6, 0x600
    v_xor_b32 v24, 0x80, v25
    buffer_load_dwordx4 v24, s[12:15], s41 offen nt lds
    s_add_u32 m0, s5, 0x1b00
    s_add_u32 s41, s6, 0x3600
    v_xor_b32 v24, 0xc0, v25
    buffer_load_dwordx4 v24, s[12:15], s41 offen nt lds
    s_add_u32 m0, s5, 0x1e00
    s_add_u32 s41, s6, 0x6600
    v_xor_b32 v24, 0xa0, v25
    buffer_load_dwordx4 v24, s[12:15], s41 offen nt lds
    s_add_u32 m0, s5, 0x2100
    s_add_u32 s41, s6, 0x9600
    v_xor_b32 v24, 0xe0, v25
    buffer_load_dwordx4 v24, s[12:15], s41 offen nt lds
    s_add_u32 m0, s5, 0x2400
    s_add_u32 s41, s6, 0x900
    v_xor_b32 v24, 16, v25
    buffer_load_dwordx4 v24, s[12:15], s41 offen nt lds
    s_add_u32 m0, s5, 0x2700
    s_add_u32 s41, s6, 0x3900
    v_xor_b32 v24, 0x50, v25
    buffer_load_dwordx4 v24, s[12:15], s41 offen nt lds
    s_add_u32 m0, s5, 0x2a00
    s_add_u32 s41, s6, 0x6900
    v_xor_b32 v24, 48, v25
    buffer_load_dwordx4 v24, s[12:15], s41 offen nt lds
    s_add_u32 m0, s5, 0x2d00
    s_add_u32 s41, s6, 0x9900
    v_xor_b32 v24, 0x70, v25
    buffer_load_dwordx4 v24, s[12:15], s41 offen nt lds
    s_mov_b32 exec_hi, -1
    s_cmp_eq_u32 s3, 3
    s_cbranch_scc1 L_ub_46
    s_barrier
    s_barrier
    s_branch L_nb_44
L_ub_46:
    v_add_u32 v24, 0xf000, v23
    v_add_u32 v25, 0x16000, v23
    s_mov_b32 s89, 0x3e16c740
    s_waitcnt vmcnt(16)
    v_readfirstlane_b32 s44, v199
    s_nop 0
    s_cmp_eq_u32 s44, 0
    s_cbranch_scc1 L_es_47
L_eb_48:
    s_mul_i32 s45, s44, 0x9e3779b1
    s_barrier
    ds_read_b128 v[208:211], v24
    ds_read_b128 v[212:215], v24 offset:1024
    ds_read_b128 v[216:219], v24 offset:2048
    ds_read_b128 v[220:223], v25
    ds_read_b128 v[224:227], v25 offset:1024
    s_waitcnt lgkmcnt(3)
    v_mfma_f32_16x16x32_bf16 v[200:203], v[232:235], v[208:211], 0
    v_mfma_f32_16x16x32_bf16 v[204:207], v[244:247], v[208:211], 0
    v_mfma_f32_16x16x32_bf16 v[200:203], v[236:239], v[212:215], v[200:203]
    v_mfma_f32_16x16x32_bf16 v[204:207], v[248:251], v[212:215], v[204:207]
    s_waitcnt lgkmcnt(2)
    v_mfma_f32_16x16x32_bf16 v[200:203], v[240:243], v[216:219], v[200:203]
    v_mfma_f32_16x16x32_bf16 v[204:207], v[252:255], v[216:219], v[204:207]
    s_waitcnt lgkmcnt(1)
    s_nop 5
    v_fma_f32 v220, v200, s89, v220
    v_fma_f32 v221, v201, s89, v221
    v_fma_f32 v222, v202, s89, v222
    v_fma_f32 v223, v203, s89, v223
    s_waitcnt lgkmcnt(0)
    v_fma_f32 v224, v204, s89, v224
    v_fma_f32 v225, v205, s89, v225
    v_fma_f32 v226, v206, s89, v226
    v_fma_f32 v227, v207, s89, v227
    v_cvt_pk_bf16_f32 v228, v220, v221
    v_cvt_pk_bf16_f32 v229, v222, v223
    v_cvt_pk_bf16_f32 v230, v224, v225
    v_cvt_pk_bf16_f32 v231, v226, v227
    buffer_store_dwordx4 v[228:231], v23, s[20:23], s47 offen sc1
    s_barrier
    s_waitcnt vmcnt(0)
    v_mov_b32 v24, s45
    s_lshl_b32 s4, s48, 7
    s_add_u32 s4, s4, 0x70000
    v_mov_b32 v25, 0
    s_mov_b64 exec, 1
    buffer_store_dword v24, v25, s[20:23], s4 offen sc1
    s_mov_b64 exec, -1
    s_branch L_ub_49
L_nb_44:
    s_waitcnt vmcnt(0)
L_ub_49:
    s_barrier
    s_setprio 1
    ds_read_b128 v[112:115], v150
    ds_read_b64_tr_b16 v[28:29], v144
    ds_read_b64_tr_b16 v[30:31], v144 offset:3072
    ds_read_b128 v[116:119], v151 offset:12288
    ds_read_b128 v[120:123], v152 offset:24576
    ds_read_b128 v[124:127], v153 offset:36864
    ds_read_b64_tr_b16 v[32:33], v145
    ds_read_b64_tr_b16 v[34:35], v145 offset:3072
    ds_read_b64_tr_b16 v[36:37], v146
    ds_read_b64_tr_b16 v[38:39], v146 offset:3072
    ds_read_b64_tr_b16 v[40:41], v147
    ds_read_b64_tr_b16 v[42:43], v147 offset:3072
    ds_read_b64_tr_b16 v[44:45], v148
    ds_read_b64_tr_b16 v[46:47], v148 offset:3072
    ds_read_b64_tr_b16 v[48:49], v149
    ds_read_b64_tr_b16 v[50:51], v149 offset:3072
    v_mov_b32 v24, 0
    v_lshlrev_b32 v25, 2, v1
    ds_write_b32 v25, v24 offset:61440
    s_waitcnt lgkmcnt(13)
    v_mfma_f32_16x16x32_bf16 v[160:163], v[28:31], v[112:115], 0
    s_waitcnt lgkmcnt(0)
    s_barrier
    ds_read_b128 v[128:131], v151
    v_mfma_f32_16x16x32_bf16 v[184:187], v[28:31], v[116:119], 0
    ds_read_b64_tr_b16 v[52:53], v144 offset:24576
    v_mfma_f32_16x16x32_bf16 v[208:211], v[28:31], v[120:123], 0
    ds_read_b64_tr_b16 v[54:55], v144 offset:27648
    v_mfma_f32_16x16x32_bf16 v[232:235], v[28:31], v[124:127], 0
    ds_read_b128 v[132:135], v150 offset:12288
    v_mfma_f32_16x16x32_bf16 v[164:167], v[32:35], v[112:115], 0
    ds_read_b128 v[136:139], v153 offset:24576
    v_mfma_f32_16x16x32_bf16 v[188:191], v[32:35], v[116:119], 0
    ds_read_b128 v[140:143], v152 offset:36864
    v_mfma_f32_16x16x32_bf16 v[212:215], v[32:35], v[120:123], 0
    ds_read_b64_tr_b16 v[56:57], v145 offset:24576
    v_mfma_f32_16x16x32_bf16 v[236:239], v[32:35], v[124:127], 0
    ds_read_b64_tr_b16 v[58:59], v145 offset:27648
    v_mfma_f32_16x16x32_bf16 v[168:171], v[36:39], v[112:115], 0
    ds_read_b64_tr_b16 v[60:61], v146 offset:24576
    v_mfma_f32_16x16x32_bf16 v[192:195], v[36:39], v[116:119], 0
    ds_read_b64_tr_b16 v[62:63], v146 offset:27648
    v_mfma_f32_16x16x32_bf16 v[216:219], v[36:39], v[120:123], 0
    ds_read_b64_tr_b16 v[64:65], v147 offset:24576
    v_mfma_f32_16x16x32_bf16 v[240:243], v[36:39], v[124:127], 0
    ds_read_b64_tr_b16 v[66:67], v147 offset:27648
    v_mfma_f32_16x16x32_bf16 v[172:175], v[40:43], v[112:115], 0
    ds_read_b64_tr_b16 v[68:69], v148 offset:24576
    v_mfma_f32_16x16x32_bf16 v[196:199], v[40:43], v[116:119], 0
    ds_read_b64_tr_b16 v[70:71], v148 offset:27648
    v_mfma_f32_16x16x32_bf16 v[220:223], v[40:43], v[120:123], 0
    ds_read_b64_tr_b16 v[72:73], v149 offset:24576
    v_mfma_f32_16x16x32_bf16 v[244:247], v[40:43], v[124:127], 0
    ds_read_b64_tr_b16 v[74:75], v149 offset:27648
    v_mfma_f32_16x16x32_bf16 v[176:179], v[44:47], v[112:115], 0
    v_xor_b32 v144, 0x10000, v144
    v_mfma_f32_16x16x32_bf16 v[200:203], v[44:47], v[116:119], 0
    v_xor_b32 v145, 0x10000, v145
    v_mfma_f32_16x16x32_bf16 v[224:227], v[44:47], v[120:123], 0
    v_xor_b32 v146, 0x10000, v146
    v_mfma_f32_16x16x32_bf16 v[248:251], v[44:47], v[124:127], 0
    v_xor_b32 v147, 0x10000, v147
    v_mfma_f32_16x16x32_bf16 v[180:183], v[48:51], v[112:115], 0
    v_xor_b32 v148, 0x10000, v148
    v_mfma_f32_16x16x32_bf16 v[204:207], v[48:51], v[116:119], 0
    v_xor_b32 v149, 0x10000, v149
    v_mfma_f32_16x16x32_bf16 v[228:231], v[48:51], v[120:123], 0
    v_mfma_f32_16x16x32_bf16 v[252:255], v[48:51], v[124:127], 0
    s_waitcnt lgkmcnt(12)
    v_mfma_f32_16x16x32_bf16 v[160:163], v[52:55], v[128:131], v[160:163]
    s_waitcnt lgkmcnt(0)
    s_barrier
    ds_read_b128 v[112:115], v152
    v_mfma_f32_16x16x32_bf16 v[184:187], v[52:55], v[132:135], v[184:187]
    ds_read_b64_tr_b16 v[28:29], v144
    v_mfma_f32_16x16x32_bf16 v[208:211], v[52:55], v[136:139], v[208:211]
    ds_read_b64_tr_b16 v[30:31], v144 offset:3072
    v_mfma_f32_16x16x32_bf16 v[232:235], v[52:55], v[140:143], v[232:235]
    ds_read_b128 v[116:119], v153 offset:12288
    v_mfma_f32_16x16x32_bf16 v[164:167], v[56:59], v[128:131], v[164:167]
    ds_read_b128 v[120:123], v150 offset:24576
    v_mfma_f32_16x16x32_bf16 v[188:191], v[56:59], v[132:135], v[188:191]
    ds_read_b128 v[124:127], v151 offset:36864
    v_mfma_f32_16x16x32_bf16 v[212:215], v[56:59], v[136:139], v[212:215]
    ds_read_b64_tr_b16 v[32:33], v145
    v_mfma_f32_16x16x32_bf16 v[236:239], v[56:59], v[140:143], v[236:239]
    ds_read_b64_tr_b16 v[34:35], v145 offset:3072
    v_mfma_f32_16x16x32_bf16 v[168:171], v[60:63], v[128:131], v[168:171]
    ds_read_b64_tr_b16 v[36:37], v146
    v_mfma_f32_16x16x32_bf16 v[192:195], v[60:63], v[132:135], v[192:195]
    ds_read_b64_tr_b16 v[38:39], v146 offset:3072
    v_mfma_f32_16x16x32_bf16 v[216:219], v[60:63], v[136:139], v[216:219]
    ds_read_b64_tr_b16 v[40:41], v147
    v_mfma_f32_16x16x32_bf16 v[240:243], v[60:63], v[140:143], v[240:243]
    ds_read_b64_tr_b16 v[42:43], v147 offset:3072
    v_mfma_f32_16x16x32_bf16 v[172:175], v[64:67], v[128:131], v[172:175]
    ds_read_b64_tr_b16 v[44:45], v148
    v_mfma_f32_16x16x32_bf16 v[196:199], v[64:67], v[132:135], v[196:199]
    ds_read_b64_tr_b16 v[46:47], v148 offset:3072
    v_mfma_f32_16x16x32_bf16 v[220:223], v[64:67], v[136:139], v[220:223]
    ds_read_b64_tr_b16 v[48:49], v149
    v_mfma_f32_16x16x32_bf16 v[244:247], v[64:67], v[140:143], v[244:247]
    ds_read_b64_tr_b16 v[50:51], v149 offset:3072
    v_mfma_f32_16x16x32_bf16 v[176:179], v[68:71], v[128:131], v[176:179]
    v_mfma_f32_16x16x32_bf16 v[200:203], v[68:71], v[132:135], v[200:203]
    v_mfma_f32_16x16x32_bf16 v[224:227], v[68:71], v[136:139], v[224:227]
    v_mfma_f32_16x16x32_bf16 v[248:251], v[68:71], v[140:143], v[248:251]
    v_mfma_f32_16x16x32_bf16 v[180:183], v[72:75], v[128:131], v[180:183]
    v_mfma_f32_16x16x32_bf16 v[204:207], v[72:75], v[132:135], v[204:207]
    v_mfma_f32_16x16x32_bf16 v[228:231], v[72:75], v[136:139], v[228:231]
    v_mfma_f32_16x16x32_bf16 v[252:255], v[72:75], v[140:143], v[252:255]
    s_waitcnt lgkmcnt(12)
    v_mfma_f32_16x16x32_bf16 v[160:163], v[28:31], v[112:115], v[160:163]
    s_waitcnt lgkmcnt(0)
    s_barrier
    ds_read_b128 v[128:131], v153
    v_mfma_f32_16x16x32_bf16 v[184:187], v[28:31], v[116:119], v[184:187]
    ds_read_b64_tr_b16 v[52:53], v144 offset:24576
    v_mfma_f32_16x16x32_bf16 v[208:211], v[28:31], v[120:123], v[208:211]
    ds_read_b64_tr_b16 v[54:55], v144 offset:27648
    v_mfma_f32_16x16x32_bf16 v[232:235], v[28:31], v[124:127], v[232:235]
    ds_read_b128 v[132:135], v152 offset:12288
    v_mfma_f32_16x16x32_bf16 v[164:167], v[32:35], v[112:115], v[164:167]
    ds_read_b128 v[136:139], v151 offset:24576
    v_mfma_f32_16x16x32_bf16 v[188:191], v[32:35], v[116:119], v[188:191]
    ds_read_b128 v[140:143], v150 offset:36864
    v_mfma_f32_16x16x32_bf16 v[212:215], v[32:35], v[120:123], v[212:215]
    ds_read_b64_tr_b16 v[56:57], v145 offset:24576
    v_mfma_f32_16x16x32_bf16 v[236:239], v[32:35], v[124:127], v[236:239]
    ds_read_b64_tr_b16 v[58:59], v145 offset:27648
    v_mfma_f32_16x16x32_bf16 v[168:171], v[36:39], v[112:115], v[168:171]
    ds_read_b64_tr_b16 v[60:61], v146 offset:24576
    v_mfma_f32_16x16x32_bf16 v[192:195], v[36:39], v[116:119], v[192:195]
    ds_read_b64_tr_b16 v[62:63], v146 offset:27648
    v_mfma_f32_16x16x32_bf16 v[216:219], v[36:39], v[120:123], v[216:219]
    ds_read_b64_tr_b16 v[64:65], v147 offset:24576
    v_mfma_f32_16x16x32_bf16 v[240:243], v[36:39], v[124:127], v[240:243]
    ds_read_b64_tr_b16 v[66:67], v147 offset:27648
    v_mfma_f32_16x16x32_bf16 v[172:175], v[40:43], v[112:115], v[172:175]
    ds_read_b64_tr_b16 v[68:69], v148 offset:24576
    v_mfma_f32_16x16x32_bf16 v[196:199], v[40:43], v[116:119], v[196:199]
    ds_read_b64_tr_b16 v[70:71], v148 offset:27648
    v_mfma_f32_16x16x32_bf16 v[220:223], v[40:43], v[120:123], v[220:223]
    ds_read_b64_tr_b16 v[72:73], v149 offset:24576
    v_mfma_f32_16x16x32_bf16 v[244:247], v[40:43], v[124:127], v[244:247]
    ds_read_b64_tr_b16 v[74:75], v149 offset:27648
    v_mfma_f32_16x16x32_bf16 v[176:179], v[44:47], v[112:115], v[176:179]
    v_xor_b32 v144, 0x10000, v144
    v_mfma_f32_16x16x32_bf16 v[200:203], v[44:47], v[116:119], v[200:203]
    v_xor_b32 v145, 0x10000, v145
    v_mfma_f32_16x16x32_bf16 v[224:227], v[44:47], v[120:123], v[224:227]
    v_xor_b32 v146, 0x10000, v146
    v_mfma_f32_16x16x32_bf16 v[248:251], v[44:47], v[124:127], v[248:251]
    v_xor_b32 v147, 0x10000, v147
    v_mfma_f32_16x16x32_bf16 v[180:183], v[48:51], v[112:115], v[180:183]
    v_xor_b32 v148, 0x10000, v148
    v_mfma_f32_16x16x32_bf16 v[204:207], v[48:51], v[116:119], v[204:207]
    v_xor_b32 v149, 0x10000, v149
    v_mfma_f32_16x16x32_bf16 v[228:231], v[48:51], v[120:123], v[228:231]
    v_mfma_f32_16x16x32_bf16 v[252:255], v[48:51], v[124:127], v[252:255]
    s_waitcnt lgkmcnt(12)
    v_mfma_f32_16x16x32_bf16 v[160:163], v[52:55], v[128:131], v[160:163]
    s_waitcnt lgkmcnt(0)
    s_barrier
    ds_read_b128 v[112:115], v150 offset:256
    v_mfma_f32_16x16x32_bf16 v[184:187], v[52:55], v[132:135], v[184:187]
    ds_read_b64_tr_b16 v[28:29], v144
    v_mfma_f32_16x16x32_bf16 v[208:211], v[52:55], v[136:139], v[208:211]
    ds_read_b64_tr_b16 v[30:31], v144 offset:3072
    v_mfma_f32_16x16x32_bf16 v[232:235], v[52:55], v[140:143], v[232:235]
    ds_read_b128 v[116:119], v151 offset:12544
    v_mfma_f32_16x16x32_bf16 v[164:167], v[56:59], v[128:131], v[164:167]
    ds_read_b128 v[120:123], v152 offset:24832
    v_mfma_f32_16x16x32_bf16 v[188:191], v[56:59], v[132:135], v[188:191]
    ds_read_b128 v[124:127], v153 offset:37120
    v_mfma_f32_16x16x32_bf16 v[212:215], v[56:59], v[136:139], v[212:215]
    ds_read_b64_tr_b16 v[32:33], v145
    v_mfma_f32_16x16x32_bf16 v[236:239], v[56:59], v[140:143], v[236:239]
    ds_read_b64_tr_b16 v[34:35], v145 offset:3072
    v_mfma_f32_16x16x32_bf16 v[168:171], v[60:63], v[128:131], v[168:171]
    ds_read_b64_tr_b16 v[36:37], v146
    v_mfma_f32_16x16x32_bf16 v[192:195], v[60:63], v[132:135], v[192:195]
    ds_read_b64_tr_b16 v[38:39], v146 offset:3072
    v_mfma_f32_16x16x32_bf16 v[216:219], v[60:63], v[136:139], v[216:219]
    ds_read_b64_tr_b16 v[40:41], v147
    v_mfma_f32_16x16x32_bf16 v[240:243], v[60:63], v[140:143], v[240:243]
    ds_read_b64_tr_b16 v[42:43], v147 offset:3072
    v_mfma_f32_16x16x32_bf16 v[172:175], v[64:67], v[128:131], v[172:175]
    ds_read_b64_tr_b16 v[44:45], v148
    v_mfma_f32_16x16x32_bf16 v[196:199], v[64:67], v[132:135], v[196:199]
    ds_read_b64_tr_b16 v[46:47], v148 offset:3072
    v_mfma_f32_16x16x32_bf16 v[220:223], v[64:67], v[136:139], v[220:223]
    ds_read_b64_tr_b16 v[48:49], v149
    v_mfma_f32_16x16x32_bf16 v[244:247], v[64:67], v[140:143], v[244:247]
    ds_read_b64_tr_b16 v[50:51], v149 offset:3072
    v_mfma_f32_16x16x32_bf16 v[176:179], v[68:71], v[128:131], v[176:179]
    v_mfma_f32_16x16x32_bf16 v[200:203], v[68:71], v[132:135], v[200:203]
    v_mfma_f32_16x16x32_bf16 v[224:227], v[68:71], v[136:139], v[224:227]
    v_mfma_f32_16x16x32_bf16 v[248:251], v[68:71], v[140:143], v[248:251]
    v_mfma_f32_16x16x32_bf16 v[180:183], v[72:75], v[128:131], v[180:183]
    v_mfma_f32_16x16x32_bf16 v[204:207], v[72:75], v[132:135], v[204:207]
    v_mfma_f32_16x16x32_bf16 v[228:231], v[72:75], v[136:139], v[228:231]
    v_mfma_f32_16x16x32_bf16 v[252:255], v[72:75], v[140:143], v[252:255]
    s_waitcnt lgkmcnt(12)
    v_mfma_f32_16x16x32_bf16 v[160:163], v[28:31], v[112:115], v[160:163]
    s_waitcnt lgkmcnt(0)
    s_barrier
    ds_read_b128 v[128:131], v151 offset:256
    v_mfma_f32_16x16x32_bf16 v[184:187], v[28:31], v[116:119], v[184:187]
    ds_read_b64_tr_b16 v[52:53], v144 offset:24576
    v_mfma_f32_16x16x32_bf16 v[208:211], v[28:31], v[120:123], v[208:211]
    ds_read_b64_tr_b16 v[54:55], v144 offset:27648
    v_mfma_f32_16x16x32_bf16 v[232:235], v[28:31], v[124:127], v[232:235]
    ds_read_b128 v[132:135], v150 offset:12544
    v_mfma_f32_16x16x32_bf16 v[164:167], v[32:35], v[112:115], v[164:167]
    ds_read_b128 v[136:139], v153 offset:24832
    v_mfma_f32_16x16x32_bf16 v[188:191], v[32:35], v[116:119], v[188:191]
    ds_read_b128 v[140:143], v152 offset:37120
    v_mfma_f32_16x16x32_bf16 v[212:215], v[32:35], v[120:123], v[212:215]
    ds_read_b64_tr_b16 v[56:57], v145 offset:24576
    v_mfma_f32_16x16x32_bf16 v[236:239], v[32:35], v[124:127], v[236:239]
    ds_read_b64_tr_b16 v[58:59], v145 offset:27648
    v_mfma_f32_16x16x32_bf16 v[168:171], v[36:39], v[112:115], v[168:171]
    ds_read_b64_tr_b16 v[60:61], v146 offset:24576
    v_mfma_f32_16x16x32_bf16 v[192:195], v[36:39], v[116:119], v[192:195]
    ds_read_b64_tr_b16 v[62:63], v146 offset:27648
    v_mfma_f32_16x16x32_bf16 v[216:219], v[36:39], v[120:123], v[216:219]
    ds_read_b64_tr_b16 v[64:65], v147 offset:24576
    v_mfma_f32_16x16x32_bf16 v[240:243], v[36:39], v[124:127], v[240:243]
    ds_read_b64_tr_b16 v[66:67], v147 offset:27648
    v_mfma_f32_16x16x32_bf16 v[172:175], v[40:43], v[112:115], v[172:175]
    ds_read_b64_tr_b16 v[68:69], v148 offset:24576
    v_mfma_f32_16x16x32_bf16 v[196:199], v[40:43], v[116:119], v[196:199]
    ds_read_b64_tr_b16 v[70:71], v148 offset:27648
    v_mfma_f32_16x16x32_bf16 v[220:223], v[40:43], v[120:123], v[220:223]
    ds_read_b64_tr_b16 v[72:73], v149 offset:24576
    v_mfma_f32_16x16x32_bf16 v[244:247], v[40:43], v[124:127], v[244:247]
    ds_read_b64_tr_b16 v[74:75], v149 offset:27648
    v_mfma_f32_16x16x32_bf16 v[176:179], v[44:47], v[112:115], v[176:179]
    v_xor_b32 v144, 0x10000, v144
    v_mfma_f32_16x16x32_bf16 v[200:203], v[44:47], v[116:119], v[200:203]
    v_xor_b32 v145, 0x10000, v145
    v_mfma_f32_16x16x32_bf16 v[224:227], v[44:47], v[120:123], v[224:227]
    v_xor_b32 v146, 0x10000, v146
    v_mfma_f32_16x16x32_bf16 v[248:251], v[44:47], v[124:127], v[248:251]
    v_xor_b32 v147, 0x10000, v147
    v_mfma_f32_16x16x32_bf16 v[180:183], v[48:51], v[112:115], v[180:183]
    v_xor_b32 v148, 0x10000, v148
    v_mfma_f32_16x16x32_bf16 v[204:207], v[48:51], v[116:119], v[204:207]
    v_xor_b32 v149, 0x10000, v149
    v_mfma_f32_16x16x32_bf16 v[228:231], v[48:51], v[120:123], v[228:231]
    v_mfma_f32_16x16x32_bf16 v[252:255], v[48:51], v[124:127], v[252:255]
    s_waitcnt lgkmcnt(12)
    v_mfma_f32_16x16x32_bf16 v[160:163], v[52:55], v[128:131], v[160:163]
    s_waitcnt lgkmcnt(0)
    s_barrier
    ds_read_b128 v[112:115], v152 offset:256
    v_mfma_f32_16x16x32_bf16 v[184:187], v[52:55], v[132:135], v[184:187]
    ds_read_b64_tr_b16 v[28:29], v144
    v_mfma_f32_16x16x32_bf16 v[208:211], v[52:55], v[136:139], v[208:211]
    ds_read_b64_tr_b16 v[30:31], v144 offset:3072
    v_mfma_f32_16x16x32_bf16 v[232:235], v[52:55], v[140:143], v[232:235]
    ds_read_b128 v[116:119], v153 offset:12544
    v_mfma_f32_16x16x32_bf16 v[164:167], v[56:59], v[128:131], v[164:167]
    ds_read_b128 v[120:123], v150 offset:24832
    v_mfma_f32_16x16x32_bf16 v[188:191], v[56:59], v[132:135], v[188:191]
    ds_read_b128 v[124:127], v151 offset:37120
    v_mfma_f32_16x16x32_bf16 v[212:215], v[56:59], v[136:139], v[212:215]
    ds_read_b64_tr_b16 v[32:33], v145
    v_mfma_f32_16x16x32_bf16 v[236:239], v[56:59], v[140:143], v[236:239]
    ds_read_b64_tr_b16 v[34:35], v145 offset:3072
    v_mfma_f32_16x16x32_bf16 v[168:171], v[60:63], v[128:131], v[168:171]
    ds_read_b64_tr_b16 v[36:37], v146
    v_mfma_f32_16x16x32_bf16 v[192:195], v[60:63], v[132:135], v[192:195]
    ds_read_b64_tr_b16 v[38:39], v146 offset:3072
    v_mfma_f32_16x16x32_bf16 v[216:219], v[60:63], v[136:139], v[216:219]
    ds_read_b64_tr_b16 v[40:41], v147
    v_mfma_f32_16x16x32_bf16 v[240:243], v[60:63], v[140:143], v[240:243]
    ds_read_b64_tr_b16 v[42:43], v147 offset:3072
    v_mfma_f32_16x16x32_bf16 v[172:175], v[64:67], v[128:131], v[172:175]
    ds_read_b64_tr_b16 v[44:45], v148
    v_mfma_f32_16x16x32_bf16 v[196:199], v[64:67], v[132:135], v[196:199]
    ds_read_b64_tr_b16 v[46:47], v148 offset:3072
    v_mfma_f32_16x16x32_bf16 v[220:223], v[64:67], v[136:139], v[220:223]
    ds_read_b64_tr_b16 v[48:49], v149
    v_mfma_f32_16x16x32_bf16 v[244:247], v[64:67], v[140:143], v[244:247]
    ds_read_b64_tr_b16 v[50:51], v149 offset:3072
    v_mfma_f32_16x16x32_bf16 v[176:179], v[68:71], v[128:131], v[176:179]
    v_mfma_f32_16x16x32_bf16 v[200:203], v[68:71], v[132:135], v[200:203]
    v_mfma_f32_16x16x32_bf16 v[224:227], v[68:71], v[136:139], v[224:227]
    v_mfma_f32_16x16x32_bf16 v[248:251], v[68:71], v[140:143], v[248:251]
    v_mfma_f32_16x16x32_bf16 v[180:183], v[72:75], v[128:131], v[180:183]
    v_mfma_f32_16x16x32_bf16 v[204:207], v[72:75], v[132:135], v[204:207]
    v_mfma_f32_16x16x32_bf16 v[228:231], v[72:75], v[136:139], v[228:231]
    v_mfma_f32_16x16x32_bf16 v[252:255], v[72:75], v[140:143], v[252:255]
    s_waitcnt lgkmcnt(12)
    v_mfma_f32_16x16x32_bf16 v[160:163], v[28:31], v[112:115], v[160:163]
    s_waitcnt lgkmcnt(0)
    s_barrier
    ds_read_b128 v[128:131], v153 offset:256
    v_mfma_f32_16x16x32_bf16 v[184:187], v[28:31], v[116:119], v[184:187]
    ds_read_b64_tr_b16 v[52:53], v144 offset:24576
    v_mfma_f32_16x16x32_bf16 v[208:211], v[28:31], v[120:123], v[208:211]
    ds_read_b64_tr_b16 v[54:55], v144 offset:27648
    v_mfma_f32_16x16x32_bf16 v[232:235], v[28:31], v[124:127], v[232:235]
    ds_read_b128 v[132:135], v152 offset:12544
    v_mfma_f32_16x16x32_bf16 v[164:167], v[32:35], v[112:115], v[164:167]
    ds_read_b128 v[136:139], v151 offset:24832
    v_mfma_f32_16x16x32_bf16 v[188:191], v[32:35], v[116:119], v[188:191]
    ds_read_b128 v[140:143], v150 offset:37120
    v_mfma_f32_16x16x32_bf16 v[212:215], v[32:35], v[120:123], v[212:215]
    ds_read_b64_tr_b16 v[56:57], v145 offset:24576
    v_mfma_f32_16x16x32_bf16 v[236:239], v[32:35], v[124:127], v[236:239]
    ds_read_b64_tr_b16 v[58:59], v145 offset:27648
    v_mfma_f32_16x16x32_bf16 v[168:171], v[36:39], v[112:115], v[168:171]
    ds_read_b64_tr_b16 v[60:61], v146 offset:24576
    v_mfma_f32_16x16x32_bf16 v[192:195], v[36:39], v[116:119], v[192:195]
    ds_read_b64_tr_b16 v[62:63], v146 offset:27648
    v_mfma_f32_16x16x32_bf16 v[216:219], v[36:39], v[120:123], v[216:219]
    ds_read_b64_tr_b16 v[64:65], v147 offset:24576
    v_mfma_f32_16x16x32_bf16 v[240:243], v[36:39], v[124:127], v[240:243]
    ds_read_b64_tr_b16 v[66:67], v147 offset:27648
    v_mfma_f32_16x16x32_bf16 v[172:175], v[40:43], v[112:115], v[172:175]
    ds_read_b64_tr_b16 v[68:69], v148 offset:24576
    v_mfma_f32_16x16x32_bf16 v[196:199], v[40:43], v[116:119], v[196:199]
    ds_read_b64_tr_b16 v[70:71], v148 offset:27648
    v_mfma_f32_16x16x32_bf16 v[220:223], v[40:43], v[120:123], v[220:223]
    ds_read_b64_tr_b16 v[72:73], v149 offset:24576
    v_mfma_f32_16x16x32_bf16 v[244:247], v[40:43], v[124:127], v[244:247]
    ds_read_b64_tr_b16 v[74:75], v149 offset:27648
    v_mfma_f32_16x16x32_bf16 v[176:179], v[44:47], v[112:115], v[176:179]
    v_xor_b32 v144, 0x10000, v144
    v_mfma_f32_16x16x32_bf16 v[200:203], v[44:47], v[116:119], v[200:203]
    v_xor_b32 v145, 0x10000, v145
    v_mfma_f32_16x16x32_bf16 v[224:227], v[44:47], v[120:123], v[224:227]
    v_xor_b32 v146, 0x10000, v146
    v_mfma_f32_16x16x32_bf16 v[248:251], v[44:47], v[124:127], v[248:251]
    v_xor_b32 v147, 0x10000, v147
    v_mfma_f32_16x16x32_bf16 v[180:183], v[48:51], v[112:115], v[180:183]
    v_xor_b32 v148, 0x10000, v148
    v_mfma_f32_16x16x32_bf16 v[204:207], v[48:51], v[116:119], v[204:207]
    v_xor_b32 v149, 0x10000, v149
    v_mfma_f32_16x16x32_bf16 v[228:231], v[48:51], v[120:123], v[228:231]
    v_mfma_f32_16x16x32_bf16 v[252:255], v[48:51], v[124:127], v[252:255]
    s_waitcnt lgkmcnt(12)
    v_mfma_f32_16x16x32_bf16 v[160:163], v[52:55], v[128:131], v[160:163]
    s_waitcnt lgkmcnt(0)
    s_barrier
    ds_read_b128 v[112:115], v150 offset:512
    v_mfma_f32_16x16x32_bf16 v[184:187], v[52:55], v[132:135], v[184:187]
    ds_read_b64_tr_b16 v[28:29], v144
    v_mfma_f32_16x16x32_bf16 v[208:211], v[52:55], v[136:139], v[208:211]
    ds_read_b64_tr_b16 v[30:31], v144 offset:3072
    v_mfma_f32_16x16x32_bf16 v[232:235], v[52:55], v[140:143], v[232:235]
    ds_read_b128 v[116:119], v151 offset:12800
    v_mfma_f32_16x16x32_bf16 v[164:167], v[56:59], v[128:131], v[164:167]
    ds_read_b128 v[120:123], v152 offset:25088
    v_mfma_f32_16x16x32_bf16 v[188:191], v[56:59], v[132:135], v[188:191]
    ds_read_b128 v[124:127], v153 offset:37376
    v_mfma_f32_16x16x32_bf16 v[212:215], v[56:59], v[136:139], v[212:215]
    ds_read_b64_tr_b16 v[32:33], v145
    v_mfma_f32_16x16x32_bf16 v[236:239], v[56:59], v[140:143], v[236:239]
    ds_read_b64_tr_b16 v[34:35], v145 offset:3072
    v_mfma_f32_16x16x32_bf16 v[168:171], v[60:63], v[128:131], v[168:171]
    ds_read_b64_tr_b16 v[36:37], v146
    v_mfma_f32_16x16x32_bf16 v[192:195], v[60:63], v[132:135], v[192:195]
    ds_read_b64_tr_b16 v[38:39], v146 offset:3072
    v_mfma_f32_16x16x32_bf16 v[216:219], v[60:63], v[136:139], v[216:219]
    ds_read_b64_tr_b16 v[40:41], v147
    v_mfma_f32_16x16x32_bf16 v[240:243], v[60:63], v[140:143], v[240:243]
    ds_read_b64_tr_b16 v[42:43], v147 offset:3072
    v_mfma_f32_16x16x32_bf16 v[172:175], v[64:67], v[128:131], v[172:175]
    ds_read_b64_tr_b16 v[44:45], v148
    v_mfma_f32_16x16x32_bf16 v[196:199], v[64:67], v[132:135], v[196:199]
    ds_read_b64_tr_b16 v[46:47], v148 offset:3072
    v_mfma_f32_16x16x32_bf16 v[220:223], v[64:67], v[136:139], v[220:223]
    ds_read_b64_tr_b16 v[48:49], v149
    v_mfma_f32_16x16x32_bf16 v[244:247], v[64:67], v[140:143], v[244:247]
    ds_read_b64_tr_b16 v[50:51], v149 offset:3072
    v_mfma_f32_16x16x32_bf16 v[176:179], v[68:71], v[128:131], v[176:179]
    v_mfma_f32_16x16x32_bf16 v[200:203], v[68:71], v[132:135], v[200:203]
    v_mfma_f32_16x16x32_bf16 v[224:227], v[68:71], v[136:139], v[224:227]
    v_mfma_f32_16x16x32_bf16 v[248:251], v[68:71], v[140:143], v[248:251]
    v_mfma_f32_16x16x32_bf16 v[180:183], v[72:75], v[128:131], v[180:183]
    v_mfma_f32_16x16x32_bf16 v[204:207], v[72:75], v[132:135], v[204:207]
    v_mfma_f32_16x16x32_bf16 v[228:231], v[72:75], v[136:139], v[228:231]
    v_mfma_f32_16x16x32_bf16 v[252:255], v[72:75], v[140:143], v[252:255]
    s_waitcnt lgkmcnt(12)
    v_mfma_f32_16x16x32_bf16 v[160:163], v[28:31], v[112:115], v[160:163]
    s_waitcnt lgkmcnt(0)
    s_barrier
    ds_read_b128 v[128:131], v151 offset:512
    v_mfma_f32_16x16x32_bf16 v[184:187], v[28:31], v[116:119], v[184:187]
    ds_read_b64_tr_b16 v[52:53], v144 offset:24576
    v_mfma_f32_16x16x32_bf16 v[208:211], v[28:31], v[120:123], v[208:211]
    ds_read_b64_tr_b16 v[54:55], v144 offset:27648
    v_mfma_f32_16x16x32_bf16 v[232:235], v[28:31], v[124:127], v[232:235]
    ds_read_b128 v[132:135], v150 offset:12800
    v_mfma_f32_16x16x32_bf16 v[164:167], v[32:35], v[112:115], v[164:167]
    ds_read_b128 v[136:139], v153 offset:25088
    v_mfma_f32_16x16x32_bf16 v[188:191], v[32:35], v[116:119], v[188:191]
    ds_read_b128 v[140:143], v152 offset:37376
    v_mfma_f32_16x16x32_bf16 v[212:215], v[32:35], v[120:123], v[212:215]
    ds_read_b64_tr_b16 v[56:57], v145 offset:24576
    v_mfma_f32_16x16x32_bf16 v[236:239], v[32:35], v[124:127], v[236:239]
    ds_read_b64_tr_b16 v[58:59], v145 offset:27648
    v_mfma_f32_16x16x32_bf16 v[168:171], v[36:39], v[112:115], v[168:171]
    ds_read_b64_tr_b16 v[60:61], v146 offset:24576
    v_mfma_f32_16x16x32_bf16 v[192:195], v[36:39], v[116:119], v[192:195]
    ds_read_b64_tr_b16 v[62:63], v146 offset:27648
    v_mfma_f32_16x16x32_bf16 v[216:219], v[36:39], v[120:123], v[216:219]
    ds_read_b64_tr_b16 v[64:65], v147 offset:24576
    v_mfma_f32_16x16x32_bf16 v[240:243], v[36:39], v[124:127], v[240:243]
    ds_read_b64_tr_b16 v[66:67], v147 offset:27648
    v_mfma_f32_16x16x32_bf16 v[172:175], v[40:43], v[112:115], v[172:175]
    ds_read_b64_tr_b16 v[68:69], v148 offset:24576
    v_mfma_f32_16x16x32_bf16 v[196:199], v[40:43], v[116:119], v[196:199]
    ds_read_b64_tr_b16 v[70:71], v148 offset:27648
    v_mfma_f32_16x16x32_bf16 v[220:223], v[40:43], v[120:123], v[220:223]
    ds_read_b64_tr_b16 v[72:73], v149 offset:24576
    v_mfma_f32_16x16x32_bf16 v[244:247], v[40:43], v[124:127], v[244:247]
    ds_read_b64_tr_b16 v[74:75], v149 offset:27648
    v_mfma_f32_16x16x32_bf16 v[176:179], v[44:47], v[112:115], v[176:179]
    v_xor_b32 v144, 0x10000, v144
    v_mfma_f32_16x16x32_bf16 v[200:203], v[44:47], v[116:119], v[200:203]
    v_xor_b32 v145, 0x10000, v145
    v_mfma_f32_16x16x32_bf16 v[224:227], v[44:47], v[120:123], v[224:227]
    v_xor_b32 v146, 0x10000, v146
    v_mfma_f32_16x16x32_bf16 v[248:251], v[44:47], v[124:127], v[248:251]
    v_xor_b32 v147, 0x10000, v147
    v_mfma_f32_16x16x32_bf16 v[180:183], v[48:51], v[112:115], v[180:183]
    v_xor_b32 v148, 0x10000, v148
    v_mfma_f32_16x16x32_bf16 v[204:207], v[48:51], v[116:119], v[204:207]
    v_xor_b32 v149, 0x10000, v149
    v_mfma_f32_16x16x32_bf16 v[228:231], v[48:51], v[120:123], v[228:231]
    v_mfma_f32_16x16x32_bf16 v[252:255], v[48:51], v[124:127], v[252:255]
    s_waitcnt lgkmcnt(12)
    v_mfma_f32_16x16x32_bf16 v[160:163], v[52:55], v[128:131], v[160:163]
    s_waitcnt lgkmcnt(0)
    s_barrier
    ds_read_b128 v[112:115], v152 offset:512
    v_mfma_f32_16x16x32_bf16 v[184:187], v[52:55], v[132:135], v[184:187]
    ds_read_b64_tr_b16 v[28:29], v144
    v_mfma_f32_16x16x32_bf16 v[208:211], v[52:55], v[136:139], v[208:211]
    ds_read_b64_tr_b16 v[30:31], v144 offset:3072
    v_mfma_f32_16x16x32_bf16 v[232:235], v[52:55], v[140:143], v[232:235]
    ds_read_b128 v[116:119], v153 offset:12800
    v_mfma_f32_16x16x32_bf16 v[164:167], v[56:59], v[128:131], v[164:167]
    ds_read_b128 v[120:123], v150 offset:25088
    v_mfma_f32_16x16x32_bf16 v[188:191], v[56:59], v[132:135], v[188:191]
    ds_read_b128 v[124:127], v151 offset:37376
    v_mfma_f32_16x16x32_bf16 v[212:215], v[56:59], v[136:139], v[212:215]
    ds_read_b64_tr_b16 v[32:33], v145
    v_mfma_f32_16x16x32_bf16 v[236:239], v[56:59], v[140:143], v[236:239]
    ds_read_b64_tr_b16 v[34:35], v145 offset:3072
    v_mfma_f32_16x16x32_bf16 v[168:171], v[60:63], v[128:131], v[168:171]
    ds_read_b64_tr_b16 v[36:37], v146
    v_mfma_f32_16x16x32_bf16 v[192:195], v[60:63], v[132:135], v[192:195]
    ds_read_b64_tr_b16 v[38:39], v146 offset:3072
    v_mfma_f32_16x16x32_bf16 v[216:219], v[60:63], v[136:139], v[216:219]
    ds_read_b64_tr_b16 v[40:41], v147
    v_mfma_f32_16x16x32_bf16 v[240:243], v[60:63], v[140:143], v[240:243]
    ds_read_b64_tr_b16 v[42:43], v147 offset:3072
    v_mfma_f32_16x16x32_bf16 v[172:175], v[64:67], v[128:131], v[172:175]
    ds_read_b64_tr_b16 v[44:45], v148
    v_mfma_f32_16x16x32_bf16 v[196:199], v[64:67], v[132:135], v[196:199]
    ds_read_b64_tr_b16 v[46:47], v148 offset:3072
    v_mfma_f32_16x16x32_bf16 v[220:223], v[64:67], v[136:139], v[220:223]
    ds_read_b64_tr_b16 v[48:49], v149
    v_mfma_f32_16x16x32_bf16 v[244:247], v[64:67], v[140:143], v[244:247]
    ds_read_b64_tr_b16 v[50:51], v149 offset:3072
    v_mfma_f32_16x16x32_bf16 v[176:179], v[68:71], v[128:131], v[176:179]
    ds_read_b128 v[76:79], v153 offset:512
    v_mfma_f32_16x16x32_bf16 v[200:203], v[68:71], v[132:135], v[200:203]
    ds_read_b128 v[80:83], v152 offset:12800
    v_mfma_f32_16x16x32_bf16 v[224:227], v[68:71], v[136:139], v[224:227]
    ds_read_b128 v[84:87], v151 offset:25088
    v_mfma_f32_16x16x32_bf16 v[248:251], v[68:71], v[140:143], v[248:251]
    ds_read_b128 v[88:91], v150 offset:37376
    v_mfma_f32_16x16x32_bf16 v[180:183], v[72:75], v[128:131], v[180:183]
    v_mfma_f32_16x16x32_bf16 v[204:207], v[72:75], v[132:135], v[204:207]
    v_mfma_f32_16x16x32_bf16 v[228:231], v[72:75], v[136:139], v[228:231]
    v_mfma_f32_16x16x32_bf16 v[252:255], v[72:75], v[140:143], v[252:255]
    s_waitcnt lgkmcnt(15)
    v_mfma_f32_16x16x32_bf16 v[160:163], v[28:31], v[112:115], v[160:163]
    s_waitcnt lgkmcnt(0)
    s_barrier
    ds_read_b64_tr_b16 v[52:53], v144 offset:24576
    ds_read_b64_tr_b16 v[54:55], v144 offset:27648
    v_mfma_f32_16x16x32_bf16 v[164:167], v[32:35], v[112:115], v[164:167]
    ds_read_b64_tr_b16 v[56:57], v145 offset:24576
    ds_read_b64_tr_b16 v[58:59], v145 offset:27648
    v_mfma_f32_16x16x32_bf16 v[168:171], v[36:39], v[112:115], v[168:171]
    ds_read_b64_tr_b16 v[60:61], v146 offset:24576
    ds_read_b64_tr_b16 v[62:63], v146 offset:27648
    v_mfma_f32_16x16x32_bf16 v[172:175], v[40:43], v[112:115], v[172:175]
    ds_read_b64_tr_b16 v[64:65], v147 offset:24576
    ds_read_b64_tr_b16 v[66:67], v147 offset:27648
    v_mfma_f32_16x16x32_bf16 v[176:179], v[44:47], v[112:115], v[176:179]
    ds_read_b64_tr_b16 v[68:69], v148 offset:24576
    ds_read_b64_tr_b16 v[70:71], v148 offset:27648
    v_mfma_f32_16x16x32_bf16 v[180:183], v[48:51], v[112:115], v[180:183]
    ds_read_b64_tr_b16 v[72:73], v149 offset:24576
    ds_read_b64_tr_b16 v[74:75], v149 offset:27648
    v_mfma_f32_16x16x32_bf16 v[184:187], v[28:31], v[116:119], v[184:187]
    v_mfma_f32_16x16x32_bf16 v[188:191], v[32:35], v[116:119], v[188:191]
    v_mfma_f32_16x16x32_bf16 v[192:195], v[36:39], v[116:119], v[192:195]
    v_mfma_f32_16x16x32_bf16 v[196:199], v[40:43], v[116:119], v[196:199]
    v_mfma_f32_16x16x32_bf16 v[200:203], v[44:47], v[116:119], v[200:203]
    v_mfma_f32_16x16x32_bf16 v[204:207], v[48:51], v[116:119], v[204:207]
    s_waitcnt lgkmcnt(9)
    v_mfma_f32_16x16x32_bf16 v[160:163], v[52:55], v[76:79], v[160:163]
    s_waitcnt lgkmcnt(7)
    v_mfma_f32_16x16x32_bf16 v[164:167], v[56:59], v[76:79], v[164:167]
    s_waitcnt lgkmcnt(5)
    v_mfma_f32_16x16x32_bf16 v[168:171], v[60:63], v[76:79], v[168:171]
    s_waitcnt lgkmcnt(3)
    v_mfma_f32_16x16x32_bf16 v[172:175], v[64:67], v[76:79], v[172:175]
    s_waitcnt lgkmcnt(2)
    v_mfma_f32_16x16x32_bf16 v[176:179], v[68:71], v[76:79], v[176:179]
    s_waitcnt lgkmcnt(0)
    v_mfma_f32_16x16x32_bf16 v[180:183], v[72:75], v[76:79], v[180:183]
    v_mfma_f32_16x16x32_bf16 v[184:187], v[52:55], v[80:83], v[184:187]
    v_mfma_f32_16x16x32_bf16 v[188:191], v[56:59], v[80:83], v[188:191]
    v_mfma_f32_16x16x32_bf16 v[192:195], v[60:63], v[80:83], v[192:195]
    v_cvt_pk_bf16_f32 v128, v160, v161
    v_cvt_pk_bf16_f32 v130, v164, v165
    v_cvt_pk_bf16_f32 v129, v162, v163
    v_mfma_f32_16x16x32_bf16 v[196:199], v[64:67], v[80:83], v[196:199]
    v_cvt_pk_bf16_f32 v131, v166, v167
    v_cvt_pk_bf16_f32 v132, v168, v169
    v_cvt_pk_bf16_f32 v134, v172, v173
    v_mfma_f32_16x16x32_bf16 v[200:203], v[68:71], v[80:83], v[200:203]
    v_cvt_pk_bf16_f32 v133, v170, v171
    v_cvt_pk_bf16_f32 v135, v174, v175
    v_permlane16_swap_b32 v128, v130
    v_mfma_f32_16x16x32_bf16 v[204:207], v[72:75], v[80:83], v[204:207]
    v_permlane16_swap_b32 v129, v131
    ds_write_b128 v154, v[128:131]
    v_cvt_pk_bf16_f32 v136, v176, v177
    v_mfma_f32_16x16x32_bf16 v[208:211], v[28:31], v[120:123], v[208:211]
    v_cvt_pk_bf16_f32 v138, v180, v181
    v_cvt_pk_bf16_f32 v137, v178, v179
    v_cvt_pk_bf16_f32 v139, v182, v183
    v_mfma_f32_16x16x32_bf16 v[212:215], v[32:35], v[120:123], v[212:215]
    v_permlane16_swap_b32 v132, v134
    v_permlane16_swap_b32 v133, v135
    ds_write_b128 v155, v[132:135]
    v_mfma_f32_16x16x32_bf16 v[216:219], v[36:39], v[120:123], v[216:219]
    v_permlane16_swap_b32 v136, v138
    v_permlane16_swap_b32 v137, v139
    ds_write_b128 v156, v[136:139]
    v_mfma_f32_16x16x32_bf16 v[220:223], v[40:43], v[120:123], v[220:223]
    v_mfma_f32_16x16x32_bf16 v[224:227], v[44:47], v[120:123], v[224:227]
    v_cvt_pk_bf16_f32 v140, v184, v185
    v_cvt_pk_bf16_f32 v142, v188, v189
    v_cvt_pk_bf16_f32 v141, v186, v187
    v_mfma_f32_16x16x32_bf16 v[228:231], v[48:51], v[120:123], v[228:231]
    v_cvt_pk_bf16_f32 v143, v190, v191
    v_xor_b32 v154, 64, v154
    v_cvt_pk_bf16_f32 v92, v192, v193
    v_mfma_f32_16x16x32_bf16 v[208:211], v[52:55], v[84:87], v[208:211]
    v_cvt_pk_bf16_f32 v94, v196, v197
    v_cvt_pk_bf16_f32 v93, v194, v195
    v_cvt_pk_bf16_f32 v95, v198, v199
    v_mfma_f32_16x16x32_bf16 v[212:215], v[56:59], v[84:87], v[212:215]
    v_xor_b32 v155, 64, v155
    v_permlane16_swap_b32 v140, v142
    v_permlane16_swap_b32 v141, v143
    v_mfma_f32_16x16x32_bf16 v[216:219], v[60:63], v[84:87], v[216:219]
    ds_write_b128 v154, v[140:143] offset:12288
    v_cvt_pk_bf16_f32 v96, v200, v201
    v_cvt_pk_bf16_f32 v98, v204, v205
    v_mfma_f32_16x16x32_bf16 v[220:223], v[64:67], v[84:87], v[220:223]
    v_cvt_pk_bf16_f32 v97, v202, v203
    v_cvt_pk_bf16_f32 v99, v206, v207
    v_xor_b32 v156, 64, v156
    v_mfma_f32_16x16x32_bf16 v[224:227], v[68:71], v[84:87], v[224:227]
    v_permlane16_swap_b32 v92, v94
    v_permlane16_swap_b32 v93, v95
    ds_write_b128 v155, v[92:95] offset:12288
    v_mfma_f32_16x16x32_bf16 v[228:231], v[72:75], v[84:87], v[228:231]
    v_permlane16_swap_b32 v96, v98
    v_permlane16_swap_b32 v97, v99
    ds_write_b128 v156, v[96:99] offset:12288
    v_mfma_f32_16x16x32_bf16 v[232:235], v[28:31], v[124:127], v[232:235]
    v_mfma_f32_16x16x32_bf16 v[236:239], v[32:35], v[124:127], v[236:239]
    v_mfma_f32_16x16x32_bf16 v[240:243], v[36:39], v[124:127], v[240:243]
    v_cvt_pk_bf16_f32 v128, v208, v209
    v_cvt_pk_bf16_f32 v130, v212, v213
    v_cvt_pk_bf16_f32 v129, v210, v211
    v_mfma_f32_16x16x32_bf16 v[244:247], v[40:43], v[124:127], v[244:247]
    v_cvt_pk_bf16_f32 v131, v214, v215
    v_xor_b32 v154, 0xc0, v154
    v_cvt_pk_bf16_f32 v132, v216, v217
    v_mfma_f32_16x16x32_bf16 v[248:251], v[44:47], v[124:127], v[248:251]
    v_cvt_pk_bf16_f32 v134, v220, v221
    v_cvt_pk_bf16_f32 v133, v218, v219
    v_cvt_pk_bf16_f32 v135, v222, v223
    v_mfma_f32_16x16x32_bf16 v[252:255], v[48:51], v[124:127], v[252:255]
    v_xor_b32 v155, 0xc0, v155
    v_permlane16_swap_b32 v128, v130
    v_permlane16_swap_b32 v129, v131
    v_mfma_f32_16x16x32_bf16 v[232:235], v[52:55], v[88:91], v[232:235]
    ds_write_b128 v154, v[128:131] offset:24576
    v_cvt_pk_bf16_f32 v136, v224, v225
    v_cvt_pk_bf16_f32 v138, v228, v229
    v_mfma_f32_16x16x32_bf16 v[236:239], v[56:59], v[88:91], v[236:239]
    v_cvt_pk_bf16_f32 v137, v226, v227
    v_cvt_pk_bf16_f32 v139, v230, v231
    v_xor_b32 v156, 0xc0, v156
    v_mfma_f32_16x16x32_bf16 v[240:243], v[60:63], v[88:91], v[240:243]
    v_permlane16_swap_b32 v132, v134
    v_permlane16_swap_b32 v133, v135
    ds_write_b128 v155, v[132:135] offset:24576
    v_mfma_f32_16x16x32_bf16 v[244:247], v[64:67], v[88:91], v[244:247]
    v_permlane16_swap_b32 v136, v138
    v_permlane16_swap_b32 v137, v139
    ds_write_b128 v156, v[136:139] offset:24576
    v_mfma_f32_16x16x32_bf16 v[248:251], v[68:71], v[88:91], v[248:251]
    v_mfma_f32_16x16x32_bf16 v[252:255], v[72:75], v[88:91], v[252:255]
    v_cvt_pk_bf16_f32 v140, v232, v233
    v_cvt_pk_bf16_f32 v142, v236, v237
    v_cvt_pk_bf16_f32 v141, v234, v235
    v_cvt_pk_bf16_f32 v143, v238, v239
    v_xor_b32 v154, 64, v154
    v_cvt_pk_bf16_f32 v92, v240, v241
    v_cvt_pk_bf16_f32 v94, v244, v245
    v_cvt_pk_bf16_f32 v93, v242, v243
    v_cvt_pk_bf16_f32 v95, v246, v247
    v_xor_b32 v155, 64, v155
    v_permlane16_swap_b32 v140, v142
    v_permlane16_swap_b32 v141, v143
    ds_write_b128 v154, v[140:143] offset:36864
    v_cvt_pk_bf16_f32 v96, v248, v249
    v_cvt_pk_bf16_f32 v98, v252, v253
    v_cvt_pk_bf16_f32 v97, v250, v251
    v_cvt_pk_bf16_f32 v99, v254, v255
    v_xor_b32 v156, 64, v156
    v_permlane16_swap_b32 v92, v94
    v_permlane16_swap_b32 v93, v95
    ds_write_b128 v155, v[92:95] offset:36864
    v_permlane16_swap_b32 v96, v98
    v_permlane16_swap_b32 v97, v99
    ds_write_b128 v156, v[96:99] offset:36864
    s_setprio 2
    s_waitcnt lgkmcnt(0)
    s_barrier
    s_lshl_b32 s4, s3, 6
    v_xor_b32 v150, s4, v150
    v_add_u32 v150, s101, v150
    v_mov_b32 v76, s88
    v_xor_b32 v151, s4, v151
    v_add_u32 v151, s101, v151
    v_mov_b32 v77, s88
    v_xor_b32 v152, s4, v152
    v_add_u32 v152, s101, v152
    v_mov_b32 v78, s88
    v_xor_b32 v153, s4, v153
    v_add_u32 v153, s101, v153
    v_mov_b32 v79, s88
    ds_read_b128 v[28:31], v150
    ds_read_b128 v[32:35], v151
    ds_read_b128 v[36:39], v152
    ds_read_b128 v[40:43], v153
    ds_read_b128 v[44:47], v150 offset:256
    ds_read_b128 v[48:51], v151 offset:256
    ds_read_b128 v[52:55], v152 offset:256
    ds_read_b128 v[56:59], v153 offset:256
    ds_read_b128 v[60:63], v150 offset:512
    ds_read_b128 v[64:67], v151 offset:512
    ds_read_b128 v[68:71], v152 offset:512
    ds_read_b128 v[72:75], v153 offset:512
    s_waitcnt lgkmcnt(10)
    v_mfma_f32_16x16x32_bf16 v[80:83], v[28:31], v[28:31], 0
    v_mfma_f32_16x16x32_bf16 v[84:87], v[28:31], v[76:79], 0
    v_mfma_f32_16x16x32_bf16 v[80:83], v[32:35], v[32:35], v[80:83]
    v_mfma_f32_16x16x32_bf16 v[84:87], v[32:35], v[76:79], v[84:87]
    s_waitcnt lgkmcnt(8)
    v_mfma_f32_16x16x32_bf16 v[80:83], v[36:39], v[36:39], v[80:83]
    v_mfma_f32_16x16x32_bf16 v[84:87], v[36:39], v[76:79], v[84:87]
    v_mfma_f32_16x16x32_bf16 v[80:83], v[40:43], v[40:43], v[80:83]
    v_mfma_f32_16x16x32_bf16 v[84:87], v[40:43], v[76:79], v[84:87]
    s_waitcnt lgkmcnt(6)
    v_mfma_f32_16x16x32_bf16 v[80:83], v[44:47], v[44:47], v[80:83]
    v_mfma_f32_16x16x32_bf16 v[84:87], v[44:47], v[76:79], v[84:87]
    v_mfma_f32_16x16x32_bf16 v[80:83], v[48:51], v[48:51], v[80:83]
    v_mfma_f32_16x16x32_bf16 v[84:87], v[48:51], v[76:79], v[84:87]
    s_waitcnt lgkmcnt(4)
    v_mfma_f32_16x16x32_bf16 v[80:83], v[52:55], v[52:55], v[80:83]
    v_mfma_f32_16x16x32_bf16 v[84:87], v[52:55], v[76:79], v[84:87]
    v_mfma_f32_16x16x32_bf16 v[80:83], v[56:59], v[56:59], v[80:83]
    v_mfma_f32_16x16x32_bf16 v[84:87], v[56:59], v[76:79], v[84:87]
    s_waitcnt lgkmcnt(3)
    v_mfma_f32_16x16x32_bf16 v[80:83], v[60:63], v[60:63], v[80:83]
    v_mfma_f32_16x16x32_bf16 v[84:87], v[60:63], v[76:79], v[84:87]
    s_waitcnt lgkmcnt(2)
    v_mfma_f32_16x16x32_bf16 v[80:83], v[64:67], v[64:67], v[80:83]
    v_mfma_f32_16x16x32_bf16 v[84:87], v[64:67], v[76:79], v[84:87]
    s_waitcnt lgkmcnt(1)
    v_mfma_f32_16x16x32_bf16 v[80:83], v[68:71], v[68:71], v[80:83]
    v_mfma_f32_16x16x32_bf16 v[84:87], v[68:71], v[76:79], v[84:87]
    s_waitcnt lgkmcnt(0)
    v_mfma_f32_16x16x32_bf16 v[80:83], v[72:75], v[72:75], v[80:83]
    v_mfma_f32_16x16x32_bf16 v[84:87], v[72:75], v[76:79], v[84:87]
    s_setprio 0
    ds_read_b64_tr_b16 v[112:113], v100
    ds_read_b64_tr_b16 v[114:115], v101
    ds_read_b64_tr_b16 v[116:117], v102
    ds_read_b64_tr_b16 v[118:119], v103
    ds_read_b64_tr_b16 v[120:121], v104
    ds_read_b64_tr_b16 v[122:123], v105
    v_xor_b32 v100, 64, v100
    ds_read_b64_tr_b16 v[124:125], v100 offset:768
    v_xor_b32 v101, 64, v101
    ds_read_b64_tr_b16 v[126:127], v101 offset:768
    v_xor_b32 v102, 64, v102
    ds_read_b64_tr_b16 v[128:129], v102 offset:768
    v_xor_b32 v103, 64, v103
    ds_read_b64_tr_b16 v[130:131], v103 offset:768
    v_xor_b32 v104, 64, v104
    ds_read_b64_tr_b16 v[132:133], v104 offset:768
    v_xor_b32 v105, 64, v105
    ds_read_b64_tr_b16 v[134:135], v105 offset:768
    v_xor_b32 v100, 0x60, v100
    ds_read_b64_tr_b16 v[136:137], v100 offset:1536
    v_xor_b32 v101, 0x60, v101
    ds_read_b64_tr_b16 v[138:139], v101 offset:1536
    v_xor_b32 v102, 0x60, v102
    ds_read_b64_tr_b16 v[140:141], v102 offset:1536
    v_xor_b32 v103, 0x60, v103
    ds_read_b64_tr_b16 v[142:143], v103 offset:1536
    v_xor_b32 v104, 0x60, v104
    ds_read_b64_tr_b16 v[144:145], v104 offset:1536
    v_xor_b32 v105, 0x60, v105
    ds_read_b64_tr_b16 v[146:147], v105 offset:1536
    v_xor_b32 v100, 64, v100
    ds_read_b64_tr_b16 v[148:149], v100 offset:2304
    v_xor_b32 v101, 64, v101
    ds_read_b64_tr_b16 v[150:151], v101 offset:2304
    v_xor_b32 v102, 64, v102
    ds_read_b64_tr_b16 v[152:153], v102 offset:2304
    v_xor_b32 v103, 64, v103
    ds_read_b64_tr_b16 v[154:155], v103 offset:2304
    v_xor_b32 v104, 64, v104
    ds_read_b64_tr_b16 v[156:157], v104 offset:2304
    v_xor_b32 v105, 64, v105
    ds_read_b64_tr_b16 v[158:159], v105 offset:2304
    v_cndmask_b32 v24, v80, v81, s[92:93]
    v_cndmask_b32 v25, v82, v83, s[96:97]
    v_cndmask_b32 v24, v24, v25, s[94:95]
    ds_write_b32 v27, v24 offset:768
    v_cndmask_b32 v24, v84, v85, s[92:93]
    v_cndmask_b32 v25, v86, v87, s[96:97]
    v_cndmask_b32 v24, v24, v25, s[94:95]
    ds_write_b32 v27, v24 offset:1024
    s_mov_b32 s24, s84
    s_and_b32 s25, s85, 0xffff
    s_mov_b32 s26, 0x100
    s_mov_b32 s27, 0x20000
    v_mov_b32 v22, 0
    buffer_load_dword v22, v22, s[24:27], 0 offen sc1
    s_add_u32 m0, s101, 0x10000
    s_add_u32 s42, s40, 0x6000
    buffer_load_dwordx4 v2, s[8:11], s42 offen nt lds
    buffer_load_dwordx4 v3, s[8:11], s42 offen offset:1024 nt lds
    buffer_load_dwordx4 v4, s[8:11], s42 offen offset:2048 nt lds
    s_waitcnt lgkmcnt(0)
    s_barrier
    s_add_u32 m0, s101, 0x10c00
    s_add_u32 s42, s40, 0x6600
    buffer_load_dwordx4 v5, s[8:11], s42 offen nt lds
    buffer_load_dwordx4 v6, s[8:11], s42 offen offset:1024 nt lds
    buffer_load_dwordx4 v7, s[8:11], s42 offen offset:2048 nt lds
    s_add_u32 m0, s101, 0x11800
    s_add_u32 s42, s40, 0x6c00
    buffer_load_dwordx4 v2, s[8:11], s42 offen nt lds
    buffer_load_dwordx4 v3, s[8:11], s42 offen offset:1024 nt lds
    buffer_load_dwordx4 v4, s[8:11], s42 offen offset:2048 nt lds
    s_add_u32 m0, s101, 0x12400
    s_add_u32 s42, s40, 0x7200
    buffer_load_dwordx4 v5, s[8:11], s42 offen nt lds
    buffer_load_dwordx4 v6, s[8:11], s42 offen offset:1024 nt lds
    buffer_load_dwordx4 v7, s[8:11], s42 offen offset:2048 nt lds
    s_barrier
    v_and_b32 v24, 15, v1
    v_lshrrev_b32 v25, 2, v24
    v_lshrrev_b32 v106, 3, v24
    v_xor_b32 v106, v25, v106
    v_and_b32 v106, 1, v106
    v_lshlrev_b32 v106, 3, v106
    v_and_b32 v25, 1, v25
    v_or_b32 v106, v106, v25
    v_and_b32 v25, 1, v24
    v_lshl_or_b32 v106, v25, 2, v106
    v_and_b32 v25, 2, v24
    v_or_b32 v106, v106, v25
    v_and_b32 v24, 31, v1
    v_mul_u32_u24 v21, 0x300, v24
    v_add_u32 v21, 0x1c000, v21
    v_lshrrev_b32 v24, 5, v1
    s_mul_i32 s4, s3, 12
    v_add_u32 v24, s4, v24
    v_add_u32 v25, 0, v24
    v_xor_b32 v25, v25, v106
    v_lshl_add_u32 v100, v25, 4, v21
    v_add_u32 v25, 2, v24
    v_xor_b32 v25, v25, v106
    v_lshl_add_u32 v101, v25, 4, v21
    v_add_u32 v25, 4, v24
    v_xor_b32 v25, v25, v106
    v_lshl_add_u32 v102, v25, 4, v21
    v_add_u32 v25, 6, v24
    v_xor_b32 v25, v25, v106
    v_lshl_add_u32 v103, v25, 4, v21
    v_add_u32 v25, 8, v24
    v_xor_b32 v25, v25, v106
    v_lshl_add_u32 v104, v25, 4, v21
    v_add_u32 v25, 10, v24
    v_xor_b32 v25, v25, v106
    v_lshl_add_u32 v105, v25, 4, v21
    s_add_u32 m0, s101, 0x1c000
    s_add_u32 s42, s40, 0xc000
    buffer_load_dwordx4 v2, s[8:11], s42 offen nt lds
    buffer_load_dwordx4 v3, s[8:11], s42 offen offset:1024 nt lds
    buffer_load_dwordx4 v4, s[8:11], s42 offen offset:2048 nt lds
    s_add_u32 m0, s101, 0x1cc00
    s_add_u32 s42, s40, 0xc600
    buffer_load_dwordx4 v5, s[8:11], s42 offen nt lds
    buffer_load_dwordx4 v6, s[8:11], s42 offen offset:1024 nt lds
    buffer_load_dwordx4 v7, s[8:11], s42 offen offset:2048 nt lds
    s_add_u32 m0, s101, 0x1d800
    s_add_u32 s42, s40, 0xcc00
    buffer_load_dwordx4 v2, s[8:11], s42 offen nt lds
    buffer_load_dwordx4 v3, s[8:11], s42 offen offset:1024 nt lds
    buffer_load_dwordx4 v4, s[8:11], s42 offen offset:2048 nt lds
    s_add_u32 m0, s101, 0x1e400
    s_add_u32 s42, s40, 0xd200
    buffer_load_dwordx4 v5, s[8:11], s42 offen nt lds
    buffer_load_dwordx4 v6, s[8:11], s42 offen offset:1024 nt lds
    buffer_load_dwordx4 v7, s[8:11], s42 offen offset:2048 nt lds
    s_waitcnt vmcnt(12)
    v_readfirstlane_b32 s44, v22
    s_nop 0
    s_cmp_eq_u32 s44, 0
    s_cbranch_scc1 L_es_50
L_eb_51:
    s_mul_i32 s45, s44, 0x9e3779b1
    s_getreg_b32 s46, hwreg(HW_REG_XCC_ID)
    s_and_b32 s46, s46, 15
    s_setprio 0
    s_barrier
    ds_read_b128 v[28:31], v14
    ds_read_b128 v[32:35], v14 offset:4096
    ds_read_b128 v[36:39], v15
    ds_read_b128 v[40:43], v15 offset:4096
    ds_read_b128 v[44:47], v16
    ds_read_b128 v[48:51], v16 offset:4096
    ds_read_b128 v[52:55], v17
    ds_read_b128 v[56:59], v17 offset:4096
    ds_read_b128 v[60:63], v107
    ds_read_b128 v[64:67], v107 offset:1024
    ds_read_b64_tr_b16 v[76:77], v8
    ds_read_b64_tr_b16 v[78:79], v9
    ds_read_b64_tr_b16 v[80:81], v10
    ds_read_b64_tr_b16 v[82:83], v11
    ds_read_b64_tr_b16 v[84:85], v12
    ds_read_b64_tr_b16 v[86:87], v13
    s_waitcnt lgkmcnt(3)
    v_mfma_f32_32x32x16_bf16 v[160:175], v[76:79], v[28:31], 0
    ds_read_b64_tr_b16 v[88:89], v8 offset:12288
    ds_read_b64_tr_b16 v[90:91], v9 offset:12288
    v_mfma_f32_32x32x16_bf16 v[176:191], v[76:79], v[32:35], 0
    ds_read_b64_tr_b16 v[92:93], v10 offset:12288
    ds_read_b64_tr_b16 v[94:95], v11 offset:12288
    s_waitcnt lgkmcnt(5)
    v_mfma_f32_32x32x16_bf16 v[192:207], v[80:83], v[28:31], 0
    ds_read_b64_tr_b16 v[96:97], v12 offset:12288
    ds_read_b64_tr_b16 v[98:99], v13 offset:12288
    v_mfma_f32_32x32x16_bf16 v[208:223], v[80:83], v[32:35], 0
    s_waitcnt lgkmcnt(5)
    v_mfma_f32_32x32x16_bf16 v[224:239], v[84:87], v[28:31], 0
    s_barrier
    v_mfma_f32_32x32x16_bf16 v[240:255], v[84:87], v[32:35], 0
    s_waitcnt lgkmcnt(3)
    v_mfma_f32_32x32x16_bf16 v[160:175], v[88:91], v[36:39], v[160:175]
    ds_read_b64_tr_b16 v[76:77], v8 offset:24576
    ds_read_b64_tr_b16 v[78:79], v9 offset:24576
    v_mfma_f32_32x32x16_bf16 v[176:191], v[88:91], v[40:43], v[176:191]
    ds_read_b64_tr_b16 v[80:81], v10 offset:24576
    ds_read_b64_tr_b16 v[82:83], v11 offset:24576
    s_waitcnt lgkmcnt(5)
    v_mfma_f32_32x32x16_bf16 v[192:207], v[92:95], v[36:39], v[192:207]
    ds_read_b64_tr_b16 v[84:85], v12 offset:24576
    ds_read_b64_tr_b16 v[86:87], v13 offset:24576
    v_mfma_f32_32x32x16_bf16 v[208:223], v[92:95], v[40:43], v[208:223]
    s_waitcnt lgkmcnt(5)
    v_mfma_f32_32x32x16_bf16 v[224:239], v[96:99], v[36:39], v[224:239]
    v_mfma_f32_32x32x16_bf16 v[240:255], v[96:99], v[40:43], v[240:255]
    s_waitcnt lgkmcnt(3)
    v_mfma_f32_32x32x16_bf16 v[160:175], v[76:79], v[44:47], v[160:175]
    ds_read_b64_tr_b16 v[88:89], v8 offset:36864
    ds_read_b64_tr_b16 v[90:91], v9 offset:36864
    v_mfma_f32_32x32x16_bf16 v[176:191], v[76:79], v[48:51], v[176:191]
    ds_read_b64_tr_b16 v[92:93], v10 offset:36864
    ds_read_b64_tr_b16 v[94:95], v11 offset:36864
    s_waitcnt lgkmcnt(5)
    v_mfma_f32_32x32x16_bf16 v[192:207], v[80:83], v[44:47], v[192:207]
    ds_read_b64_tr_b16 v[96:97], v12 offset:36864
    ds_read_b64_tr_b16 v[98:99], v13 offset:36864
    v_mfma_f32_32x32x16_bf16 v[208:223], v[80:83], v[48:51], v[208:223]
    s_waitcnt lgkmcnt(5)
    v_mfma_f32_32x32x16_bf16 v[224:239], v[84:87], v[44:47], v[224:239]
    v_mfma_f32_32x32x16_bf16 v[240:255], v[84:87], v[48:51], v[240:255]
    s_waitcnt lgkmcnt(3)
    v_mfma_f32_32x32x16_bf16 v[160:175], v[88:91], v[52:55], v[160:175]
    v_mfma_f32_32x32x16_bf16 v[176:191], v[88:91], v[56:59], v[176:191]
    s_waitcnt lgkmcnt(2)
    v_mfma_f32_32x32x16_bf16 v[192:207], v[92:95], v[52:55], v[192:207]
    v_mfma_f32_32x32x16_bf16 v[208:223], v[92:95], v[56:59], v[208:223]
    s_waitcnt lgkmcnt(0)
    v_mfma_f32_32x32x16_bf16 v[224:239], v[96:99], v[52:55], v[224:239]
    v_mfma_f32_32x32x16_bf16 v[240:255], v[96:99], v[56:59], v[240:255]
    v_mfma_f32_32x32x16_bf16 v[160:175], v[112:115], v[60:63], v[160:175]
    v_add_u32 v8, 0x10000, v8
    v_add_u32 v9, 0x10000, v9
    v_add_u32 v10, 0x10000, v10
    v_mfma_f32_32x32x16_bf16 v[176:191], v[112:115], v[64:67], v[176:191]
    v_add_u32 v11, 0x10000, v11
    v_add_u32 v12, 0x10000, v12
    v_add_u32 v13, 0x10000, v13
    v_mfma_f32_32x32x16_bf16 v[192:207], v[116:119], v[60:63], v[192:207]
    v_mfma_f32_32x32x16_bf16 v[208:223], v[116:119], v[64:67], v[208:223]
    v_mfma_f32_32x32x16_bf16 v[224:239], v[120:123], v[60:63], v[224:239]
    v_mfma_f32_32x32x16_bf16 v[240:255], v[120:123], v[64:67], v[240:255]
    s_waitcnt vmcnt(0)
    s_barrier
    ds_read_b128 v[108:111], v20
    ds_read_b128 v[28:31], v14
    ds_read_b128 v[32:35], v14 offset:4096
    ds_read_b128 v[36:39], v15
    ds_read_b128 v[40:43], v15 offset:4096
    ds_read_b128 v[44:47], v16
    ds_read_b128 v[48:51], v16 offset:4096
    ds_read_b128 v[52:55], v17
    ds_read_b128 v[56:59], v17 offset:4096
    ds_read_b128 v[60:63], v107
    ds_read_b128 v[64:67], v107 offset:1024
    ds_read_b64_tr_b16 v[76:77], v8
    ds_read_b64_tr_b16 v[78:79], v9
    ds_read_b64_tr_b16 v[80:81], v10
    ds_read_b64_tr_b16 v[82:83], v11
    ds_read_b64_tr_b16 v[84:85], v12
    ds_read_b64_tr_b16 v[86:87], v13
    s_waitcnt lgkmcnt(15)
    v_max3_u32 v26, v108, v109, v110
    v_max_u32 v26, v26, v111
    s_nop 0
    v_readfirstlane_b32 s5, v26
    s_nop 0
    s_cmp_eq_u32 s5, 2
    s_cbranch_scc1 L_resc_52
L_rback_53:
    s_add_u32 m0, s101, 0
    s_add_u32 s42, s40, 0x12000
    buffer_load_dwordx4 v2, s[8:11], s42 offen nt lds
    buffer_load_dwordx4 v3, s[8:11], s42 offen offset:1024 nt lds
    buffer_load_dwordx4 v4, s[8:11], s42 offen offset:2048 nt lds
    s_add_u32 m0, s101, 0xc00
    s_add_u32 s42, s40, 0x12600
    buffer_load_dwordx4 v5, s[8:11], s42 offen nt lds
    buffer_load_dwordx4 v6, s[8:11], s42 offen offset:1024 nt lds
    buffer_load_dwordx4 v7, s[8:11], s42 offen offset:2048 nt lds
    s_add_u32 m0, s101, 0x1800
    s_add_u32 s42, s40, 0x12c00
    buffer_load_dwordx4 v2, s[8:11], s42 offen nt lds
    buffer_load_dwordx4 v3, s[8:11], s42 offen offset:1024 nt lds
    buffer_load_dwordx4 v4, s[8:11], s42 offen offset:2048 nt lds
    s_waitcnt lgkmcnt(6)
    s_barrier
    s_waitcnt lgkmcnt(3)
    v_mfma_f32_32x32x16_bf16 v[160:175], v[76:79], v[28:31], v[160:175]
    ds_read_b64_tr_b16 v[88:89], v8 offset:12288
    ds_read_b64_tr_b16 v[90:91], v9 offset:12288
    s_add_u32 m0, s101, 0x2400
    s_add_u32 s42, s40, 0x13200
    v_mfma_f32_32x32x16_bf16 v[176:191], v[76:79], v[32:35], v[176:191]
    ds_read_b64_tr_b16 v[92:93], v10 offset:12288
    ds_read_b64_tr_b16 v[94:95], v11 offset:12288
    buffer_load_dwordx4 v5, s[8:11], s42 offen nt lds
    s_waitcnt lgkmcnt(5)
    v_mfma_f32_32x32x16_bf16 v[192:207], v[80:83], v[28:31], v[192:207]
    ds_read_b64_tr_b16 v[96:97], v12 offset:12288
    ds_read_b64_tr_b16 v[98:99], v13 offset:12288
    buffer_load_dwordx4 v6, s[8:11], s42 offen offset:1024 nt lds
    v_mfma_f32_32x32x16_bf16 v[208:223], v[80:83], v[32:35], v[208:223]
    buffer_load_dwordx4 v7, s[8:11], s42 offen offset:2048 nt lds
    s_waitcnt lgkmcnt(5)
    v_mfma_f32_32x32x16_bf16 v[224:239], v[84:87], v[28:31], v[224:239]
    v_mfma_f32_32x32x16_bf16 v[240:255], v[84:87], v[32:35], v[240:255]
    s_waitcnt lgkmcnt(3)
    v_mfma_f32_32x32x16_bf16 v[160:175], v[88:91], v[36:39], v[160:175]
    ds_read_b64_tr_b16 v[76:77], v8 offset:24576
    ds_read_b64_tr_b16 v[78:79], v9 offset:24576
    v_mfma_f32_32x32x16_bf16 v[176:191], v[88:91], v[40:43], v[176:191]
    ds_read_b64_tr_b16 v[80:81], v10 offset:24576
    ds_read_b64_tr_b16 v[82:83], v11 offset:24576
    s_waitcnt lgkmcnt(5)
    v_mfma_f32_32x32x16_bf16 v[192:207], v[92:95], v[36:39], v[192:207]
    ds_read_b64_tr_b16 v[84:85], v12 offset:24576
    ds_read_b64_tr_b16 v[86:87], v13 offset:24576
    v_mfma_f32_32x32x16_bf16 v[208:223], v[92:95], v[40:43], v[208:223]
    s_waitcnt lgkmcnt(5)
    v_mfma_f32_32x32x16_bf16 v[224:239], v[96:99], v[36:39], v[224:239]
    v_mfma_f32_32x32x16_bf16 v[240:255], v[96:99], v[40:43], v[240:255]
    s_waitcnt lgkmcnt(3)
    v_mfma_f32_32x32x16_bf16 v[160:175], v[76:79], v[44:47], v[160:175]
    ds_read_b64_tr_b16 v[88:89], v8 offset:36864
    ds_read_b64_tr_b16 v[90:91], v9 offset:36864
    v_mfma_f32_32x32x16_bf16 v[176:191], v[76:79], v[48:51], v[176:191]
    ds_read_b64_tr_b16 v[92:93], v10 offset:36864
    ds_read_b64_tr_b16 v[94:95], v11 offset:36864
    s_waitcnt lgkmcnt(5)
    v_mfma_f32_32x32x16_bf16 v[192:207], v[80:83], v[44:47], v[192:207]
    ds_read_b64_tr_b16 v[96:97], v12 offset:36864
    ds_read_b64_tr_b16 v[98:99], v13 offset:36864
    v_mfma_f32_32x32x16_bf16 v[208:223], v[80:83], v[48:51], v[208:223]
    s_waitcnt lgkmcnt(5)
    v_mfma_f32_32x32x16_bf16 v[224:239], v[84:87], v[44:47], v[224:239]
    v_mfma_f32_32x32x16_bf16 v[240:255], v[84:87], v[48:51], v[240:255]
    s_waitcnt lgkmcnt(3)
    v_mfma_f32_32x32x16_bf16 v[160:175], v[88:91], v[52:55], v[160:175]
    v_mfma_f32_32x32x16_bf16 v[176:191], v[88:91], v[56:59], v[176:191]
    s_waitcnt lgkmcnt(2)
    v_mfma_f32_32x32x16_bf16 v[192:207], v[92:95], v[52:55], v[192:207]
    v_mfma_f32_32x32x16_bf16 v[208:223], v[92:95], v[56:59], v[208:223]
    s_waitcnt lgkmcnt(0)
    v_mfma_f32_32x32x16_bf16 v[224:239], v[96:99], v[52:55], v[224:239]
    v_mfma_f32_32x32x16_bf16 v[240:255], v[96:99], v[56:59], v[240:255]
    v_mfma_f32_32x32x16_bf16 v[160:175], v[124:127], v[60:63], v[160:175]
    v_add_u32 v8, 0xc000, v8
    v_add_u32 v9, 0xc000, v9
    v_add_u32 v10, 0xc000, v10
    v_mfma_f32_32x32x16_bf16 v[176:191], v[124:127], v[64:67], v[176:191]
    v_add_u32 v11, 0xc000, v11
    v_add_u32 v12, 0xc000, v12
    v_add_u32 v13, 0xc000, v13
    v_mfma_f32_32x32x16_bf16 v[192:207], v[128:131], v[60:63], v[192:207]
    v_mfma_f32_32x32x16_bf16 v[208:223], v[128:131], v[64:67], v[208:223]
    v_mfma_f32_32x32x16_bf16 v[224:239], v[132:135], v[60:63], v[224:239]
    v_mfma_f32_32x32x16_bf16 v[240:255], v[132:135], v[64:67], v[240:255]
    s_waitcnt vmcnt(0)
    s_barrier
    ds_read_b128 v[108:111], v20
    ds_read_b128 v[28:31], v14
    ds_read_b128 v[32:35], v14 offset:4096
    ds_read_b128 v[36:39], v15
    ds_read_b128 v[40:43], v15 offset:4096
    ds_read_b128 v[44:47], v16
    ds_read_b128 v[48:51], v16 offset:4096
    ds_read_b128 v[52:55], v17
    ds_read_b128 v[56:59], v17 offset:4096
    ds_read_b128 v[60:63], v107
    ds_read_b128 v[64:67], v107 offset:1024
    ds_read_b64_tr_b16 v[76:77], v8
    ds_read_b64_tr_b16 v[78:79], v9
    ds_read_b64_tr_b16 v[80:81], v10
    ds_read_b64_tr_b16 v[82:83], v11
    ds_read_b64_tr_b16 v[84:85], v12
    ds_read_b64_tr_b16 v[86:87], v13
    s_waitcnt lgkmcnt(15)
    v_max3_u32 v26, v108, v109, v110
    v_max_u32 v26, v26, v111
    s_nop 0
    v_readfirstlane_b32 s5, v26
    s_nop 0
    s_cmp_eq_u32 s5, 3
    s_cbranch_scc1 L_resc_54
L_rback_55:
    v_lshlrev_b32 v70, 4, v0
    s_mov_b32 s41, 0x60000
    buffer_load_dword v68, v70, s[20:23], s41 offen sc1
    s_waitcnt lgkmcnt(3)
    v_mfma_f32_32x32x16_bf16 v[160:175], v[76:79], v[28:31], v[160:175]
    ds_read_b64_tr_b16 v[88:89], v8 offset:12288
    ds_read_b64_tr_b16 v[90:91], v9 offset:12288
    v_mfma_f32_32x32x16_bf16 v[176:191], v[76:79], v[32:35], v[176:191]
    ds_read_b64_tr_b16 v[92:93], v10 offset:12288
    ds_read_b64_tr_b16 v[94:95], v11 offset:12288
    s_waitcnt lgkmcnt(5)
    v_mfma_f32_32x32x16_bf16 v[192:207], v[80:83], v[28:31], v[192:207]
    ds_read_b64_tr_b16 v[96:97], v12 offset:12288
    ds_read_b64_tr_b16 v[98:99], v13 offset:12288
    v_mfma_f32_32x32x16_bf16 v[208:223], v[80:83], v[32:35], v[208:223]
    s_waitcnt lgkmcnt(5)
    v_mfma_f32_32x32x16_bf16 v[224:239], v[84:87], v[28:31], v[224:239]
    s_barrier
    v_mfma_f32_32x32x16_bf16 v[240:255], v[84:87], v[32:35], v[240:255]
    s_add_u32 m0, s101, 0x10000
    s_add_u32 s42, s58, 0x4800
    s_waitcnt lgkmcnt(3)
    v_mfma_f32_32x32x16_bf16 v[160:175], v[88:91], v[36:39], v[160:175]
    ds_read_b64_tr_b16 v[76:77], v8 offset:24576
    ds_read_b64_tr_b16 v[78:79], v9 offset:24576
    buffer_load_dwordx4 v23, s[20:23], s42 offen lds
    v_mfma_f32_32x32x16_bf16 v[176:191], v[88:91], v[40:43], v[176:191]
    ds_read_b64_tr_b16 v[80:81], v10 offset:24576
    ds_read_b64_tr_b16 v[82:83], v11 offset:24576
    s_waitcnt lgkmcnt(5)
    v_mfma_f32_32x32x16_bf16 v[192:207], v[92:95], v[36:39], v[192:207]
    ds_read_b64_tr_b16 v[84:85], v12 offset:24576
    ds_read_b64_tr_b16 v[86:87], v13 offset:24576
    buffer_load_dwordx4 v23, s[20:23], s42 offen offset:1024 lds
    v_mfma_f32_32x32x16_bf16 v[208:223], v[92:95], v[40:43], v[208:223]
    s_waitcnt lgkmcnt(5)
    v_mfma_f32_32x32x16_bf16 v[224:239], v[96:99], v[36:39], v[224:239]
    buffer_load_dwordx4 v23, s[20:23], s42 offen offset:2048 lds
    v_mfma_f32_32x32x16_bf16 v[240:255], v[96:99], v[40:43], v[240:255]
    s_waitcnt lgkmcnt(3)
    v_mfma_f32_32x32x16_bf16 v[160:175], v[76:79], v[44:47], v[160:175]
    ds_read_b64_tr_b16 v[88:89], v8 offset:36864
    ds_read_b64_tr_b16 v[90:91], v9 offset:36864
    buffer_load_dwordx4 v23, s[20:23], s42 offen offset:3072 lds
    v_mfma_f32_32x32x16_bf16 v[176:191], v[76:79], v[48:51], v[176:191]
    ds_read_b64_tr_b16 v[92:93], v10 offset:36864
    ds_read_b64_tr_b16 v[94:95], v11 offset:36864
    s_add_u32 m0, s101, 0x11000
    s_add_u32 s42, s58, 0x5800
    s_waitcnt lgkmcnt(5)
    v_mfma_f32_32x32x16_bf16 v[192:207], v[80:83], v[44:47], v[192:207]
    ds_read_b64_tr_b16 v[96:97], v12 offset:36864
    ds_read_b64_tr_b16 v[98:99], v13 offset:36864
    buffer_load_dwordx4 v23, s[20:23], s42 offen lds
    v_mfma_f32_32x32x16_bf16 v[208:223], v[80:83], v[48:51], v[208:223]
    s_waitcnt lgkmcnt(5)
    v_mfma_f32_32x32x16_bf16 v[224:239], v[84:87], v[44:47], v[224:239]
    buffer_load_dwordx4 v23, s[20:23], s42 offen offset:1024 lds
    v_mfma_f32_32x32x16_bf16 v[240:255], v[84:87], v[48:51], v[240:255]
    s_waitcnt lgkmcnt(3)
    v_mfma_f32_32x32x16_bf16 v[160:175], v[88:91], v[52:55], v[160:175]
    buffer_load_dwordx4 v23, s[20:23], s42 offen offset:2048 lds
    v_mfma_f32_32x32x16_bf16 v[176:191], v[88:91], v[56:59], v[176:191]
    s_waitcnt lgkmcnt(2)
    v_mfma_f32_32x32x16_bf16 v[192:207], v[92:95], v[52:55], v[192:207]
    buffer_load_dwordx4 v23, s[20:23], s42 offen offset:3072 lds
    v_mfma_f32_32x32x16_bf16 v[208:223], v[92:95], v[56:59], v[208:223]
    s_add_u32 m0, s101, 0x12000
    s_add_u32 s42, s58, 0x6800
    s_waitcnt lgkmcnt(0)
    v_mfma_f32_32x32x16_bf16 v[224:239], v[96:99], v[52:55], v[224:239]
    buffer_load_dwordx4 v23, s[20:23], s42 offen lds
    v_mfma_f32_32x32x16_bf16 v[240:255], v[96:99], v[56:59], v[240:255]
    v_mfma_f32_32x32x16_bf16 v[160:175], v[136:139], v[60:63], v[160:175]
    v_add_u32 v8, 0xfffe4000, v8
    v_add_u32 v9, 0xfffe4000, v9
    v_add_u32 v10, 0xfffe4000, v10
    buffer_load_dwordx4 v23, s[20:23], s42 offen offset:1024 lds
    v_mfma_f32_32x32x16_bf16 v[176:191], v[136:139], v[64:67], v[176:191]
    v_add_u32 v11, 0xfffe4000, v11
    v_add_u32 v12, 0xfffe4000, v12
    v_add_u32 v13, 0xfffe4000, v13
    v_mfma_f32_32x32x16_bf16 v[192:207], v[140:143], v[60:63], v[192:207]
    buffer_load_dwordx4 v23, s[20:23], s42 offen offset:2048 lds
    v_mfma_f32_32x32x16_bf16 v[208:223], v[140:143], v[64:67], v[208:223]
    v_mfma_f32_32x32x16_bf16 v[224:239], v[144:147], v[60:63], v[224:239]
    buffer_load_dwordx4 v23, s[20:23], s42 offen offset:3072 lds
    s_mov_b32 s28, s78
    s_and_b32 s29, s79, 0xffff
    s_mov_b32 s30, 0x48000
    s_mov_b32 s31, 0x20000
    v_lshrrev_b32 v24, 2, v1
    v_mul_u32_u24 v24, 0x300, v24
    v_and_b32 v25, 3, v1
    v_mul_u32_u24 v25, 12, v25
    v_add_u32 v22, v24, v25
    s_mul_i32 s98, s3, 0x12000
    s_and_b32 s4, s2, 15
    s_mul_i32 s4, s4, 48
    s_add_u32 s98, s98, s4
    v_mfma_f32_32x32x16_bf16 v[240:255], v[144:147], v[64:67], v[240:255]
    s_add_u32 s43, s98, 0
    buffer_load_dwordx3 v[112:114], v22, s[28:31], s43 offen
    s_add_u32 s43, s98, 0x3000
    buffer_load_dwordx3 v[116:118], v22, s[28:31], s43 offen
    s_add_u32 s43, s98, 0x6000
    buffer_load_dwordx3 v[120:122], v22, s[28:31], s43 offen
    s_add_u32 s43, s98, 0x9000
    buffer_load_dwordx3 v[124:126], v22, s[28:31], s43 offen
    s_add_u32 s43, s98, 0xc000
    buffer_load_dwordx3 v[128:130], v22, s[28:31], s43 offen
    s_add_u32 s43, s98, 0xf000
    buffer_load_dwordx3 v[132:134], v22, s[28:31], s43 offen
    s_waitcnt vmcnt(6)
    s_barrier
    ds_read_b128 v[108:111], v20
    ds_read_b128 v[28:31], v14
    ds_read_b128 v[32:35], v14 offset:4096
    ds_read_b128 v[36:39], v15
    ds_read_b128 v[40:43], v15 offset:4096
    ds_read_b128 v[44:47], v16
    ds_read_b128 v[48:51], v16 offset:4096
    ds_read_b128 v[52:55], v17
    ds_read_b128 v[56:59], v17 offset:4096
    ds_read_b128 v[60:63], v107
    ds_read_b128 v[64:67], v107 offset:1024
    ds_read_b64_tr_b16 v[76:77], v8
    ds_read_b64_tr_b16 v[78:79], v9
    ds_read_b64_tr_b16 v[80:81], v10
    ds_read_b64_tr_b16 v[82:83], v11
    ds_read_b64_tr_b16 v[84:85], v12
    ds_read_b64_tr_b16 v[86:87], v13
    s_waitcnt lgkmcnt(15)
    v_max3_u32 v26, v108, v109, v110
    v_max_u32 v26, v26, v111
    s_nop 0
    v_readfirstlane_b32 s5, v26
    s_nop 0
    s_cmp_eq_u32 s5, 4
    s_cbranch_scc1 L_resc_56
L_rback_57:
    s_waitcnt lgkmcnt(3)
    v_mfma_f32_32x32x16_bf16 v[160:175], v[76:79], v[28:31], v[160:175]
    ds_read_b64_tr_b16 v[88:89], v8 offset:12288
    ds_read_b64_tr_b16 v[90:91], v9 offset:12288
    v_mfma_f32_32x32x16_bf16 v[176:191], v[76:79], v[32:35], v[176:191]
    ds_read_b64_tr_b16 v[92:93], v10 offset:12288
    ds_read_b64_tr_b16 v[94:95], v11 offset:12288
    s_waitcnt lgkmcnt(5)
    v_mfma_f32_32x32x16_bf16 v[192:207], v[80:83], v[28:31], v[192:207]
    ds_read_b64_tr_b16 v[96:97], v12 offset:12288
    ds_read_b64_tr_b16 v[98:99], v13 offset:12288
    v_mfma_f32_32x32x16_bf16 v[208:223], v[80:83], v[32:35], v[208:223]
    s_waitcnt lgkmcnt(5)
    v_mfma_f32_32x32x16_bf16 v[224:239], v[84:87], v[28:31], v[224:239]
    v_mfma_f32_32x32x16_bf16 v[240:255], v[84:87], v[32:35], v[240:255]
    s_waitcnt lgkmcnt(3)
    v_mfma_f32_32x32x16_bf16 v[160:175], v[88:91], v[36:39], v[160:175]
    ds_read_b64_tr_b16 v[76:77], v8 offset:24576
    ds_read_b64_tr_b16 v[78:79], v9 offset:24576
    v_mfma_f32_32x32x16_bf16 v[176:191], v[88:91], v[40:43], v[176:191]
    ds_read_b64_tr_b16 v[80:81], v10 offset:24576
    ds_read_b64_tr_b16 v[82:83], v11 offset:24576
    s_waitcnt lgkmcnt(5)
    v_mfma_f32_32x32x16_bf16 v[192:207], v[92:95], v[36:39], v[192:207]
    ds_read_b64_tr_b16 v[84:85], v12 offset:24576
    ds_read_b64_tr_b16 v[86:87], v13 offset:24576
    v_mfma_f32_32x32x16_bf16 v[208:223], v[92:95], v[40:43], v[208:223]
    s_waitcnt lgkmcnt(5)
    v_mfma_f32_32x32x16_bf16 v[224:239], v[96:99], v[36:39], v[224:239]
    v_mfma_f32_32x32x16_bf16 v[240:255], v[96:99], v[40:43], v[240:255]
    s_waitcnt lgkmcnt(3)
    v_mfma_f32_32x32x16_bf16 v[160:175], v[76:79], v[44:47], v[160:175]
    ds_read_b64_tr_b16 v[88:89], v8 offset:36864
    ds_read_b64_tr_b16 v[90:91], v9 offset:36864
    v_mfma_f32_32x32x16_bf16 v[176:191], v[76:79], v[48:51], v[176:191]
    ds_read_b64_tr_b16 v[92:93], v10 offset:36864
    ds_read_b64_tr_b16 v[94:95], v11 offset:36864
    s_waitcnt lgkmcnt(5)
    v_mfma_f32_32x32x16_bf16 v[192:207], v[80:83], v[44:47], v[192:207]
    ds_read_b64_tr_b16 v[96:97], v12 offset:36864
    ds_read_b64_tr_b16 v[98:99], v13 offset:36864
    v_mfma_f32_32x32x16_bf16 v[208:223], v[80:83], v[48:51], v[208:223]
    s_waitcnt lgkmcnt(5)
    v_mfma_f32_32x32x16_bf16 v[224:239], v[84:87], v[44:47], v[224:239]
    v_mfma_f32_32x32x16_bf16 v[240:255], v[84:87], v[48:51], v[240:255]
    s_waitcnt lgkmcnt(3)
    v_mfma_f32_32x32x16_bf16 v[160:175], v[88:91], v[52:55], v[160:175]
    v_mfma_f32_32x32x16_bf16 v[176:191], v[88:91], v[56:59], v[176:191]
    s_waitcnt lgkmcnt(2)
    v_mfma_f32_32x32x16_bf16 v[192:207], v[92:95], v[52:55], v[192:207]
    v_mfma_f32_32x32x16_bf16 v[208:223], v[92:95], v[56:59], v[208:223]
    s_waitcnt lgkmcnt(0)
    v_mfma_f32_32x32x16_bf16 v[224:239], v[96:99], v[52:55], v[224:239]
    v_mfma_f32_32x32x16_bf16 v[240:255], v[96:99], v[56:59], v[240:255]
    v_mfma_f32_32x32x16_bf16 v[160:175], v[148:151], v[60:63], v[160:175]
    v_mfma_f32_32x32x16_bf16 v[176:191], v[148:151], v[64:67], v[176:191]
    v_mfma_f32_32x32x16_bf16 v[192:207], v[152:155], v[60:63], v[192:207]
    v_mfma_f32_32x32x16_bf16 v[208:223], v[152:155], v[64:67], v[208:223]
    s_nop 8
    v_cvt_pk_bf16_f32 v76, v160, v161
    v_cvt_pk_bf16_f32 v77, v162, v163
    v_cvt_pk_bf16_f32 v78, v164, v165
    v_cvt_pk_bf16_f32 v79, v166, v167
    ds_write_b128 v100, v[76:79]
    v_mfma_f32_32x32x16_bf16 v[224:239], v[156:159], v[60:63], v[224:239]
    v_cvt_pk_bf16_f32 v80, v168, v169
    v_cvt_pk_bf16_f32 v81, v170, v171
    v_cvt_pk_bf16_f32 v82, v172, v173
    v_cvt_pk_bf16_f32 v83, v174, v175
    ds_write_b128 v101, v[80:83]
    v_mfma_f32_32x32x16_bf16 v[240:255], v[156:159], v[64:67], v[240:255]
    v_cvt_pk_bf16_f32 v84, v176, v177
    v_cvt_pk_bf16_f32 v85, v178, v179
    v_cvt_pk_bf16_f32 v86, v180, v181
    v_cvt_pk_bf16_f32 v87, v182, v183
    ds_write_b128 v100, v[84:87] offset:24576
    v_cvt_pk_bf16_f32 v88, v184, v185
    v_cvt_pk_bf16_f32 v89, v186, v187
    v_cvt_pk_bf16_f32 v90, v188, v189
    v_cvt_pk_bf16_f32 v91, v190, v191
    ds_write_b128 v101, v[88:91] offset:24576
    v_cvt_pk_bf16_f32 v76, v192, v193
    v_cvt_pk_bf16_f32 v77, v194, v195
    v_cvt_pk_bf16_f32 v78, v196, v197
    v_cvt_pk_bf16_f32 v79, v198, v199
    ds_write_b128 v102, v[76:79]
    v_cvt_pk_bf16_f32 v80, v200, v201
    v_cvt_pk_bf16_f32 v81, v202, v203
    v_cvt_pk_bf16_f32 v82, v204, v205
    v_cvt_pk_bf16_f32 v83, v206, v207
    ds_write_b128 v103, v[80:83]
    v_cvt_pk_bf16_f32 v84, v208, v209
    v_cvt_pk_bf16_f32 v85, v210, v211
    v_cvt_pk_bf16_f32 v86, v212, v213
    v_cvt_pk_bf16_f32 v87, v214, v215
    ds_write_b128 v102, v[84:87] offset:24576
    v_cvt_pk_bf16_f32 v88, v216, v217
    v_cvt_pk_bf16_f32 v89, v218, v219
    v_cvt_pk_bf16_f32 v90, v220, v221
    v_cvt_pk_bf16_f32 v91, v222, v223
    ds_write_b128 v103, v[88:91] offset:24576
    v_cvt_pk_bf16_f32 v76, v224, v225
    v_cvt_pk_bf16_f32 v77, v226, v227
    v_cvt_pk_bf16_f32 v78, v228, v229
    v_cvt_pk_bf16_f32 v79, v230, v231
    ds_write_b128 v104, v[76:79]
    v_cvt_pk_bf16_f32 v80, v232, v233
    v_cvt_pk_bf16_f32 v81, v234, v235
    v_cvt_pk_bf16_f32 v82, v236, v237
    v_cvt_pk_bf16_f32 v83, v238, v239
    ds_write_b128 v105, v[80:83]
    v_cvt_pk_bf16_f32 v84, v240, v241
    v_cvt_pk_bf16_f32 v85, v242, v243
    v_cvt_pk_bf16_f32 v86, v244, v245
    v_cvt_pk_bf16_f32 v87, v246, v247
    ds_write_b128 v104, v[84:87] offset:24576
    v_cvt_pk_bf16_f32 v88, v248, v249
    v_cvt_pk_bf16_f32 v89, v250, v251
    v_cvt_pk_bf16_f32 v90, v252, v253
    v_cvt_pk_bf16_f32 v91, v254, v255
    ds_write_b128 v105, v[88:91] offset:24576
    s_waitcnt vmcnt(0)
    s_waitcnt lgkmcnt(0)
    s_barrier
    s_setprio 0
L_tb_58:
    v_xor_b32 v24, s45, v68
    v_cmp_lt_u32 vcc, 15, v24
    s_nop 0
    s_cmp_lg_u64 vcc, 0
    s_cbranch_scc1 L_tbs_59
L_tbb_60:
    v_and_b32 v68, 15, v68
    v_cmp_eq_u32 s[52:53], s46, v68
    v_mov_b32 v25, 1
    v_lshlrev_b32 v25, v68, v25
    s_nop 1
    v_or_b32_dpp v25, v25, v25 row_ror:1 row_mask:0xf bank_mask:0xf
    s_nop 1
    v_or_b32_dpp v25, v25, v25 row_ror:2 row_mask:0xf bank_mask:0xf
    s_nop 1
    v_or_b32_dpp v25, v25, v25 row_ror:4 row_mask:0xf bank_mask:0xf
    s_nop 1
    v_or_b32_dpp v25, v25, v25 row_ror:8 row_mask:0xf bank_mask:0xf
    v_mov_b32 v26, v25
    s_nop 1
    v_permlane16_swap_b32 v26, v25
    v_or_b32 v25, v25, v26
    v_mov_b32 v26, v25
    s_nop 1
    v_permlane32_swap_b32 v26, v25
    v_or_b32 v25, v25, v26
    s_bcnt1_i32_b64 s4, s[52:53]
    v_mov_b32 v24, s4
    s_lshl_b32 s5, s3, 3
    v_mov_b32 v26, s5
    v_mov_b32 v70, v24
    v_mov_b32 v71, v25
    ds_write_b64 v26, v[70:71] offset:61504
    s_waitcnt lgkmcnt(0)
    s_barrier
    v_mov_b32 v24, 0
    ds_read_b128 v[68:71], v24 offset:61504
    ds_read_b128 v[72:75], v24 offset:61520
    s_waitcnt lgkmcnt(1)
    v_readfirstlane_b32 s4, v68
    v_readfirstlane_b32 s5, v70
    s_waitcnt lgkmcnt(0)
    v_readfirstlane_b32 s6, v72
    v_readfirstlane_b32 s7, v74
    v_or3_b32 v25, v69, v71, v73
    v_or_b32 v25, v25, v75
    s_nop 0
    v_readfirstlane_b32 s49, v25
    s_add_u32 s5, s5, s4
    s_add_u32 s6, s6, s5
    s_add_u32 s47, s7, s6
    s_cmp_eq_u32 s3, 1
    s_cselect_b32 s59, s4, 0
    s_cmp_eq_u32 s3, 2
    s_cselect_b32 s59, s5, s59
    s_cmp_eq_u32 s3, 3
    s_cselect_b32 s59, s6, s59
    v_mbcnt_lo_u32_b32 v24, s52, 0
    v_mbcnt_hi_u32_b32 v24, s53, v24
    v_add_u32 v24, s59, v24
    v_lshlrev_b32 v25, 2, v24
    v_add_u32 v25, 0xf700, v25
    v_lshlrev_b32 v26, 2, v1
    v_add_u32 v26, 0xf100, v26
    v_cndmask_b32 v25, v26, v25, s[52:53]
    ds_write_b32 v25, v0
    v_cmp_eq_u32 vcc, s2, v0
    v_mov_b32 v25, 0xf060
    s_nop 0
    v_cndmask_b32 v25, v26, v25, vcc
    ds_write_b32 v25, v24
    v_mov_b32 v2, s45
    v_lshlrev_b32 v25, 16, v2
    v_and_b32 v2, 0xffff0000, v2
    s_mov_b32 s50, 0xaaaaaaaa
    s_mov_b32 s51, 0xaaaaaaaa
    v_cndmask_b32 v2, v25, v2, s[50:51]
    v_mov_b32 v3, 0xff61b1e6
    v_lshrrev_b32 v14, 3, v1
    v_and_b32 v24, 7, v1
    v_lshlrev_b32 v15, 4, v24
    s_and_b32 s4, s3, 1
    s_lshl_b32 s4, s4, 7
    v_add_u32 v15, s4, v15
    v_mov_b32 v24, 0
    s_waitcnt lgkmcnt(0)
    s_barrier
    ds_read_b32 v26, v24 offset:61536
    s_waitcnt lgkmcnt(0)
    v_readfirstlane_b32 s48, v26
    s_lshr_b32 s4, s3, 1
    s_mul_i32 s4, s4, s47
    s_add_u32 s99, s48, s4
    s_mov_b32 s100, 0
    s_add_u32 s4, s100, 0
    v_add_u32 v24, s4, v14
    v_cmp_gt_u32 s[66:67], s47, v24
    v_min_u32 v24, 0xff, v24
    v_lshlrev_b32 v24, 2, v24
    ds_read_b32 v8, v24 offset:63232
    s_add_u32 s4, s100, 8
    v_add_u32 v24, s4, v14
    v_cmp_gt_u32 s[68:69], s47, v24
    v_min_u32 v24, 0xff, v24
    v_lshlrev_b32 v24, 2, v24
    ds_read_b32 v9, v24 offset:63232
    s_add_u32 s4, s100, 16
    v_add_u32 v24, s4, v14
    v_cmp_gt_u32 s[70:71], s47, v24
    v_min_u32 v24, 0xff, v24
    v_lshlrev_b32 v24, 2, v24
    ds_read_b32 v10, v24 offset:63232
    s_add_u32 s4, s100, 24
    v_add_u32 v24, s4, v14
    v_cmp_gt_u32 s[72:73], s47, v24
    v_min_u32 v24, 0xff, v24
    v_lshlrev_b32 v24, 2, v24
    ds_read_b32 v11, v24 offset:63232
    v_mov_b32 v25, 0x7ffffff0
    s_waitcnt lgkmcnt(3)
    v_lshl_add_u32 v8, v8, 14, v15
    v_cndmask_b32 v8, v25, v8, s[66:67]
    s_waitcnt lgkmcnt(2)
    v_lshl_add_u32 v9, v9, 14, v15
    v_cndmask_b32 v9, v25, v9, s[68:69]
    s_waitcnt lgkmcnt(1)
    v_lshl_add_u32 v10, v10, 14, v15
    v_cndmask_b32 v10, v25, v10, s[70:71]
    s_waitcnt lgkmcnt(0)
    v_lshl_add_u32 v11, v11, 14, v15
    v_cndmask_b32 v11, v25, v11, s[72:73]
    s_lshl_b32 s80, s99, 8
    s_add_u32 s80, s80, 0x100000
    v_lshrrev_b32 v16, 4, v1
    v_and_b32 v17, 15, v1
    v_lshlrev_b32 v17, 4, v17
    s_lshr_b32 s5, s2, 4
    s_lshl_b32 s4, s3, 4
    s_add_u32 s4, s4, s5
    s_lshl_b32 s81, s4, 12
    s_add_u32 s81, s81, 0x500000
    v_mov_b32 v26, 0x7ffffff0
    v_add_u32 v24, 0, v16
    v_lshrrev_b32 v25, v24, s49
    v_and_b32 v25, 1, v25
    v_cmp_eq_u32 s[74:75], 1, v25
    v_lshl_add_u32 v12, v24, 8, v17
    s_nop 0
    v_cndmask_b32 v12, v26, v12, s[74:75]
    v_add_u32 v24, 4, v16
    v_lshrrev_b32 v25, v24, s49
    v_and_b32 v25, 1, v25
    v_cmp_eq_u32 s[76:77], 1, v25
    v_lshl_add_u32 v13, v24, 8, v17
    s_nop 0
    v_cndmask_b32 v13, v26, v13, s[76:77]
    s_barrier
    s_cmp_ge_u32 s99, 64
    s_cbranch_scc1 L_stageB
    buffer_load_dwordx4 v[164:167], v8, s[20:23], s80 offen sc1
    buffer_load_dwordx4 v[168:171], v9, s[20:23], s80 offen sc1
    buffer_load_dwordx4 v[172:175], v10, s[20:23], s80 offen sc1
    buffer_load_dwordx4 v[176:179], v11, s[20:23], s80 offen sc1
    s_waitcnt vmcnt(0)
    v_xor_b32 v24, v167, v2
    v_cmp_lt_u32 vcc, 0xffff, v24
    s_nop 0
    s_and_b64 s[52:53], vcc, s[66:67]
    v_xor_b32 v24, v171, v2
    v_cmp_lt_u32 vcc, 0xffff, v24
    s_nop 0
    s_and_b64 s[54:55], vcc, s[68:69]
    s_or_b64 s[52:53], s[52:53], s[54:55]
    v_xor_b32 v24, v175, v2
    v_cmp_lt_u32 vcc, 0xffff, v24
    s_nop 0
    s_and_b64 s[54:55], vcc, s[70:71]
    s_or_b64 s[52:53], s[52:53], s[54:55]
    v_xor_b32 v24, v179, v2
    v_cmp_lt_u32 vcc, 0xffff, v24
    s_nop 0
    s_and_b64 s[54:55], vcc, s[72:73]
    s_or_b64 s[52:53], s[52:53], s[54:55]
    s_cbranch_scc1 L_pl_61
L_pd_62:
    v_and_b32 v24, 0xffff, v167
    s_nop 1
    v_mov_b32_dpp v40, v24 quad_perm:[0,0,0,0] row_mask:0xf bank_mask:0xf
    v_mov_b32_dpp v25, v24 quad_perm:[1,1,1,1] row_mask:0xf bank_mask:0xf
    v_mov_b32_dpp v44, v24 quad_perm:[2,2,2,2] row_mask:0xf bank_mask:0xf
    v_mov_b32_dpp v26, v24 quad_perm:[3,3,3,3] row_mask:0xf bank_mask:0xf
    v_lshl_or_b32 v40, v40, 16, v25
    v_lshl_or_b32 v44, v44, 16, v26
    v_cndmask_b32 v40, v3, v40, s[66:67]
    v_and_b32 v24, 0xffff, v171
    s_nop 1
    v_mov_b32_dpp v41, v24 quad_perm:[0,0,0,0] row_mask:0xf bank_mask:0xf
    v_mov_b32_dpp v25, v24 quad_perm:[1,1,1,1] row_mask:0xf bank_mask:0xf
    v_mov_b32_dpp v45, v24 quad_perm:[2,2,2,2] row_mask:0xf bank_mask:0xf
    v_mov_b32_dpp v26, v24 quad_perm:[3,3,3,3] row_mask:0xf bank_mask:0xf
    v_lshl_or_b32 v41, v41, 16, v25
    v_lshl_or_b32 v45, v45, 16, v26
    v_cndmask_b32 v41, v3, v41, s[68:69]
    v_and_b32 v24, 0xffff, v175
    s_nop 1
    v_mov_b32_dpp v42, v24 quad_perm:[0,0,0,0] row_mask:0xf bank_mask:0xf
    v_mov_b32_dpp v25, v24 quad_perm:[1,1,1,1] row_mask:0xf bank_mask:0xf
    v_mov_b32_dpp v46, v24 quad_perm:[2,2,2,2] row_mask:0xf bank_mask:0xf
    v_mov_b32_dpp v26, v24 quad_perm:[3,3,3,3] row_mask:0xf bank_mask:0xf
    v_lshl_or_b32 v42, v42, 16, v25
    v_lshl_or_b32 v46, v46, 16, v26
    v_cndmask_b32 v42, v3, v42, s[70:71]
    v_and_b32 v24, 0xffff, v179
    s_nop 1
    v_mov_b32_dpp v43, v24 quad_perm:[0,0,0,0] row_mask:0xf bank_mask:0xf
    v_mov_b32_dpp v25, v24 quad_perm:[1,1,1,1] row_mask:0xf bank_mask:0xf
    v_mov_b32_dpp v47, v24 quad_perm:[2,2,2,2] row_mask:0xf bank_mask:0xf
    v_mov_b32_dpp v26, v24 quad_perm:[3,3,3,3] row_mask:0xf bank_mask:0xf
    v_lshl_or_b32 v43, v43, 16, v25
    v_lshl_or_b32 v47, v47, 16, v26
    v_cndmask_b32 v43, v3, v43, s[72:73]
    v_max3_f32 v38, v40, v41, v42
    v_max_f32 v38, v38, v43
    s_nop 1
    v_max_f32_dpp v38, v38, v38 row_ror:8 row_mask:0xf bank_mask:0xf
    v_mov_b32 v26, v38
    s_nop 1
    v_permlane16_swap_b32 v26, v38
    v_max_f32 v38, v38, v26
    v_mov_b32 v26, v38
    s_nop 1
    v_permlane32_swap_b32 v26, v38
    v_max_f32 v38, v38, v26
    v_sub_f32 v40, v40, v38
    v_sub_f32 v41, v41, v38
    v_sub_f32 v42, v42, v38
    v_sub_f32 v43, v43, v38
    v_exp_f32 v40, v40
    v_exp_f32 v41, v41
    v_exp_f32 v42, v42
    v_exp_f32 v43, v43
    v_mul_f32 v39, v40, v44
    v_lshlrev_b32 v76, 16, v164
    v_and_b32 v77, 0xffff0000, v164
    v_pk_mul_f32 v[32:33], v[76:77], v[40:41] op_sel:[0,0] op_sel_hi:[1,0]
    v_lshlrev_b32 v76, 16, v165
    v_and_b32 v77, 0xffff0000, v165
    v_pk_mul_f32 v[34:35], v[76:77], v[40:41] op_sel:[0,0] op_sel_hi:[1,0]
    v_lshlrev_b32 v76, 16, v166
    v_and_b32 v77, 0xffff0000, v166
    v_pk_mul_f32 v[36:37], v[76:77], v[40:41] op_sel:[0,0] op_sel_hi:[1,0]
    v_fma_f32 v39, v41, v45, v39
    v_lshlrev_b32 v76, 16, v168
    v_and_b32 v77, 0xffff0000, v168
    v_pk_fma_f32 v[32:33], v[76:77], v[40:41], v[32:33] op_sel:[0,1,0] op_sel_hi:[1,1,1]
    v_lshlrev_b32 v76, 16, v169
    v_and_b32 v77, 0xffff0000, v169
    v_pk_fma_f32 v[34:35], v[76:77], v[40:41], v[34:35] op_sel:[0,1,0] op_sel_hi:[1,1,1]
    v_lshlrev_b32 v76, 16, v170
    v_and_b32 v77, 0xffff0000, v170
    v_pk_fma_f32 v[36:37], v[76:77], v[40:41], v[36:37] op_sel:[0,1,0] op_sel_hi:[1,1,1]
    v_fma_f32 v39, v42, v46, v39
    v_lshlrev_b32 v76, 16, v172
    v_and_b32 v77, 0xffff0000, v172
    v_pk_fma_f32 v[32:33], v[76:77], v[42:43], v[32:33] op_sel:[0,0,0] op_sel_hi:[1,0,1]
    v_lshlrev_b32 v76, 16, v173
    v_and_b32 v77, 0xffff0000, v173
    v_pk_fma_f32 v[34:35], v[76:77], v[42:43], v[34:35] op_sel:[0,0,0] op_sel_hi:[1,0,1]
    v_lshlrev_b32 v76, 16, v174
    v_and_b32 v77, 0xffff0000, v174
    v_pk_fma_f32 v[36:37], v[76:77], v[42:43], v[36:37] op_sel:[0,0,0] op_sel_hi:[1,0,1]
    v_fma_f32 v39, v43, v47, v39
    v_lshlrev_b32 v76, 16, v176
    v_and_b32 v77, 0xffff0000, v176
    v_pk_fma_f32 v[32:33], v[76:77], v[42:43], v[32:33] op_sel:[0,1,0] op_sel_hi:[1,1,1]
    v_lshlrev_b32 v76, 16, v177
    v_and_b32 v77, 0xffff0000, v177
    v_pk_fma_f32 v[34:35], v[76:77], v[42:43], v[34:35] op_sel:[0,1,0] op_sel_hi:[1,1,1]
    v_lshlrev_b32 v76, 16, v178
    v_and_b32 v77, 0xffff0000, v178
    v_pk_fma_f32 v[36:37], v[76:77], v[42:43], v[36:37] op_sel:[0,1,0] op_sel_hi:[1,1,1]
    s_cmp_gt_u32 s47, 32
    s_cbranch_scc1 L_more
L_rowdone:
    v_mov_b32 v24, v39
    v_permlane32_swap_b32 v32, v33
    v_permlane32_swap_b32 v34, v35
    v_permlane32_swap_b32 v36, v37
    v_permlane32_swap_b32 v24, v39
    v_add_f32 v32, v32, v33
    v_add_f32 v34, v34, v35
    v_add_f32 v36, v36, v37
    v_add_f32 v39, v39, v24
    v_permlane16_swap_b32 v32, v34
    s_nop 0
    v_permlane16_swap_b32 v36, v39
    v_add_f32 v32, v32, v34
    v_add_f32 v36, v36, v39
    s_nop 0
    v_add_f32_dpp v32, v32, v32 row_ror:8 row_mask:0xf bank_mask:0xf
    v_add_f32_dpp v36, v36, v36 row_ror:8 row_mask:0xf bank_mask:0xf
    v_mov_b32 v33, v32
    v_mov_b32 v37, v36
    s_lshl_b32 s41, s99, 12
    s_lshl_b32 s4, s46, 8
    s_add_u32 s41, s41, s4
    s_add_u32 s41, s41, 0x500000
    v_permlane32_swap_b32 v33, v32
    v_permlane32_swap_b32 v37, v36
    v_cvt_pk_bf16_f32 v181, v33, v32
    v_cvt_pk_bf16_f32 v182, v37, v36
    v_mov_b32 v35, v37
    v_mov_b32 v180, v181
    s_nop 0
    v_permlane16_swap_b32 v35, v37
    v_permlane16_swap_b32 v180, v181
    v_cndmask_b32 v24, v38, v37, s[94:95]
    v_lshrrev_b32 v25, 16, v24
    v_and_b32 v24, 0xffff, v24
    v_cndmask_b32 v24, v25, v24, s[50:51]
    v_or_b32 v183, v24, v2
    s_mov_b64 exec, 0xff
    buffer_store_dwordx4 v[180:183], v15, s[20:23], s41 offen sc1
    s_mov_b64 exec, -1
    s_lshl_b32 s4, s47, 1
    s_add_u32 s99, s99, s4
    s_cmp_lt_u32 s99, 64
    s_cbranch_scc1 L_nextrow
L_stageB:
    buffer_load_dwordx4 v[164:167], v12, s[20:23], s81 offen sc1
    buffer_load_dwordx4 v[168:171], v13, s[20:23], s81 offen sc1
    s_mul_i32 s4, s3, 0x1800
    v_add_u32 v24, s4, v23
    ds_write_b96 v24, v[112:114]
    ds_write_b96 v24, v[116:118] offset:1024
    ds_write_b96 v24, v[120:122] offset:2048
    ds_write_b96 v24, v[124:126] offset:3072
    ds_write_b96 v24, v[128:130] offset:4096
    ds_write_b96 v24, v[132:134] offset:5120
    s_mov_b32 s32, s64
    s_and_b32 s33, s65, 0xffff
    s_mov_b32 s34, 0x3000
    s_mov_b32 s35, 0x20000
    s_mov_b32 s36, s82
    s_and_b32 s37, s83, 0xffff
    s_mov_b32 s38, 0x3000
    s_mov_b32 s39, 0x20000
    v_lshlrev_b32 v24, 2, v17
    v_lshl_add_u32 v24, v16, 4, v24
    v_add_u32 v7, s4, v24
    s_and_b32 s4, s2, 15
    s_mul_i32 s4, s4, 48
    s_lshr_b32 s5, s2, 4
    s_mul_i32 s6, s5, 0x300
    s_add_u32 s40, s6, s4
    v_lshlrev_b32 v6, 2, v1
    buffer_load_dword v5, v6, s[32:35], s40 offen
    s_waitcnt lgkmcnt(0)
    ds_read_b96 v[192:194], v7
    ds_read_b96 v[196:198], v7 offset:1024
    ds_read_b96 v[200:202], v7 offset:2048
    ds_read_b96 v[204:206], v7 offset:3072
    ds_read_b96 v[208:210], v7 offset:4096
    ds_read_b96 v[212:214], v7 offset:5120
    s_waitcnt lgkmcnt(5)
    v_lshlrev_b32 v128, 16, v192
    v_and_b32 v129, 0xffff0000, v192
    v_lshlrev_b32 v130, 16, v193
    v_and_b32 v131, 0xffff0000, v193
    v_lshlrev_b32 v132, 16, v194
    v_and_b32 v133, 0xffff0000, v194
    s_waitcnt lgkmcnt(4)
    v_lshlrev_b32 v134, 16, v196
    v_and_b32 v135, 0xffff0000, v196
    v_lshlrev_b32 v136, 16, v197
    v_and_b32 v137, 0xffff0000, v197
    v_lshlrev_b32 v138, 16, v198
    v_and_b32 v139, 0xffff0000, v198
    s_waitcnt lgkmcnt(3)
    v_lshlrev_b32 v140, 16, v200
    v_and_b32 v141, 0xffff0000, v200
    v_lshlrev_b32 v142, 16, v201
    v_and_b32 v143, 0xffff0000, v201
    v_lshlrev_b32 v144, 16, v202
    v_and_b32 v145, 0xffff0000, v202
    s_waitcnt lgkmcnt(2)
    v_lshlrev_b32 v146, 16, v204
    v_and_b32 v147, 0xffff0000, v204
    v_lshlrev_b32 v148, 16, v205
    v_and_b32 v149, 0xffff0000, v205
    v_lshlrev_b32 v150, 16, v206
    v_and_b32 v151, 0xffff0000, v206
    s_waitcnt lgkmcnt(1)
    v_lshlrev_b32 v152, 16, v208
    v_and_b32 v153, 0xffff0000, v208
    v_lshlrev_b32 v154, 16, v209
    v_and_b32 v155, 0xffff0000, v209
    v_lshlrev_b32 v156, 16, v210
    v_and_b32 v157, 0xffff0000, v210
    s_waitcnt lgkmcnt(0)
    v_lshlrev_b32 v158, 16, v212
    v_and_b32 v159, 0xffff0000, v212
    v_lshlrev_b32 v160, 16, v213
    v_and_b32 v161, 0xffff0000, v213
    v_lshlrev_b32 v162, 16, v214
    v_and_b32 v163, 0xffff0000, v214
    s_waitcnt vmcnt(0)
    v_xor_b32 v24, v167, v2
    v_cmp_lt_u32 vcc, 0xffff, v24
    s_nop 0
    s_and_b64 s[52:53], vcc, s[74:75]
    v_xor_b32 v24, v171, v2
    v_cmp_lt_u32 vcc, 0xffff, v24
    s_nop 0
    s_and_b64 s[54:55], vcc, s[76:77]
    s_or_b64 s[52:53], s[52:53], s[54:55]
    s_cbranch_scc1 L_pl_73
L_pd_74:
    v_and_b32 v24, 0xffff, v167
    s_nop 1
    v_mov_b32_dpp v40, v24 quad_perm:[0,0,0,0] row_mask:0xf bank_mask:0xf
    v_mov_b32_dpp v25, v24 quad_perm:[1,1,1,1] row_mask:0xf bank_mask:0xf
    v_mov_b32_dpp v44, v24 quad_perm:[2,2,2,2] row_mask:0xf bank_mask:0xf
    v_mov_b32_dpp v26, v24 quad_perm:[3,3,3,3] row_mask:0xf bank_mask:0xf
    v_lshl_or_b32 v40, v40, 16, v25
    v_lshl_or_b32 v44, v44, 16, v26
    v_cndmask_b32 v40, v3, v40, s[74:75]
    v_and_b32 v24, 0xffff, v171
    s_nop 1
    v_mov_b32_dpp v41, v24 quad_perm:[0,0,0,0] row_mask:0xf bank_mask:0xf
    v_mov_b32_dpp v25, v24 quad_perm:[1,1,1,1] row_mask:0xf bank_mask:0xf
    v_mov_b32_dpp v45, v24 quad_perm:[2,2,2,2] row_mask:0xf bank_mask:0xf
    v_mov_b32_dpp v26, v24 quad_perm:[3,3,3,3] row_mask:0xf bank_mask:0xf
    v_lshl_or_b32 v41, v41, 16, v25
    v_lshl_or_b32 v45, v45, 16, v26
    v_cndmask_b32 v41, v3, v41, s[76:77]
    v_max_f32 v38, v40, v41
    v_mov_b32 v26, v38
    s_nop 1
    v_permlane16_swap_b32 v26, v38
    v_max_f32 v38, v38, v26
    v_mov_b32 v26, v38
    s_nop 1
    v_permlane32_swap_b32 v26, v38
    v_max_f32 v38, v38, v26
    v_sub_f32 v40, v40, v38
    v_sub_f32 v41, v41, v38
    v_exp_f32 v40, v40
    v_exp_f32 v41, v41
    v_mul_f32 v39, v40, v44
    v_lshlrev_b32 v76, 16, v164
    v_and_b32 v77, 0xffff0000, v164
    v_pk_mul_f32 v[32:33], v[76:77], v[40:41] op_sel:[0,0] op_sel_hi:[1,0]
    v_lshlrev_b32 v76, 16, v165
    v_and_b32 v77, 0xffff0000, v165
    v_pk_mul_f32 v[34:35], v[76:77], v[40:41] op_sel:[0,0] op_sel_hi:[1,0]
    v_lshlrev_b32 v76, 16, v166
    v_and_b32 v77, 0xffff0000, v166
    v_pk_mul_f32 v[36:37], v[76:77], v[40:41] op_sel:[0,0] op_sel_hi:[1,0]
    v_fma_f32 v39, v41, v45, v39
    v_lshlrev_b32 v76, 16, v168
    v_and_b32 v77, 0xffff0000, v168
    v_pk_fma_f32 v[32:33], v[76:77], v[40:41], v[32:33] op_sel:[0,1,0] op_sel_hi:[1,1,1]
    v_lshlrev_b32 v76, 16, v169
    v_and_b32 v77, 0xffff0000, v169
    v_pk_fma_f32 v[34:35], v[76:77], v[40:41], v[34:35] op_sel:[0,1,0] op_sel_hi:[1,1,1]
    v_lshlrev_b32 v76, 16, v170
    v_and_b32 v77, 0xffff0000, v170
    v_pk_fma_f32 v[36:37], v[76:77], v[40:41], v[36:37] op_sel:[0,1,0] op_sel_hi:[1,1,1]
    s_cmp_ge_u32 s49, 0x100
    s_cbranch_scc1 L_moreB
L_fin:
    v_mov_b32 v24, v39
    v_permlane32_swap_b32 v32, v33
    v_permlane32_swap_b32 v34, v35
    v_permlane32_swap_b32 v36, v37
    v_permlane32_swap_b32 v24, v39
    v_add_f32 v32, v32, v33
    v_add_f32 v34, v34, v35
    v_add_f32 v36, v36, v37
    v_add_f32 v39, v39, v24
    v_permlane16_swap_b32 v32, v34
    s_nop 0
    v_permlane16_swap_b32 v36, v39
    v_add_f32 v32, v32, v34
    v_add_f32 v36, v36, v39
    v_mov_b32 v33, v32
    v_mov_b32 v37, v36
    v_mul_u32_u24 v24, 24, v16
    s_mul_i32 s4, s3, 0x60
    s_add_u32 s4, s4, 0xed00
    v_permlane32_swap_b32 v33, v32
    v_permlane32_swap_b32 v37, v36
    v_mov_b32 v34, v33
    v_mov_b32 v35, v32
    v_mov_b32 v39, v37
    v_mov_b32 v26, v36
    v_permlane16_swap_b32 v33, v34
    v_permlane16_swap_b32 v32, v35
    v_permlane16_swap_b32 v37, v39
    v_permlane16_swap_b32 v36, v26
    v_rcp_f32 v39, v39
    v_add_u32 v24, s4, v24
    v_mov_b32 v25, 0xf100
    v_cmp_eq_u32 vcc, 0, v17
    v_mul_f32 v33, v33, v39
    v_mul_f32 v32, v32, v39
    v_mul_f32 v34, v34, v39
    v_mul_f32 v35, v35, v39
    v_mul_f32 v37, v37, v39
    v_mul_f32 v36, v36, v39
    v_cndmask_b32 v24, v25, v24, vcc
    v_cvt_pk_bf16_f32 v25, v33, v32
    v_lshlrev_b32 v33, 16, v25
    v_and_b32 v32, 0xffff0000, v25
    v_cvt_pk_bf16_f32 v25, v34, v35
    v_lshlrev_b32 v34, 16, v25
    v_and_b32 v35, 0xffff0000, v25
    v_cvt_pk_bf16_f32 v25, v37, v36
    v_lshlrev_b32 v37, 16, v25
    v_and_b32 v36, 0xffff0000, v25
    v_pk_mul_f32 v[40:41], v[128:129], v[32:33] op_sel:[0,1] op_sel_hi:[1,1]
    v_pk_mul_f32 v[42:43], v[130:131], v[32:33] op_sel:[0,1] op_sel_hi:[1,1]
    v_pk_mul_f32 v[44:45], v[132:133], v[32:33] op_sel:[0,1] op_sel_hi:[1,1]
    v_pk_fma_f32 v[40:41], v[134:135], v[32:33], v[40:41] op_sel:[0,0,0] op_sel_hi:[1,0,1]
    v_pk_fma_f32 v[42:43], v[136:137], v[32:33], v[42:43] op_sel:[0,0,0] op_sel_hi:[1,0,1]
    v_pk_fma_f32 v[44:45], v[138:139], v[32:33], v[44:45] op_sel:[0,0,0] op_sel_hi:[1,0,1]
    v_pk_fma_f32 v[40:41], v[140:141], v[34:35], v[40:41] op_sel:[0,0,0] op_sel_hi:[1,0,1]
    v_pk_fma_f32 v[42:43], v[142:143], v[34:35], v[42:43] op_sel:[0,0,0] op_sel_hi:[1,0,1]
    v_pk_fma_f32 v[44:45], v[144:145], v[34:35], v[44:45] op_sel:[0,0,0] op_sel_hi:[1,0,1]
    v_pk_fma_f32 v[40:41], v[146:147], v[34:35], v[40:41] op_sel:[0,1,0] op_sel_hi:[1,1,1]
    v_pk_fma_f32 v[42:43], v[148:149], v[34:35], v[42:43] op_sel:[0,1,0] op_sel_hi:[1,1,1]
    v_pk_fma_f32 v[44:45], v[150:151], v[34:35], v[44:45] op_sel:[0,1,0] op_sel_hi:[1,1,1]
    v_pk_fma_f32 v[40:41], v[152:153], v[36:37], v[40:41] op_sel:[0,1,0] op_sel_hi:[1,1,1]
    v_pk_fma_f32 v[42:43], v[154:155], v[36:37], v[42:43] op_sel:[0,1,0] op_sel_hi:[1,1,1]
    v_pk_fma_f32 v[44:45], v[156:157], v[36:37], v[44:45] op_sel:[0,1,0] op_sel_hi:[1,1,1]
    v_pk_fma_f32 v[40:41], v[158:159], v[36:37], v[40:41] op_sel:[0,0,0] op_sel_hi:[1,0,1]
    v_pk_fma_f32 v[42:43], v[160:161], v[36:37], v[42:43] op_sel:[0,0,0] op_sel_hi:[1,0,1]
    v_pk_fma_f32 v[44:45], v[162:163], v[36:37], v[44:45] op_sel:[0,0,0] op_sel_hi:[1,0,1]
    v_add_f32_dpp v40, v40, v40 row_ror:1 row_mask:0xf bank_mask:0xf
    v_add_f32_dpp v41, v41, v41 row_ror:1 row_mask:0xf bank_mask:0xf
    v_add_f32_dpp v42, v42, v42 row_ror:1 row_mask:0xf bank_mask:0xf
    v_add_f32_dpp v43, v43, v43 row_ror:1 row_mask:0xf bank_mask:0xf
    v_add_f32_dpp v44, v44, v44 row_ror:1 row_mask:0xf bank_mask:0xf
    v_add_f32_dpp v45, v45, v45 row_ror:1 row_mask:0xf bank_mask:0xf
    v_add_f32_dpp v40, v40, v40 row_ror:2 row_mask:0xf bank_mask:0xf
    v_add_f32_dpp v41, v41, v41 row_ror:2 row_mask:0xf bank_mask:0xf
    v_add_f32_dpp v42, v42, v42 row_ror:2 row_mask:0xf bank_mask:0xf
    v_add_f32_dpp v43, v43, v43 row_ror:2 row_mask:0xf bank_mask:0xf
    v_add_f32_dpp v44, v44, v44 row_ror:2 row_mask:0xf bank_mask:0xf
    v_add_f32_dpp v45, v45, v45 row_ror:2 row_mask:0xf bank_mask:0xf
    v_add_f32_dpp v40, v40, v40 row_ror:4 row_mask:0xf bank_mask:0xf
    v_add_f32_dpp v41, v41, v41 row_ror:4 row_mask:0xf bank_mask:0xf
    v_add_f32_dpp v42, v42, v42 row_ror:4 row_mask:0xf bank_mask:0xf
    v_add_f32_dpp v43, v43, v43 row_ror:4 row_mask:0xf bank_mask:0xf
    v_add_f32_dpp v44, v44, v44 row_ror:4 row_mask:0xf bank_mask:0xf
    v_add_f32_dpp v45, v45, v45 row_ror:4 row_mask:0xf bank_mask:0xf
    v_add_f32_dpp v40, v40, v40 row_ror:8 row_mask:0xf bank_mask:0xf
    v_add_f32_dpp v41, v41, v41 row_ror:8 row_mask:0xf bank_mask:0xf
    v_add_f32_dpp v42, v42, v42 row_ror:8 row_mask:0xf bank_mask:0xf
    v_add_f32_dpp v43, v43, v43 row_ror:8 row_mask:0xf bank_mask:0xf
    v_add_f32_dpp v44, v44, v44 row_ror:8 row_mask:0xf bank_mask:0xf
    v_add_f32_dpp v45, v45, v45 row_ror:8 row_mask:0xf bank_mask:0xf
    ds_write_b64 v24, v[40:41]
    ds_write_b64 v24, v[42:43] offset:8
    ds_write_b64 v24, v[44:45] offset:16
    v_min_u32 v24, 11, v1
    v_lshlrev_b32 v24, 3, v24
    v_lshlrev_b32 v32, 16, v5
    v_and_b32 v33, 0xffff0000, v5
    s_waitcnt lgkmcnt(0)
    s_barrier
    s_cmp_lg_u32 s3, 0
    s_cbranch_scc1 L_out
    ds_read_b64 v[112:113], v24 offset:60672
    ds_read_b64 v[114:115], v24 offset:60768
    ds_read_b64 v[116:117], v24 offset:60864
    ds_read_b64 v[118:119], v24 offset:60960
    s_waitcnt lgkmcnt(2)
    v_pk_add_f32 v[112:113], v[112:113], v[114:115]
    s_waitcnt lgkmcnt(0)
    v_pk_add_f32 v[116:117], v[116:117], v[118:119]
    v_pk_add_f32 v[112:113], v[112:113], v[116:117]
    v_cvt_pk_bf16_f32 v25, v112, v113
    v_lshlrev_b32 v112, 16, v25
    v_and_b32 v113, 0xffff0000, v25
    v_add_f32 v112, v112, v32
    v_add_f32 v113, v113, v33
    s_mov_b64 exec, 0xfff
    v_cvt_pk_bf16_f32 v24, v112, v113
    buffer_store_dword v24, v6, s[36:39], s40 offen
    s_mov_b64 exec, -1
L_out:
L_end:
    s_endpgm
L_hotend:
L_es_6:
    s_sleep 4
    v_mov_b32 v29, 0
    buffer_load_dword v29, v29, s[24:27], 0 offen sc1
    s_waitcnt vmcnt(0)
    v_readfirstlane_b32 s44, v29
    s_nop 0
    s_cmp_lg_u32 s44, 0
    s_cbranch_scc1 L_eb_7
    s_add_u32 s56, s56, 1
    s_cmp_lt_u32 s56, 0x61a80
    s_cbranch_scc1 L_es_6
    s_branch L_eb_7
L_ar_9:
    s_mov_b32 s47, 0
    v_min_u32 v24, 17, v1
    v_lshlrev_b32 v24, 7, v24
    s_mul_i32 s4, s3, 0x900
    s_add_u32 s4, s4, 0x70000
    buffer_load_dword v27, v24, s[20:23], s4 offen sc1
    s_waitcnt vmcnt(0)
    v_cmp_ne_u32 vcc, s45, v27
    s_nop 0
    s_lshr_b32 s0, vcc_lo, 12
    s_and_b32 s4, vcc_lo, 0xfff
    s_cbranch_scc0 L_ag_10
    s_sleep 4
    s_add_u32 s56, s56, 1
    s_cmp_lt_u32 s56, 0x61a80
    s_cbranch_scc1 L_ar_9
    s_branch L_ag_10
L_rare_12:
    s_waitcnt lgkmcnt(0)
    s_nop 15
    ds_read_b128 v[96:99], v21
    ds_read_b128 v[100:103], v21 offset:256
    s_waitcnt lgkmcnt(0)
    v_fma_f32 v100, -v100, v29, v48
    v_fma_f32 v101, -v101, v29, v48
    v_fma_f32 v102, -v102, v29, v48
    v_fma_f32 v103, -v103, v29, v48
    v_add_f32 v100, v100, v64
    v_add_f32 v101, v101, v65
    v_add_f32 v102, v102, v66
    v_add_f32 v103, v103, v67
    v_mul_f32 v100, v100, v96
    v_mul_f32 v101, v101, v97
    v_mul_f32 v102, v102, v98
    v_mul_f32 v103, v103, v99
    v_max3_f32 v31, v100, v101, v102
    v_max_f32 v31, v31, v103
    ds_read_b128 v[96:99], v21 offset:64
    ds_read_b128 v[100:103], v21 offset:320
    s_waitcnt lgkmcnt(0)
    v_fma_f32 v100, -v100, v29, v52
    v_fma_f32 v101, -v101, v29, v52
    v_fma_f32 v102, -v102, v29, v52
    v_fma_f32 v103, -v103, v29, v52
    v_add_f32 v100, v100, v68
    v_add_f32 v101, v101, v69
    v_add_f32 v102, v102, v70
    v_add_f32 v103, v103, v71
    v_mul_f32 v100, v100, v96
    v_mul_f32 v101, v101, v97
    v_mul_f32 v102, v102, v98
    v_mul_f32 v103, v103, v99
    v_max3_f32 v31, v100, v101, v31
    v_max3_f32 v31, v102, v103, v31
    ds_read_b128 v[96:99], v21 offset:128
    ds_read_b128 v[100:103], v21 offset:384
    s_waitcnt lgkmcnt(0)
    v_fma_f32 v100, -v100, v29, v56
    v_fma_f32 v101, -v101, v29, v56
    v_fma_f32 v102, -v102, v29, v56
    v_fma_f32 v103, -v103, v29, v56
    v_add_f32 v100, v100, v72
    v_add_f32 v101, v101, v73
    v_add_f32 v102, v102, v74
    v_add_f32 v103, v103, v75
    v_mul_f32 v100, v100, v96
    v_mul_f32 v101, v101, v97
    v_mul_f32 v102, v102, v98
    v_mul_f32 v103, v103, v99
    v_max3_f32 v31, v100, v101, v31
    v_max3_f32 v31, v102, v103, v31
    ds_read_b128 v[96:99], v21 offset:192
    ds_read_b128 v[100:103], v21 offset:448
    s_waitcnt lgkmcnt(0)
    v_fma_f32 v100, -v100, v29, v60
    v_fma_f32 v101, -v101, v29, v60
    v_fma_f32 v102, -v102, v29, v60
    v_fma_f32 v103, -v103, v29, v60
    v_add_f32 v100, v100, v76
    v_add_f32 v101, v101, v77
    v_add_f32 v102, v102, v78
    v_add_f32 v103, v103, v79
    v_mul_f32 v100, v100, v96
    v_mul_f32 v101, v101, v97
    v_mul_f32 v102, v102, v98
    v_mul_f32 v103, v103, v99
    v_max3_f32 v31, v100, v101, v31
    v_max3_f32 v31, v102, v103, v31
    v_mov_b32 v26, v31
    s_nop 1
    v_permlane16_swap_b32 v26, v31
    v_max_f32 v31, v31, v26
    v_mov_b32 v26, v31
    s_nop 1
    v_permlane32_swap_b32 v26, v31
    v_max_f32 v31, v31, v26
    v_max_f32 v31, v31, v27
    v_sub_f32 v24, v27, v31
    v_exp_f32 v24, v24
    v_mov_b32 v27, v31
    v_mul_f32 v28, v28, v24
    v_and_b32 v25, 15, v1
    v_lshlrev_b32 v25, 2, v25
    s_lshl_b32 s4, s3, 6
    v_add_u32 v25, s4, v25
    ds_write_b32 v25, v24 offset:61184
    v_mov_b32 v24, 1
    s_lshl_b32 s4, s3, 2
    v_mov_b32 v25, s4
    ds_write_b32 v25, v24 offset:61440
    ds_read_b128 v[96:99], v21
    ds_read_b128 v[100:103], v21 offset:256
    s_waitcnt lgkmcnt(0)
    v_fma_f32 v100, -v100, v29, v48
    v_fma_f32 v101, -v101, v29, v48
    v_fma_f32 v102, -v102, v29, v48
    v_fma_f32 v103, -v103, v29, v48
    v_add_f32 v100, v100, v64
    v_add_f32 v101, v101, v65
    v_add_f32 v102, v102, v66
    v_add_f32 v103, v103, v67
    v_mul_f32 v100, v100, v96
    v_mul_f32 v101, v101, v97
    v_mul_f32 v102, v102, v98
    v_mul_f32 v103, v103, v99
    v_sub_f32 v100, v100, v27
    v_sub_f32 v101, v101, v27
    v_sub_f32 v102, v102, v27
    v_sub_f32 v103, v103, v27
    v_exp_f32 v100, v100
    v_exp_f32 v101, v101
    v_exp_f32 v102, v102
    v_exp_f32 v103, v103
    v_mul_f32 v96, v96, v100
    v_mul_f32 v97, v97, v101
    v_mul_f32 v98, v98, v102
    v_mul_f32 v99, v99, v103
    v_add_f32 v100, v100, v101
    v_add_f32 v102, v102, v103
    v_add_f32 v30, v100, v102
    v_cvt_pk_bf16_f32 v102, v96, v97
    v_cvt_pk_bf16_f32 v103, v98, v99
    v_add_f32 v96, v96, v97
    v_add_f32 v98, v98, v99
    ds_write_b64 v16, v[102:103]
    v_add_f32 v32, v96, v98
    ds_read_b128 v[96:99], v21 offset:64
    ds_read_b128 v[100:103], v21 offset:320
    s_waitcnt lgkmcnt(0)
    v_fma_f32 v100, -v100, v29, v52
    v_fma_f32 v101, -v101, v29, v52
    v_fma_f32 v102, -v102, v29, v52
    v_fma_f32 v103, -v103, v29, v52
    v_add_f32 v100, v100, v68
    v_add_f32 v101, v101, v69
    v_add_f32 v102, v102, v70
    v_add_f32 v103, v103, v71
    v_mul_f32 v100, v100, v96
    v_mul_f32 v101, v101, v97
    v_mul_f32 v102, v102, v98
    v_mul_f32 v103, v103, v99
    v_sub_f32 v100, v100, v27
    v_sub_f32 v101, v101, v27
    v_sub_f32 v102, v102, v27
    v_sub_f32 v103, v103, v27
    v_exp_f32 v100, v100
    v_exp_f32 v101, v101
    v_exp_f32 v102, v102
    v_exp_f32 v103, v103
    v_mul_f32 v96, v96, v100
    v_mul_f32 v97, v97, v101
    v_mul_f32 v98, v98, v102
    v_mul_f32 v99, v99, v103
    v_add_f32 v100, v100, v101
    v_add_f32 v102, v102, v103
    v_add_f32 v100, v100, v102
    v_add_f32 v30, v30, v100
    v_cvt_pk_bf16_f32 v102, v96, v97
    v_cvt_pk_bf16_f32 v103, v98, v99
    v_add_f32 v96, v96, v97
    v_add_f32 v98, v98, v99
    ds_write_b64 v17, v[102:103]
    v_add_f32 v33, v96, v98
    ds_read_b128 v[96:99], v21 offset:128
    ds_read_b128 v[100:103], v21 offset:384
    s_waitcnt lgkmcnt(0)
    v_fma_f32 v100, -v100, v29, v56
    v_fma_f32 v101, -v101, v29, v56
    v_fma_f32 v102, -v102, v29, v56
    v_fma_f32 v103, -v103, v29, v56
    v_add_f32 v100, v100, v72
    v_add_f32 v101, v101, v73
    v_add_f32 v102, v102, v74
    v_add_f32 v103, v103, v75
    v_mul_f32 v100, v100, v96
    v_mul_f32 v101, v101, v97
    v_mul_f32 v102, v102, v98
    v_mul_f32 v103, v103, v99
    v_sub_f32 v100, v100, v27
    v_sub_f32 v101, v101, v27
    v_sub_f32 v102, v102, v27
    v_sub_f32 v103, v103, v27
    v_exp_f32 v100, v100
    v_exp_f32 v101, v101
    v_exp_f32 v102, v102
    v_exp_f32 v103, v103
    v_mul_f32 v96, v96, v100
    v_mul_f32 v97, v97, v101
    v_mul_f32 v98, v98, v102
    v_mul_f32 v99, v99, v103
    v_add_f32 v100, v100, v101
    v_add_f32 v102, v102, v103
    v_add_f32 v100, v100, v102
    v_add_f32 v30, v30, v100
    v_cvt_pk_bf16_f32 v102, v96, v97
    v_cvt_pk_bf16_f32 v103, v98, v99
    v_add_f32 v96, v96, v97
    v_add_f32 v98, v98, v99
    ds_write_b64 v18, v[102:103]
    v_add_f32 v34, v96, v98
    ds_read_b128 v[96:99], v21 offset:192
    ds_read_b128 v[100:103], v21 offset:448
    s_waitcnt lgkmcnt(0)
    v_fma_f32 v100, -v100, v29, v60
    v_fma_f32 v101, -v101, v29, v60
    v_fma_f32 v102, -v102, v29, v60
    v_fma_f32 v103, -v103, v29, v60
    v_add_f32 v100, v100, v76
    v_add_f32 v101, v101, v77
    v_add_f32 v102, v102, v78
    v_add_f32 v103, v103, v79
    v_mul_f32 v100, v100, v96
    v_mul_f32 v101, v101, v97
    v_mul_f32 v102, v102, v98
    v_mul_f32 v103, v103, v99
    v_sub_f32 v100, v100, v27
    v_sub_f32 v101, v101, v27
    v_sub_f32 v102, v102, v27
    v_sub_f32 v103, v103, v27
    v_exp_f32 v100, v100
    v_exp_f32 v101, v101
    v_exp_f32 v102, v102
    v_exp_f32 v103, v103
    v_mul_f32 v96, v96, v100
    v_mul_f32 v97, v97, v101
    v_mul_f32 v98, v98, v102
    v_mul_f32 v99, v99, v103
    v_add_f32 v100, v100, v101
    v_add_f32 v102, v102, v103
    v_add_f32 v100, v100, v102
    v_add_f32 v30, v30, v100
    v_cvt_pk_bf16_f32 v102, v96, v97
    v_cvt_pk_bf16_f32 v103, v98, v99
    v_add_f32 v96, v96, v97
    v_add_f32 v98, v98, v99
    ds_write_b64 v19, v[102:103]
    v_add_f32 v35, v96, v98
    v_cvt_pk_bf16_f32 v32, v32, v33
    v_cvt_pk_bf16_f32 v33, v34, v35
    ds_write_b64 v20, v[32:33]
    s_waitcnt lgkmcnt(0)
    s_nop 3
    s_branch L_back_13
L_fv_14:
    s_nop 7
    v_min_u32 v24, 17, v1
    v_lshlrev_b32 v24, 7, v24
    s_mul_i32 s4, s3, 0x900
    s_add_u32 s4, s4, 0x70000
    buffer_load_dword v26, v24, s[20:23], s4 offen sc1
    s_waitcnt vmcnt(0)
    v_cmp_ne_u32 vcc, s45, v26
    s_nop 0
    s_lshr_b32 s0, vcc_lo, 12
    s_and_b32 s4, vcc_lo, 0xfff
    s_cmp_eq_u32 s0, 0
    s_cbranch_scc1 L_fvb_15
    s_sleep 4
    s_add_u32 s56, s56, 1
    s_cmp_lt_u32 s56, 0x61a80
    s_cbranch_scc1 L_fv_14
    s_branch L_fvb_15
L_rare_16:
    s_waitcnt lgkmcnt(0)
    s_nop 15
    ds_read_b128 v[96:99], v21
    ds_read_b128 v[100:103], v21 offset:256
    s_waitcnt lgkmcnt(0)
    v_fma_f32 v100, -v100, v29, v49
    v_fma_f32 v101, -v101, v29, v49
    v_fma_f32 v102, -v102, v29, v49
    v_fma_f32 v103, -v103, v29, v49
    v_add_f32 v100, v100, v64
    v_add_f32 v101, v101, v65
    v_add_f32 v102, v102, v66
    v_add_f32 v103, v103, v67
    v_mul_f32 v100, v100, v96
    v_mul_f32 v101, v101, v97
    v_mul_f32 v102, v102, v98
    v_mul_f32 v103, v103, v99
    v_max3_f32 v31, v100, v101, v102
    v_max_f32 v31, v31, v103
    ds_read_b128 v[96:99], v21 offset:64
    ds_read_b128 v[100:103], v21 offset:320
    s_waitcnt lgkmcnt(0)
    v_fma_f32 v100, -v100, v29, v53
    v_fma_f32 v101, -v101, v29, v53
    v_fma_f32 v102, -v102, v29, v53
    v_fma_f32 v103, -v103, v29, v53
    v_add_f32 v100, v100, v68
    v_add_f32 v101, v101, v69
    v_add_f32 v102, v102, v70
    v_add_f32 v103, v103, v71
    v_mul_f32 v100, v100, v96
    v_mul_f32 v101, v101, v97
    v_mul_f32 v102, v102, v98
    v_mul_f32 v103, v103, v99
    v_max3_f32 v31, v100, v101, v31
    v_max3_f32 v31, v102, v103, v31
    ds_read_b128 v[96:99], v21 offset:128
    ds_read_b128 v[100:103], v21 offset:384
    s_waitcnt lgkmcnt(0)
    v_fma_f32 v100, -v100, v29, v57
    v_fma_f32 v101, -v101, v29, v57
    v_fma_f32 v102, -v102, v29, v57
    v_fma_f32 v103, -v103, v29, v57
    v_add_f32 v100, v100, v72
    v_add_f32 v101, v101, v73
    v_add_f32 v102, v102, v74
    v_add_f32 v103, v103, v75
    v_mul_f32 v100, v100, v96
    v_mul_f32 v101, v101, v97
    v_mul_f32 v102, v102, v98
    v_mul_f32 v103, v103, v99
    v_max3_f32 v31, v100, v101, v31
    v_max3_f32 v31, v102, v103, v31
    ds_read_b128 v[96:99], v21 offset:192
    ds_read_b128 v[100:103], v21 offset:448
    s_waitcnt lgkmcnt(0)
    v_fma_f32 v100, -v100, v29, v61
    v_fma_f32 v101, -v101, v29, v61
    v_fma_f32 v102, -v102, v29, v61
    v_fma_f32 v103, -v103, v29, v61
    v_add_f32 v100, v100, v76
    v_add_f32 v101, v101, v77
    v_add_f32 v102, v102, v78
    v_add_f32 v103, v103, v79
    v_mul_f32 v100, v100, v96
    v_mul_f32 v101, v101, v97
    v_mul_f32 v102, v102, v98
    v_mul_f32 v103, v103, v99
    v_max3_f32 v31, v100, v101, v31
    v_max3_f32 v31, v102, v103, v31
    v_mov_b32 v26, v31
    s_nop 1
    v_permlane16_swap_b32 v26, v31
    v_max_f32 v31, v31, v26
    v_mov_b32 v26, v31
    s_nop 1
    v_permlane32_swap_b32 v26, v31
    v_max_f32 v31, v31, v26
    v_max_f32 v31, v31, v27
    v_sub_f32 v24, v27, v31
    v_exp_f32 v24, v24
    v_mov_b32 v27, v31
    v_mul_f32 v28, v28, v24
    v_and_b32 v25, 15, v1
    v_lshlrev_b32 v25, 2, v25
    s_lshl_b32 s4, s3, 6
    v_add_u32 v25, s4, v25
    ds_write_b32 v25, v24 offset:61184
    v_mov_b32 v24, 2
    s_lshl_b32 s4, s3, 2
    v_mov_b32 v25, s4
    ds_write_b32 v25, v24 offset:61440
    ds_read_b128 v[96:99], v21
    ds_read_b128 v[100:103], v21 offset:256
    s_waitcnt lgkmcnt(0)
    v_fma_f32 v100, -v100, v29, v49
    v_fma_f32 v101, -v101, v29, v49
    v_fma_f32 v102, -v102, v29, v49
    v_fma_f32 v103, -v103, v29, v49
    v_add_f32 v100, v100, v64
    v_add_f32 v101, v101, v65
    v_add_f32 v102, v102, v66
    v_add_f32 v103, v103, v67
    v_mul_f32 v100, v100, v96
    v_mul_f32 v101, v101, v97
    v_mul_f32 v102, v102, v98
    v_mul_f32 v103, v103, v99
    v_sub_f32 v100, v100, v27
    v_sub_f32 v101, v101, v27
    v_sub_f32 v102, v102, v27
    v_sub_f32 v103, v103, v27
    v_exp_f32 v100, v100
    v_exp_f32 v101, v101
    v_exp_f32 v102, v102
    v_exp_f32 v103, v103
    v_mul_f32 v96, v96, v100
    v_mul_f32 v97, v97, v101
    v_mul_f32 v98, v98, v102
    v_mul_f32 v99, v99, v103
    v_add_f32 v100, v100, v101
    v_add_f32 v102, v102, v103
    v_add_f32 v30, v100, v102
    v_cvt_pk_bf16_f32 v102, v96, v97
    v_cvt_pk_bf16_f32 v103, v98, v99
    v_add_f32 v96, v96, v97
    v_add_f32 v98, v98, v99
    ds_write_b64 v16, v[102:103]
    v_add_f32 v32, v96, v98
    ds_read_b128 v[96:99], v21 offset:64
    ds_read_b128 v[100:103], v21 offset:320
    s_waitcnt lgkmcnt(0)
    v_fma_f32 v100, -v100, v29, v53
    v_fma_f32 v101, -v101, v29, v53
    v_fma_f32 v102, -v102, v29, v53
    v_fma_f32 v103, -v103, v29, v53
    v_add_f32 v100, v100, v68
    v_add_f32 v101, v101, v69
    v_add_f32 v102, v102, v70
    v_add_f32 v103, v103, v71
    v_mul_f32 v100, v100, v96
    v_mul_f32 v101, v101, v97
    v_mul_f32 v102, v102, v98
    v_mul_f32 v103, v103, v99
    v_sub_f32 v100, v100, v27
    v_sub_f32 v101, v101, v27
    v_sub_f32 v102, v102, v27
    v_sub_f32 v103, v103, v27
    v_exp_f32 v100, v100
    v_exp_f32 v101, v101
    v_exp_f32 v102, v102
    v_exp_f32 v103, v103
    v_mul_f32 v96, v96, v100
    v_mul_f32 v97, v97, v101
    v_mul_f32 v98, v98, v102
    v_mul_f32 v99, v99, v103
    v_add_f32 v100, v100, v101
    v_add_f32 v102, v102, v103
    v_add_f32 v100, v100, v102
    v_add_f32 v30, v30, v100
    v_cvt_pk_bf16_f32 v102, v96, v97
    v_cvt_pk_bf16_f32 v103, v98, v99
    v_add_f32 v96, v96, v97
    v_add_f32 v98, v98, v99
    ds_write_b64 v17, v[102:103]
    v_add_f32 v33, v96, v98
    ds_read_b128 v[96:99], v21 offset:128
    ds_read_b128 v[100:103], v21 offset:384
    s_waitcnt lgkmcnt(0)
    v_fma_f32 v100, -v100, v29, v57
    v_fma_f32 v101, -v101, v29, v57
    v_fma_f32 v102, -v102, v29, v57
    v_fma_f32 v103, -v103, v29, v57
    v_add_f32 v100, v100, v72
    v_add_f32 v101, v101, v73
    v_add_f32 v102, v102, v74
    v_add_f32 v103, v103, v75
    v_mul_f32 v100, v100, v96
    v_mul_f32 v101, v101, v97
    v_mul_f32 v102, v102, v98
    v_mul_f32 v103, v103, v99
    v_sub_f32 v100, v100, v27
    v_sub_f32 v101, v101, v27
    v_sub_f32 v102, v102, v27
    v_sub_f32 v103, v103, v27
    v_exp_f32 v100, v100
    v_exp_f32 v101, v101
    v_exp_f32 v102, v102
    v_exp_f32 v103, v103
    v_mul_f32 v96, v96, v100
    v_mul_f32 v97, v97, v101
    v_mul_f32 v98, v98, v102
    v_mul_f32 v99, v99, v103
    v_add_f32 v100, v100, v101
    v_add_f32 v102, v102, v103
    v_add_f32 v100, v100, v102
    v_add_f32 v30, v30, v100
    v_cvt_pk_bf16_f32 v102, v96, v97
    v_cvt_pk_bf16_f32 v103, v98, v99
    v_add_f32 v96, v96, v97
    v_add_f32 v98, v98, v99
    ds_write_b64 v18, v[102:103]
    v_add_f32 v34, v96, v98
    ds_read_b128 v[96:99], v21 offset:192
    ds_read_b128 v[100:103], v21 offset:448
    s_waitcnt lgkmcnt(0)
    v_fma_f32 v100, -v100, v29, v61
    v_fma_f32 v101, -v101, v29, v61
    v_fma_f32 v102, -v102, v29, v61
    v_fma_f32 v103, -v103, v29, v61
    v_add_f32 v100, v100, v76
    v_add_f32 v101, v101, v77
    v_add_f32 v102, v102, v78
    v_add_f32 v103, v103, v79
    v_mul_f32 v100, v100, v96
    v_mul_f32 v101, v101, v97
    v_mul_f32 v102, v102, v98
    v_mul_f32 v103, v103, v99
    v_sub_f32 v100, v100, v27
    v_sub_f32 v101, v101, v27
    v_sub_f32 v102, v102, v27
    v_sub_f32 v103, v103, v27
    v_exp_f32 v100, v100
    v_exp_f32 v101, v101
    v_exp_f32 v102, v102
    v_exp_f32 v103, v103
    v_mul_f32 v96, v96, v100
    v_mul_f32 v97, v97, v101
    v_mul_f32 v98, v98, v102
    v_mul_f32 v99, v99, v103
    v_add_f32 v100, v100, v101
    v_add_f32 v102, v102, v103
    v_add_f32 v100, v100, v102
    v_add_f32 v30, v30, v100
    v_cvt_pk_bf16_f32 v102, v96, v97
    v_cvt_pk_bf16_f32 v103, v98, v99
    v_add_f32 v96, v96, v97
    v_add_f32 v98, v98, v99
    ds_write_b64 v19, v[102:103]
    v_add_f32 v35, v96, v98
    v_cvt_pk_bf16_f32 v32, v32, v33
    v_cvt_pk_bf16_f32 v33, v34, v35
    ds_write_b64 v20, v[32:33]
    s_waitcnt lgkmcnt(0)
    s_nop 3
    s_branch L_back_17
L_rare_18:
    s_waitcnt lgkmcnt(0)
    s_nop 15
    ds_read_b128 v[96:99], v21
    ds_read_b128 v[100:103], v21 offset:256
    s_waitcnt lgkmcnt(0)
    v_fma_f32 v100, -v100, v29, v50
    v_fma_f32 v101, -v101, v29, v50
    v_fma_f32 v102, -v102, v29, v50
    v_fma_f32 v103, -v103, v29, v50
    v_add_f32 v100, v100, v64
    v_add_f32 v101, v101, v65
    v_add_f32 v102, v102, v66
    v_add_f32 v103, v103, v67
    v_mul_f32 v100, v100, v96
    v_mul_f32 v101, v101, v97
    v_mul_f32 v102, v102, v98
    v_mul_f32 v103, v103, v99
    v_max3_f32 v31, v100, v101, v102
    v_max_f32 v31, v31, v103
    ds_read_b128 v[96:99], v21 offset:64
    ds_read_b128 v[100:103], v21 offset:320
    s_waitcnt lgkmcnt(0)
    v_fma_f32 v100, -v100, v29, v54
    v_fma_f32 v101, -v101, v29, v54
    v_fma_f32 v102, -v102, v29, v54
    v_fma_f32 v103, -v103, v29, v54
    v_add_f32 v100, v100, v68
    v_add_f32 v101, v101, v69
    v_add_f32 v102, v102, v70
    v_add_f32 v103, v103, v71
    v_mul_f32 v100, v100, v96
    v_mul_f32 v101, v101, v97
    v_mul_f32 v102, v102, v98
    v_mul_f32 v103, v103, v99
    v_max3_f32 v31, v100, v101, v31
    v_max3_f32 v31, v102, v103, v31
    ds_read_b128 v[96:99], v21 offset:128
    ds_read_b128 v[100:103], v21 offset:384
    s_waitcnt lgkmcnt(0)
    v_fma_f32 v100, -v100, v29, v58
    v_fma_f32 v101, -v101, v29, v58
    v_fma_f32 v102, -v102, v29, v58
    v_fma_f32 v103, -v103, v29, v58
    v_add_f32 v100, v100, v72
    v_add_f32 v101, v101, v73
    v_add_f32 v102, v102, v74
    v_add_f32 v103, v103, v75
    v_mul_f32 v100, v100, v96
    v_mul_f32 v101, v101, v97
    v_mul_f32 v102, v102, v98
    v_mul_f32 v103, v103, v99
    v_max3_f32 v31, v100, v101, v31
    v_max3_f32 v31, v102, v103, v31
    ds_read_b128 v[96:99], v21 offset:192
    ds_read_b128 v[100:103], v21 offset:448
    s_waitcnt lgkmcnt(0)
    v_fma_f32 v100, -v100, v29, v62
    v_fma_f32 v101, -v101, v29, v62
    v_fma_f32 v102, -v102, v29, v62
    v_fma_f32 v103, -v103, v29, v62
    v_add_f32 v100, v100, v76
    v_add_f32 v101, v101, v77
    v_add_f32 v102, v102, v78
    v_add_f32 v103, v103, v79
    v_mul_f32 v100, v100, v96
    v_mul_f32 v101, v101, v97
    v_mul_f32 v102, v102, v98
    v_mul_f32 v103, v103, v99
    v_max3_f32 v31, v100, v101, v31
    v_max3_f32 v31, v102, v103, v31
    v_mov_b32 v26, v31
    s_nop 1
    v_permlane16_swap_b32 v26, v31
    v_max_f32 v31, v31, v26
    v_mov_b32 v26, v31
    s_nop 1
    v_permlane32_swap_b32 v26, v31
    v_max_f32 v31, v31, v26
    v_max_f32 v31, v31, v27
    v_sub_f32 v24, v27, v31
    v_exp_f32 v24, v24
    v_mov_b32 v27, v31
    v_mul_f32 v28, v28, v24
    v_and_b32 v25, 15, v1
    v_lshlrev_b32 v25, 2, v25
    s_lshl_b32 s4, s3, 6
    v_add_u32 v25, s4, v25
    ds_write_b32 v25, v24 offset:61184
    v_mov_b32 v24, 3
    s_lshl_b32 s4, s3, 2
    v_mov_b32 v25, s4
    ds_write_b32 v25, v24 offset:61440
    ds_read_b128 v[96:99], v21
    ds_read_b128 v[100:103], v21 offset:256
    s_waitcnt lgkmcnt(0)
    v_fma_f32 v100, -v100, v29, v50
    v_fma_f32 v101, -v101, v29, v50
    v_fma_f32 v102, -v102, v29, v50
    v_fma_f32 v103, -v103, v29, v50
    v_add_f32 v100, v100, v64
    v_add_f32 v101, v101, v65
    v_add_f32 v102, v102, v66
    v_add_f32 v103, v103, v67
    v_mul_f32 v100, v100, v96
    v_mul_f32 v101, v101, v97
    v_mul_f32 v102, v102, v98
    v_mul_f32 v103, v103, v99
    v_sub_f32 v100, v100, v27
    v_sub_f32 v101, v101, v27
    v_sub_f32 v102, v102, v27
    v_sub_f32 v103, v103, v27
    v_exp_f32 v100, v100
    v_exp_f32 v101, v101
    v_exp_f32 v102, v102
    v_exp_f32 v103, v103
    v_mul_f32 v96, v96, v100
    v_mul_f32 v97, v97, v101
    v_mul_f32 v98, v98, v102
    v_mul_f32 v99, v99, v103
    v_add_f32 v100, v100, v101
    v_add_f32 v102, v102, v103
    v_add_f32 v30, v100, v102
    v_cvt_pk_bf16_f32 v102, v96, v97
    v_cvt_pk_bf16_f32 v103, v98, v99
    v_add_f32 v96, v96, v97
    v_add_f32 v98, v98, v99
    ds_write_b64 v16, v[102:103]
    v_add_f32 v32, v96, v98
    ds_read_b128 v[96:99], v21 offset:64
    ds_read_b128 v[100:103], v21 offset:320
    s_waitcnt lgkmcnt(0)
    v_fma_f32 v100, -v100, v29, v54
    v_fma_f32 v101, -v101, v29, v54
    v_fma_f32 v102, -v102, v29, v54
    v_fma_f32 v103, -v103, v29, v54
    v_add_f32 v100, v100, v68
    v_add_f32 v101, v101, v69
    v_add_f32 v102, v102, v70
    v_add_f32 v103, v103, v71
    v_mul_f32 v100, v100, v96
    v_mul_f32 v101, v101, v97
    v_mul_f32 v102, v102, v98
    v_mul_f32 v103, v103, v99
    v_sub_f32 v100, v100, v27
    v_sub_f32 v101, v101, v27
    v_sub_f32 v102, v102, v27
    v_sub_f32 v103, v103, v27
    v_exp_f32 v100, v100
    v_exp_f32 v101, v101
    v_exp_f32 v102, v102
    v_exp_f32 v103, v103
    v_mul_f32 v96, v96, v100
    v_mul_f32 v97, v97, v101
    v_mul_f32 v98, v98, v102
    v_mul_f32 v99, v99, v103
    v_add_f32 v100, v100, v101
    v_add_f32 v102, v102, v103
    v_add_f32 v100, v100, v102
    v_add_f32 v30, v30, v100
    v_cvt_pk_bf16_f32 v102, v96, v97
    v_cvt_pk_bf16_f32 v103, v98, v99
    v_add_f32 v96, v96, v97
    v_add_f32 v98, v98, v99
    ds_write_b64 v17, v[102:103]
    v_add_f32 v33, v96, v98
    ds_read_b128 v[96:99], v21 offset:128
    ds_read_b128 v[100:103], v21 offset:384
    s_waitcnt lgkmcnt(0)
    v_fma_f32 v100, -v100, v29, v58
    v_fma_f32 v101, -v101, v29, v58
    v_fma_f32 v102, -v102, v29, v58
    v_fma_f32 v103, -v103, v29, v58
    v_add_f32 v100, v100, v72
    v_add_f32 v101, v101, v73
    v_add_f32 v102, v102, v74
    v_add_f32 v103, v103, v75
    v_mul_f32 v100, v100, v96
    v_mul_f32 v101, v101, v97
    v_mul_f32 v102, v102, v98
    v_mul_f32 v103, v103, v99
    v_sub_f32 v100, v100, v27
    v_sub_f32 v101, v101, v27
    v_sub_f32 v102, v102, v27
    v_sub_f32 v103, v103, v27
    v_exp_f32 v100, v100
    v_exp_f32 v101, v101
    v_exp_f32 v102, v102
    v_exp_f32 v103, v103
    v_mul_f32 v96, v96, v100
    v_mul_f32 v97, v97, v101
    v_mul_f32 v98, v98, v102
    v_mul_f32 v99, v99, v103
    v_add_f32 v100, v100, v101
    v_add_f32 v102, v102, v103
    v_add_f32 v100, v100, v102
    v_add_f32 v30, v30, v100
    v_cvt_pk_bf16_f32 v102, v96, v97
    v_cvt_pk_bf16_f32 v103, v98, v99
    v_add_f32 v96, v96, v97
    v_add_f32 v98, v98, v99
    ds_write_b64 v18, v[102:103]
    v_add_f32 v34, v96, v98
    ds_read_b128 v[96:99], v21 offset:192
    ds_read_b128 v[100:103], v21 offset:448
    s_waitcnt lgkmcnt(0)
    v_fma_f32 v100, -v100, v29, v62
    v_fma_f32 v101, -v101, v29, v62
    v_fma_f32 v102, -v102, v29, v62
    v_fma_f32 v103, -v103, v29, v62
    v_add_f32 v100, v100, v76
    v_add_f32 v101, v101, v77
    v_add_f32 v102, v102, v78
    v_add_f32 v103, v103, v79
    v_mul_f32 v100, v100, v96
    v_mul_f32 v101, v101, v97
    v_mul_f32 v102, v102, v98
    v_mul_f32 v103, v103, v99
    v_sub_f32 v100, v100, v27
    v_sub_f32 v101, v101, v27
    v_sub_f32 v102, v102, v27
    v_sub_f32 v103, v103, v27
    v_exp_f32 v100, v100
    v_exp_f32 v101, v101
    v_exp_f32 v102, v102
    v_exp_f32 v103, v103
    v_mul_f32 v96, v96, v100
    v_mul_f32 v97, v97, v101
    v_mul_f32 v98, v98, v102
    v_mul_f32 v99, v99, v103
    v_add_f32 v100, v100, v101
    v_add_f32 v102, v102, v103
    v_add_f32 v100, v100, v102
    v_add_f32 v30, v30, v100
    v_cvt_pk_bf16_f32 v102, v96, v97
    v_cvt_pk_bf16_f32 v103, v98, v99
    v_add_f32 v96, v96, v97
    v_add_f32 v98, v98, v99
    ds_write_b64 v19, v[102:103]
    v_add_f32 v35, v96, v98
    v_cvt_pk_bf16_f32 v32, v32, v33
    v_cvt_pk_bf16_f32 v33, v34, v35
    ds_write_b64 v20, v[32:33]
    s_waitcnt lgkmcnt(0)
    s_nop 3
    s_branch L_back_19
L_rare_20:
    s_waitcnt lgkmcnt(0)
    s_nop 15
    ds_read_b128 v[96:99], v21
    ds_read_b128 v[100:103], v21 offset:256
    s_waitcnt lgkmcnt(0)
    v_fma_f32 v100, -v100, v29, v51
    v_fma_f32 v101, -v101, v29, v51
    v_fma_f32 v102, -v102, v29, v51
    v_fma_f32 v103, -v103, v29, v51
    v_add_f32 v100, v100, v64
    v_add_f32 v101, v101, v65
    v_add_f32 v102, v102, v66
    v_add_f32 v103, v103, v67
    v_mul_f32 v100, v100, v96
    v_mul_f32 v101, v101, v97
    v_mul_f32 v102, v102, v98
    v_mul_f32 v103, v103, v99
    v_max3_f32 v31, v100, v101, v102
    v_max_f32 v31, v31, v103
    ds_read_b128 v[96:99], v21 offset:64
    ds_read_b128 v[100:103], v21 offset:320
    s_waitcnt lgkmcnt(0)
    v_fma_f32 v100, -v100, v29, v55
    v_fma_f32 v101, -v101, v29, v55
    v_fma_f32 v102, -v102, v29, v55
    v_fma_f32 v103, -v103, v29, v55
    v_add_f32 v100, v100, v68
    v_add_f32 v101, v101, v69
    v_add_f32 v102, v102, v70
    v_add_f32 v103, v103, v71
    v_mul_f32 v100, v100, v96
    v_mul_f32 v101, v101, v97
    v_mul_f32 v102, v102, v98
    v_mul_f32 v103, v103, v99
    v_max3_f32 v31, v100, v101, v31
    v_max3_f32 v31, v102, v103, v31
    ds_read_b128 v[96:99], v21 offset:128
    ds_read_b128 v[100:103], v21 offset:384
    s_waitcnt lgkmcnt(0)
    v_fma_f32 v100, -v100, v29, v59
    v_fma_f32 v101, -v101, v29, v59
    v_fma_f32 v102, -v102, v29, v59
    v_fma_f32 v103, -v103, v29, v59
    v_add_f32 v100, v100, v72
    v_add_f32 v101, v101, v73
    v_add_f32 v102, v102, v74
    v_add_f32 v103, v103, v75
    v_mul_f32 v100, v100, v96
    v_mul_f32 v101, v101, v97
    v_mul_f32 v102, v102, v98
    v_mul_f32 v103, v103, v99
    v_max3_f32 v31, v100, v101, v31
    v_max3_f32 v31, v102, v103, v31
    ds_read_b128 v[96:99], v21 offset:192
    ds_read_b128 v[100:103], v21 offset:448
    s_waitcnt lgkmcnt(0)
    v_fma_f32 v100, -v100, v29, v63
    v_fma_f32 v101, -v101, v29, v63
    v_fma_f32 v102, -v102, v29, v63
    v_fma_f32 v103, -v103, v29, v63
    v_add_f32 v100, v100, v76
    v_add_f32 v101, v101, v77
    v_add_f32 v102, v102, v78
    v_add_f32 v103, v103, v79
    v_mul_f32 v100, v100, v96
    v_mul_f32 v101, v101, v97
    v_mul_f32 v102, v102, v98
    v_mul_f32 v103, v103, v99
    v_max3_f32 v31, v100, v101, v31
    v_max3_f32 v31, v102, v103, v31
    v_mov_b32 v26, v31
    s_nop 1
    v_permlane16_swap_b32 v26, v31
    v_max_f32 v31, v31, v26
    v_mov_b32 v26, v31
    s_nop 1
    v_permlane32_swap_b32 v26, v31
    v_max_f32 v31, v31, v26
    v_max_f32 v31, v31, v27
    v_sub_f32 v24, v27, v31
    v_exp_f32 v24, v24
    v_mov_b32 v27, v31
    v_mul_f32 v28, v28, v24
    v_and_b32 v25, 15, v1
    v_lshlrev_b32 v25, 2, v25
    s_lshl_b32 s4, s3, 6
    v_add_u32 v25, s4, v25
    ds_write_b32 v25, v24 offset:61184
    v_mov_b32 v24, 4
    s_lshl_b32 s4, s3, 2
    v_mov_b32 v25, s4
    ds_write_b32 v25, v24 offset:61440
    ds_read_b128 v[96:99], v21
    ds_read_b128 v[100:103], v21 offset:256
    s_waitcnt lgkmcnt(0)
    v_fma_f32 v100, -v100, v29, v51
    v_fma_f32 v101, -v101, v29, v51
    v_fma_f32 v102, -v102, v29, v51
    v_fma_f32 v103, -v103, v29, v51
    v_add_f32 v100, v100, v64
    v_add_f32 v101, v101, v65
    v_add_f32 v102, v102, v66
    v_add_f32 v103, v103, v67
    v_mul_f32 v100, v100, v96
    v_mul_f32 v101, v101, v97
    v_mul_f32 v102, v102, v98
    v_mul_f32 v103, v103, v99
    v_sub_f32 v100, v100, v27
    v_sub_f32 v101, v101, v27
    v_sub_f32 v102, v102, v27
    v_sub_f32 v103, v103, v27
    v_exp_f32 v100, v100
    v_exp_f32 v101, v101
    v_exp_f32 v102, v102
    v_exp_f32 v103, v103
    v_mul_f32 v96, v96, v100
    v_mul_f32 v97, v97, v101
    v_mul_f32 v98, v98, v102
    v_mul_f32 v99, v99, v103
    v_add_f32 v100, v100, v101
    v_add_f32 v102, v102, v103
    v_add_f32 v30, v100, v102
    v_cvt_pk_bf16_f32 v102, v96, v97
    v_cvt_pk_bf16_f32 v103, v98, v99
    v_add_f32 v96, v96, v97
    v_add_f32 v98, v98, v99
    ds_write_b64 v16, v[102:103]
    v_add_f32 v32, v96, v98
    ds_read_b128 v[96:99], v21 offset:64
    ds_read_b128 v[100:103], v21 offset:320
    s_waitcnt lgkmcnt(0)
    v_fma_f32 v100, -v100, v29, v55
    v_fma_f32 v101, -v101, v29, v55
    v_fma_f32 v102, -v102, v29, v55
    v_fma_f32 v103, -v103, v29, v55
    v_add_f32 v100, v100, v68
    v_add_f32 v101, v101, v69
    v_add_f32 v102, v102, v70
    v_add_f32 v103, v103, v71
    v_mul_f32 v100, v100, v96
    v_mul_f32 v101, v101, v97
    v_mul_f32 v102, v102, v98
    v_mul_f32 v103, v103, v99
    v_sub_f32 v100, v100, v27
    v_sub_f32 v101, v101, v27
    v_sub_f32 v102, v102, v27
    v_sub_f32 v103, v103, v27
    v_exp_f32 v100, v100
    v_exp_f32 v101, v101
    v_exp_f32 v102, v102
    v_exp_f32 v103, v103
    v_mul_f32 v96, v96, v100
    v_mul_f32 v97, v97, v101
    v_mul_f32 v98, v98, v102
    v_mul_f32 v99, v99, v103
    v_add_f32 v100, v100, v101
    v_add_f32 v102, v102, v103
    v_add_f32 v100, v100, v102
    v_add_f32 v30, v30, v100
    v_cvt_pk_bf16_f32 v102, v96, v97
    v_cvt_pk_bf16_f32 v103, v98, v99
    v_add_f32 v96, v96, v97
    v_add_f32 v98, v98, v99
    ds_write_b64 v17, v[102:103]
    v_add_f32 v33, v96, v98
    ds_read_b128 v[96:99], v21 offset:128
    ds_read_b128 v[100:103], v21 offset:384
    s_waitcnt lgkmcnt(0)
    v_fma_f32 v100, -v100, v29, v59
    v_fma_f32 v101, -v101, v29, v59
    v_fma_f32 v102, -v102, v29, v59
    v_fma_f32 v103, -v103, v29, v59
    v_add_f32 v100, v100, v72
    v_add_f32 v101, v101, v73
    v_add_f32 v102, v102, v74
    v_add_f32 v103, v103, v75
    v_mul_f32 v100, v100, v96
    v_mul_f32 v101, v101, v97
    v_mul_f32 v102, v102, v98
    v_mul_f32 v103, v103, v99
    v_sub_f32 v100, v100, v27
    v_sub_f32 v101, v101, v27
    v_sub_f32 v102, v102, v27
    v_sub_f32 v103, v103, v27
    v_exp_f32 v100, v100
    v_exp_f32 v101, v101
    v_exp_f32 v102, v102
    v_exp_f32 v103, v103
    v_mul_f32 v96, v96, v100
    v_mul_f32 v97, v97, v101
    v_mul_f32 v98, v98, v102
    v_mul_f32 v99, v99, v103
    v_add_f32 v100, v100, v101
    v_add_f32 v102, v102, v103
    v_add_f32 v100, v100, v102
    v_add_f32 v30, v30, v100
    v_cvt_pk_bf16_f32 v102, v96, v97
    v_cvt_pk_bf16_f32 v103, v98, v99
    v_add_f32 v96, v96, v97
    v_add_f32 v98, v98, v99
    ds_write_b64 v18, v[102:103]
    v_add_f32 v34, v96, v98
    ds_read_b128 v[96:99], v21 offset:192
    ds_read_b128 v[100:103], v21 offset:448
    s_waitcnt lgkmcnt(0)
    v_fma_f32 v100, -v100, v29, v63
    v_fma_f32 v101, -v101, v29, v63
    v_fma_f32 v102, -v102, v29, v63
    v_fma_f32 v103, -v103, v29, v63
    v_add_f32 v100, v100, v76
    v_add_f32 v101, v101, v77
    v_add_f32 v102, v102, v78
    v_add_f32 v103, v103, v79
    v_mul_f32 v100, v100, v96
    v_mul_f32 v101, v101, v97
    v_mul_f32 v102, v102, v98
    v_mul_f32 v103, v103, v99
    v_sub_f32 v100, v100, v27
    v_sub_f32 v101, v101, v27
    v_sub_f32 v102, v102, v27
    v_sub_f32 v103, v103, v27
    v_exp_f32 v100, v100
    v_exp_f32 v101, v101
    v_exp_f32 v102, v102
    v_exp_f32 v103, v103
    v_mul_f32 v96, v96, v100
    v_mul_f32 v97, v97, v101
    v_mul_f32 v98, v98, v102
    v_mul_f32 v99, v99, v103
    v_add_f32 v100, v100, v101
    v_add_f32 v102, v102, v103
    v_add_f32 v100, v100, v102
    v_add_f32 v30, v30, v100
    v_cvt_pk_bf16_f32 v102, v96, v97
    v_cvt_pk_bf16_f32 v103, v98, v99
    v_add_f32 v96, v96, v97
    v_add_f32 v98, v98, v99
    ds_write_b64 v19, v[102:103]
    v_add_f32 v35, v96, v98
    v_cvt_pk_bf16_f32 v32, v32, v33
    v_cvt_pk_bf16_f32 v33, v34, v35
    ds_write_b64 v20, v[32:33]
    s_waitcnt lgkmcnt(0)
    s_nop 3
    s_branch L_back_21
L_es_22:
    s_sleep 4
    v_mov_b32 v29, 0
    buffer_load_dword v29, v29, s[24:27], 0 offen sc1
    s_waitcnt vmcnt(0)
    v_readfirstlane_b32 s44, v29
    s_nop 0
    s_cmp_lg_u32 s44, 0
    s_cbranch_scc1 L_eb_23
    s_add_u32 s56, s56, 1
    s_cmp_lt_u32 s56, 0x61a80
    s_cbranch_scc1 L_es_22
    s_branch L_eb_23
L_ar_25:
    s_mov_b32 s47, 0
    v_min_u32 v24, 17, v1
    v_lshlrev_b32 v24, 7, v24
    s_mul_i32 s4, s3, 0x900
    s_add_u32 s4, s4, 0x70000
    buffer_load_dword v27, v24, s[20:23], s4 offen sc1
    s_waitcnt vmcnt(0)
    v_cmp_ne_u32 vcc, s45, v27
    s_nop 0
    s_lshr_b32 s0, vcc_lo, 12
    s_and_b32 s4, vcc_lo, 0xfff
    s_cbranch_scc0 L_ag_26
    s_sleep 4
    s_add_u32 s56, s56, 1
    s_cmp_lt_u32 s56, 0x61a80
    s_cbranch_scc1 L_ar_25
    s_branch L_ag_26
L_rare_28:
    s_waitcnt lgkmcnt(0)
    s_nop 15
    ds_read_b128 v[96:99], v21
    ds_read_b128 v[100:103], v21 offset:256
    s_waitcnt lgkmcnt(0)
    v_fma_f32 v100, -v100, v29, v48
    v_fma_f32 v101, -v101, v29, v48
    v_fma_f32 v102, -v102, v29, v48
    v_fma_f32 v103, -v103, v29, v48
    v_add_f32 v100, v100, v64
    v_add_f32 v101, v101, v65
    v_add_f32 v102, v102, v66
    v_add_f32 v103, v103, v67
    v_mul_f32 v100, v100, v96
    v_mul_f32 v101, v101, v97
    v_mul_f32 v102, v102, v98
    v_mul_f32 v103, v103, v99
    v_max3_f32 v31, v100, v101, v102
    v_max_f32 v31, v31, v103
    ds_read_b128 v[96:99], v21 offset:64
    ds_read_b128 v[100:103], v21 offset:320
    s_waitcnt lgkmcnt(0)
    v_fma_f32 v100, -v100, v29, v52
    v_fma_f32 v101, -v101, v29, v52
    v_fma_f32 v102, -v102, v29, v52
    v_fma_f32 v103, -v103, v29, v52
    v_add_f32 v100, v100, v68
    v_add_f32 v101, v101, v69
    v_add_f32 v102, v102, v70
    v_add_f32 v103, v103, v71
    v_mul_f32 v100, v100, v96
    v_mul_f32 v101, v101, v97
    v_mul_f32 v102, v102, v98
    v_mul_f32 v103, v103, v99
    v_max3_f32 v31, v100, v101, v31
    v_max3_f32 v31, v102, v103, v31
    ds_read_b128 v[96:99], v21 offset:128
    ds_read_b128 v[100:103], v21 offset:384
    s_waitcnt lgkmcnt(0)
    v_fma_f32 v100, -v100, v29, v56
    v_fma_f32 v101, -v101, v29, v56
    v_fma_f32 v102, -v102, v29, v56
    v_fma_f32 v103, -v103, v29, v56
    v_add_f32 v100, v100, v72
    v_add_f32 v101, v101, v73
    v_add_f32 v102, v102, v74
    v_add_f32 v103, v103, v75
    v_mul_f32 v100, v100, v96
    v_mul_f32 v101, v101, v97
    v_mul_f32 v102, v102, v98
    v_mul_f32 v103, v103, v99
    v_max3_f32 v31, v100, v101, v31
    v_max3_f32 v31, v102, v103, v31
    ds_read_b128 v[96:99], v21 offset:192
    ds_read_b128 v[100:103], v21 offset:448
    s_waitcnt lgkmcnt(0)
    v_fma_f32 v100, -v100, v29, v60
    v_fma_f32 v101, -v101, v29, v60
    v_fma_f32 v102, -v102, v29, v60
    v_fma_f32 v103, -v103, v29, v60
    v_add_f32 v100, v100, v76
    v_add_f32 v101, v101, v77
    v_add_f32 v102, v102, v78
    v_add_f32 v103, v103, v79
    v_mul_f32 v100, v100, v96
    v_mul_f32 v101, v101, v97
    v_mul_f32 v102, v102, v98
    v_mul_f32 v103, v103, v99
    v_max3_f32 v31, v100, v101, v31
    v_max3_f32 v31, v102, v103, v31
    v_mov_b32 v26, v31
    s_nop 1
    v_permlane16_swap_b32 v26, v31
    v_max_f32 v31, v31, v26
    v_mov_b32 v26, v31
    s_nop 1
    v_permlane32_swap_b32 v26, v31
    v_max_f32 v31, v31, v26
    v_max_f32 v31, v31, v27
    v_sub_f32 v24, v27, v31
    v_exp_f32 v24, v24
    v_mov_b32 v27, v31
    v_mul_f32 v28, v28, v24
    v_and_b32 v25, 15, v1
    v_lshlrev_b32 v25, 2, v25
    s_lshl_b32 s4, s3, 6
    v_add_u32 v25, s4, v25
    ds_write_b32 v25, v24 offset:61184
    v_mov_b32 v24, 1
    s_lshl_b32 s4, s3, 2
    v_mov_b32 v25, s4
    ds_write_b32 v25, v24 offset:61440
    ds_read_b128 v[96:99], v21
    ds_read_b128 v[100:103], v21 offset:256
    s_waitcnt lgkmcnt(0)
    v_fma_f32 v100, -v100, v29, v48
    v_fma_f32 v101, -v101, v29, v48
    v_fma_f32 v102, -v102, v29, v48
    v_fma_f32 v103, -v103, v29, v48
    v_add_f32 v100, v100, v64
    v_add_f32 v101, v101, v65
    v_add_f32 v102, v102, v66
    v_add_f32 v103, v103, v67
    v_mul_f32 v100, v100, v96
    v_mul_f32 v101, v101, v97
    v_mul_f32 v102, v102, v98
    v_mul_f32 v103, v103, v99
    v_sub_f32 v100, v100, v27
    v_sub_f32 v101, v101, v27
    v_sub_f32 v102, v102, v27
    v_sub_f32 v103, v103, v27
    v_exp_f32 v100, v100
    v_exp_f32 v101, v101
    v_exp_f32 v102, v102
    v_exp_f32 v103, v103
    v_mul_f32 v96, v96, v100
    v_mul_f32 v97, v97, v101
    v_mul_f32 v98, v98, v102
    v_mul_f32 v99, v99, v103
    v_add_f32 v100, v100, v101
    v_add_f32 v102, v102, v103
    v_add_f32 v30, v100, v102
    v_cvt_pk_bf16_f32 v102, v96, v97
    v_cvt_pk_bf16_f32 v103, v98, v99
    v_add_f32 v96, v96, v97
    v_add_f32 v98, v98, v99
    ds_write_b64 v16, v[102:103]
    v_add_f32 v32, v96, v98
    ds_read_b128 v[96:99], v21 offset:64
    ds_read_b128 v[100:103], v21 offset:320
    s_waitcnt lgkmcnt(0)
    v_fma_f32 v100, -v100, v29, v52
    v_fma_f32 v101, -v101, v29, v52
    v_fma_f32 v102, -v102, v29, v52
    v_fma_f32 v103, -v103, v29, v52
    v_add_f32 v100, v100, v68
    v_add_f32 v101, v101, v69
    v_add_f32 v102, v102, v70
    v_add_f32 v103, v103, v71
    v_mul_f32 v100, v100, v96
    v_mul_f32 v101, v101, v97
    v_mul_f32 v102, v102, v98
    v_mul_f32 v103, v103, v99
    v_sub_f32 v100, v100, v27
    v_sub_f32 v101, v101, v27
    v_sub_f32 v102, v102, v27
    v_sub_f32 v103, v103, v27
    v_exp_f32 v100, v100
    v_exp_f32 v101, v101
    v_exp_f32 v102, v102
    v_exp_f32 v103, v103
    v_mul_f32 v96, v96, v100
    v_mul_f32 v97, v97, v101
    v_mul_f32 v98, v98, v102
    v_mul_f32 v99, v99, v103
    v_add_f32 v100, v100, v101
    v_add_f32 v102, v102, v103
    v_add_f32 v100, v100, v102
    v_add_f32 v30, v30, v100
    v_cvt_pk_bf16_f32 v102, v96, v97
    v_cvt_pk_bf16_f32 v103, v98, v99
    v_add_f32 v96, v96, v97
    v_add_f32 v98, v98, v99
    ds_write_b64 v17, v[102:103]
    v_add_f32 v33, v96, v98
    ds_read_b128 v[96:99], v21 offset:128
    ds_read_b128 v[100:103], v21 offset:384
    s_waitcnt lgkmcnt(0)
    v_fma_f32 v100, -v100, v29, v56
    v_fma_f32 v101, -v101, v29, v56
    v_fma_f32 v102, -v102, v29, v56
    v_fma_f32 v103, -v103, v29, v56
    v_add_f32 v100, v100, v72
    v_add_f32 v101, v101, v73
    v_add_f32 v102, v102, v74
    v_add_f32 v103, v103, v75
    v_mul_f32 v100, v100, v96
    v_mul_f32 v101, v101, v97
    v_mul_f32 v102, v102, v98
    v_mul_f32 v103, v103, v99
    v_sub_f32 v100, v100, v27
    v_sub_f32 v101, v101, v27
    v_sub_f32 v102, v102, v27
    v_sub_f32 v103, v103, v27
    v_exp_f32 v100, v100
    v_exp_f32 v101, v101
    v_exp_f32 v102, v102
    v_exp_f32 v103, v103
    v_mul_f32 v96, v96, v100
    v_mul_f32 v97, v97, v101
    v_mul_f32 v98, v98, v102
    v_mul_f32 v99, v99, v103
    v_add_f32 v100, v100, v101
    v_add_f32 v102, v102, v103
    v_add_f32 v100, v100, v102
    v_add_f32 v30, v30, v100
    v_cvt_pk_bf16_f32 v102, v96, v97
    v_cvt_pk_bf16_f32 v103, v98, v99
    v_add_f32 v96, v96, v97
    v_add_f32 v98, v98, v99
    ds_write_b64 v18, v[102:103]
    v_add_f32 v34, v96, v98
    ds_read_b128 v[96:99], v21 offset:192
    ds_read_b128 v[100:103], v21 offset:448
    s_waitcnt lgkmcnt(0)
    v_fma_f32 v100, -v100, v29, v60
    v_fma_f32 v101, -v101, v29, v60
    v_fma_f32 v102, -v102, v29, v60
    v_fma_f32 v103, -v103, v29, v60
    v_add_f32 v100, v100, v76
    v_add_f32 v101, v101, v77
    v_add_f32 v102, v102, v78
    v_add_f32 v103, v103, v79
    v_mul_f32 v100, v100, v96
    v_mul_f32 v101, v101, v97
    v_mul_f32 v102, v102, v98
    v_mul_f32 v103, v103, v99
    v_sub_f32 v100, v100, v27
    v_sub_f32 v101, v101, v27
    v_sub_f32 v102, v102, v27
    v_sub_f32 v103, v103, v27
    v_exp_f32 v100, v100
    v_exp_f32 v101, v101
    v_exp_f32 v102, v102
    v_exp_f32 v103, v103
    v_mul_f32 v96, v96, v100
    v_mul_f32 v97, v97, v101
    v_mul_f32 v98, v98, v102
    v_mul_f32 v99, v99, v103
    v_add_f32 v100, v100, v101
    v_add_f32 v102, v102, v103
    v_add_f32 v100, v100, v102
    v_add_f32 v30, v30, v100
    v_cvt_pk_bf16_f32 v102, v96, v97
    v_cvt_pk_bf16_f32 v103, v98, v99
    v_add_f32 v96, v96, v97
    v_add_f32 v98, v98, v99
    ds_write_b64 v19, v[102:103]
    v_add_f32 v35, v96, v98
    v_cvt_pk_bf16_f32 v32, v32, v33
    v_cvt_pk_bf16_f32 v33, v34, v35
    ds_write_b64 v20, v[32:33]
    s_waitcnt lgkmcnt(0)
    s_nop 3
    s_branch L_back_29
L_fv_30:
    s_nop 7
    v_min_u32 v24, 17, v1
    v_lshlrev_b32 v24, 7, v24
    s_mul_i32 s4, s3, 0x900
    s_add_u32 s4, s4, 0x70000
    buffer_load_dword v26, v24, s[20:23], s4 offen sc1
    s_waitcnt vmcnt(0)
    v_cmp_ne_u32 vcc, s45, v26
    s_nop 0
    s_lshr_b32 s0, vcc_lo, 12
    s_and_b32 s4, vcc_lo, 0xfff
    s_cmp_eq_u32 s0, 0
    s_cbranch_scc1 L_fvb_31
    s_sleep 4
    s_add_u32 s56, s56, 1
    s_cmp_lt_u32 s56, 0x61a80
    s_cbranch_scc1 L_fv_30
    s_branch L_fvb_31
L_rare_32:
    s_waitcnt lgkmcnt(0)
    s_nop 15
    ds_read_b128 v[96:99], v21
    ds_read_b128 v[100:103], v21 offset:256
    s_waitcnt lgkmcnt(0)
    v_fma_f32 v100, -v100, v29, v49
    v_fma_f32 v101, -v101, v29, v49
    v_fma_f32 v102, -v102, v29, v49
    v_fma_f32 v103, -v103, v29, v49
    v_add_f32 v100, v100, v64
    v_add_f32 v101, v101, v65
    v_add_f32 v102, v102, v66
    v_add_f32 v103, v103, v67
    v_mul_f32 v100, v100, v96
    v_mul_f32 v101, v101, v97
    v_mul_f32 v102, v102, v98
    v_mul_f32 v103, v103, v99
    v_max3_f32 v31, v100, v101, v102
    v_max_f32 v31, v31, v103
    ds_read_b128 v[96:99], v21 offset:64
    ds_read_b128 v[100:103], v21 offset:320
    s_waitcnt lgkmcnt(0)
    v_fma_f32 v100, -v100, v29, v53
    v_fma_f32 v101, -v101, v29, v53
    v_fma_f32 v102, -v102, v29, v53
    v_fma_f32 v103, -v103, v29, v53
    v_add_f32 v100, v100, v68
    v_add_f32 v101, v101, v69
    v_add_f32 v102, v102, v70
    v_add_f32 v103, v103, v71
    v_mul_f32 v100, v100, v96
    v_mul_f32 v101, v101, v97
    v_mul_f32 v102, v102, v98
    v_mul_f32 v103, v103, v99
    v_max3_f32 v31, v100, v101, v31
    v_max3_f32 v31, v102, v103, v31
    ds_read_b128 v[96:99], v21 offset:128
    ds_read_b128 v[100:103], v21 offset:384
    s_waitcnt lgkmcnt(0)
    v_fma_f32 v100, -v100, v29, v57
    v_fma_f32 v101, -v101, v29, v57
    v_fma_f32 v102, -v102, v29, v57
    v_fma_f32 v103, -v103, v29, v57
    v_add_f32 v100, v100, v72
    v_add_f32 v101, v101, v73
    v_add_f32 v102, v102, v74
    v_add_f32 v103, v103, v75
    v_mul_f32 v100, v100, v96
    v_mul_f32 v101, v101, v97
    v_mul_f32 v102, v102, v98
    v_mul_f32 v103, v103, v99
    v_max3_f32 v31, v100, v101, v31
    v_max3_f32 v31, v102, v103, v31
    ds_read_b128 v[96:99], v21 offset:192
    ds_read_b128 v[100:103], v21 offset:448
    s_waitcnt lgkmcnt(0)
    v_fma_f32 v100, -v100, v29, v61
    v_fma_f32 v101, -v101, v29, v61
    v_fma_f32 v102, -v102, v29, v61
    v_fma_f32 v103, -v103, v29, v61
    v_add_f32 v100, v100, v76
    v_add_f32 v101, v101, v77
    v_add_f32 v102, v102, v78
    v_add_f32 v103, v103, v79
    v_mul_f32 v100, v100, v96
    v_mul_f32 v101, v101, v97
    v_mul_f32 v102, v102, v98
    v_mul_f32 v103, v103, v99
    v_max3_f32 v31, v100, v101, v31
    v_max3_f32 v31, v102, v103, v31
    v_mov_b32 v26, v31
    s_nop 1
    v_permlane16_swap_b32 v26, v31
    v_max_f32 v31, v31, v26
    v_mov_b32 v26, v31
    s_nop 1
    v_permlane32_swap_b32 v26, v31
    v_max_f32 v31, v31, v26
    v_max_f32 v31, v31, v27
    v_sub_f32 v24, v27, v31
    v_exp_f32 v24, v24
    v_mov_b32 v27, v31
    v_mul_f32 v28, v28, v24
    v_and_b32 v25, 15, v1
    v_lshlrev_b32 v25, 2, v25
    s_lshl_b32 s4, s3, 6
    v_add_u32 v25, s4, v25
    ds_write_b32 v25, v24 offset:61184
    v_mov_b32 v24, 2
    s_lshl_b32 s4, s3, 2
    v_mov_b32 v25, s4
    ds_write_b32 v25, v24 offset:61440
    ds_read_b128 v[96:99], v21
    ds_read_b128 v[100:103], v21 offset:256
    s_waitcnt lgkmcnt(0)
    v_fma_f32 v100, -v100, v29, v49
    v_fma_f32 v101, -v101, v29, v49
    v_fma_f32 v102, -v102, v29, v49
    v_fma_f32 v103, -v103, v29, v49
    v_add_f32 v100, v100, v64
    v_add_f32 v101, v101, v65
    v_add_f32 v102, v102, v66
    v_add_f32 v103, v103, v67
    v_mul_f32 v100, v100, v96
    v_mul_f32 v101, v101, v97
    v_mul_f32 v102, v102, v98
    v_mul_f32 v103, v103, v99
    v_sub_f32 v100, v100, v27
    v_sub_f32 v101, v101, v27
    v_sub_f32 v102, v102, v27
    v_sub_f32 v103, v103, v27
    v_exp_f32 v100, v100
    v_exp_f32 v101, v101
    v_exp_f32 v102, v102
    v_exp_f32 v103, v103
    v_mul_f32 v96, v96, v100
    v_mul_f32 v97, v97, v101
    v_mul_f32 v98, v98, v102
    v_mul_f32 v99, v99, v103
    v_add_f32 v100, v100, v101
    v_add_f32 v102, v102, v103
    v_add_f32 v30, v100, v102
    v_cvt_pk_bf16_f32 v102, v96, v97
    v_cvt_pk_bf16_f32 v103, v98, v99
    v_add_f32 v96, v96, v97
    v_add_f32 v98, v98, v99
    ds_write_b64 v16, v[102:103]
    v_add_f32 v32, v96, v98
    ds_read_b128 v[96:99], v21 offset:64
    ds_read_b128 v[100:103], v21 offset:320
    s_waitcnt lgkmcnt(0)
    v_fma_f32 v100, -v100, v29, v53
    v_fma_f32 v101, -v101, v29, v53
    v_fma_f32 v102, -v102, v29, v53
    v_fma_f32 v103, -v103, v29, v53
    v_add_f32 v100, v100, v68
    v_add_f32 v101, v101, v69
    v_add_f32 v102, v102, v70
    v_add_f32 v103, v103, v71
    v_mul_f32 v100, v100, v96
    v_mul_f32 v101, v101, v97
    v_mul_f32 v102, v102, v98
    v_mul_f32 v103, v103, v99
    v_sub_f32 v100, v100, v27
    v_sub_f32 v101, v101, v27
    v_sub_f32 v102, v102, v27
    v_sub_f32 v103, v103, v27
    v_exp_f32 v100, v100
    v_exp_f32 v101, v101
    v_exp_f32 v102, v102
    v_exp_f32 v103, v103
    v_mul_f32 v96, v96, v100
    v_mul_f32 v97, v97, v101
    v_mul_f32 v98, v98, v102
    v_mul_f32 v99, v99, v103
    v_add_f32 v100, v100, v101
    v_add_f32 v102, v102, v103
    v_add_f32 v100, v100, v102
    v_add_f32 v30, v30, v100
    v_cvt_pk_bf16_f32 v102, v96, v97
    v_cvt_pk_bf16_f32 v103, v98, v99
    v_add_f32 v96, v96, v97
    v_add_f32 v98, v98, v99
    ds_write_b64 v17, v[102:103]
    v_add_f32 v33, v96, v98
    ds_read_b128 v[96:99], v21 offset:128
    ds_read_b128 v[100:103], v21 offset:384
    s_waitcnt lgkmcnt(0)
    v_fma_f32 v100, -v100, v29, v57
    v_fma_f32 v101, -v101, v29, v57
    v_fma_f32 v102, -v102, v29, v57
    v_fma_f32 v103, -v103, v29, v57
    v_add_f32 v100, v100, v72
    v_add_f32 v101, v101, v73
    v_add_f32 v102, v102, v74
    v_add_f32 v103, v103, v75
    v_mul_f32 v100, v100, v96
    v_mul_f32 v101, v101, v97
    v_mul_f32 v102, v102, v98
    v_mul_f32 v103, v103, v99
    v_sub_f32 v100, v100, v27
    v_sub_f32 v101, v101, v27
    v_sub_f32 v102, v102, v27
    v_sub_f32 v103, v103, v27
    v_exp_f32 v100, v100
    v_exp_f32 v101, v101
    v_exp_f32 v102, v102
    v_exp_f32 v103, v103
    v_mul_f32 v96, v96, v100
    v_mul_f32 v97, v97, v101
    v_mul_f32 v98, v98, v102
    v_mul_f32 v99, v99, v103
    v_add_f32 v100, v100, v101
    v_add_f32 v102, v102, v103
    v_add_f32 v100, v100, v102
    v_add_f32 v30, v30, v100
    v_cvt_pk_bf16_f32 v102, v96, v97
    v_cvt_pk_bf16_f32 v103, v98, v99
    v_add_f32 v96, v96, v97
    v_add_f32 v98, v98, v99
    ds_write_b64 v18, v[102:103]
    v_add_f32 v34, v96, v98
    ds_read_b128 v[96:99], v21 offset:192
    ds_read_b128 v[100:103], v21 offset:448
    s_waitcnt lgkmcnt(0)
    v_fma_f32 v100, -v100, v29, v61
    v_fma_f32 v101, -v101, v29, v61
    v_fma_f32 v102, -v102, v29, v61
    v_fma_f32 v103, -v103, v29, v61
    v_add_f32 v100, v100, v76
    v_add_f32 v101, v101, v77
    v_add_f32 v102, v102, v78
    v_add_f32 v103, v103, v79
    v_mul_f32 v100, v100, v96
    v_mul_f32 v101, v101, v97
    v_mul_f32 v102, v102, v98
    v_mul_f32 v103, v103, v99
    v_sub_f32 v100, v100, v27
    v_sub_f32 v101, v101, v27
    v_sub_f32 v102, v102, v27
    v_sub_f32 v103, v103, v27
    v_exp_f32 v100, v100
    v_exp_f32 v101, v101
    v_exp_f32 v102, v102
    v_exp_f32 v103, v103
    v_mul_f32 v96, v96, v100
    v_mul_f32 v97, v97, v101
    v_mul_f32 v98, v98, v102
    v_mul_f32 v99, v99, v103
    v_add_f32 v100, v100, v101
    v_add_f32 v102, v102, v103
    v_add_f32 v100, v100, v102
    v_add_f32 v30, v30, v100
    v_cvt_pk_bf16_f32 v102, v96, v97
    v_cvt_pk_bf16_f32 v103, v98, v99
    v_add_f32 v96, v96, v97
    v_add_f32 v98, v98, v99
    ds_write_b64 v19, v[102:103]
    v_add_f32 v35, v96, v98
    v_cvt_pk_bf16_f32 v32, v32, v33
    v_cvt_pk_bf16_f32 v33, v34, v35
    ds_write_b64 v20, v[32:33]
    s_waitcnt lgkmcnt(0)
    s_nop 3
    s_branch L_back_33
L_rare_34:
    s_waitcnt lgkmcnt(0)
    s_nop 15
    ds_read_b128 v[96:99], v21
    ds_read_b128 v[100:103], v21 offset:256
    s_waitcnt lgkmcnt(0)
    v_fma_f32 v100, -v100, v29, v50
    v_fma_f32 v101, -v101, v29, v50
    v_fma_f32 v102, -v102, v29, v50
    v_fma_f32 v103, -v103, v29, v50
    v_add_f32 v100, v100, v64
    v_add_f32 v101, v101, v65
    v_add_f32 v102, v102, v66
    v_add_f32 v103, v103, v67
    v_mul_f32 v100, v100, v96
    v_mul_f32 v101, v101, v97
    v_mul_f32 v102, v102, v98
    v_mul_f32 v103, v103, v99
    v_max3_f32 v31, v100, v101, v102
    v_max_f32 v31, v31, v103
    ds_read_b128 v[96:99], v21 offset:64
    ds_read_b128 v[100:103], v21 offset:320
    s_waitcnt lgkmcnt(0)
    v_fma_f32 v100, -v100, v29, v54
    v_fma_f32 v101, -v101, v29, v54
    v_fma_f32 v102, -v102, v29, v54
    v_fma_f32 v103, -v103, v29, v54
    v_add_f32 v100, v100, v68
    v_add_f32 v101, v101, v69
    v_add_f32 v102, v102, v70
    v_add_f32 v103, v103, v71
    v_mul_f32 v100, v100, v96
    v_mul_f32 v101, v101, v97
    v_mul_f32 v102, v102, v98
    v_mul_f32 v103, v103, v99
    v_max3_f32 v31, v100, v101, v31
    v_max3_f32 v31, v102, v103, v31
    ds_read_b128 v[96:99], v21 offset:128
    ds_read_b128 v[100:103], v21 offset:384
    s_waitcnt lgkmcnt(0)
    v_fma_f32 v100, -v100, v29, v58
    v_fma_f32 v101, -v101, v29, v58
    v_fma_f32 v102, -v102, v29, v58
    v_fma_f32 v103, -v103, v29, v58
    v_add_f32 v100, v100, v72
    v_add_f32 v101, v101, v73
    v_add_f32 v102, v102, v74
    v_add_f32 v103, v103, v75
    v_mul_f32 v100, v100, v96
    v_mul_f32 v101, v101, v97
    v_mul_f32 v102, v102, v98
    v_mul_f32 v103, v103, v99
    v_max3_f32 v31, v100, v101, v31
    v_max3_f32 v31, v102, v103, v31
    ds_read_b128 v[96:99], v21 offset:192
    ds_read_b128 v[100:103], v21 offset:448
    s_waitcnt lgkmcnt(0)
    v_fma_f32 v100, -v100, v29, v62
    v_fma_f32 v101, -v101, v29, v62
    v_fma_f32 v102, -v102, v29, v62
    v_fma_f32 v103, -v103, v29, v62
    v_add_f32 v100, v100, v76
    v_add_f32 v101, v101, v77
    v_add_f32 v102, v102, v78
    v_add_f32 v103, v103, v79
    v_mul_f32 v100, v100, v96
    v_mul_f32 v101, v101, v97
    v_mul_f32 v102, v102, v98
    v_mul_f32 v103, v103, v99
    v_max3_f32 v31, v100, v101, v31
    v_max3_f32 v31, v102, v103, v31
    v_mov_b32 v26, v31
    s_nop 1
    v_permlane16_swap_b32 v26, v31
    v_max_f32 v31, v31, v26
    v_mov_b32 v26, v31
    s_nop 1
    v_permlane32_swap_b32 v26, v31
    v_max_f32 v31, v31, v26
    v_max_f32 v31, v31, v27
    v_sub_f32 v24, v27, v31
    v_exp_f32 v24, v24
    v_mov_b32 v27, v31
    v_mul_f32 v28, v28, v24
    v_and_b32 v25, 15, v1
    v_lshlrev_b32 v25, 2, v25
    s_lshl_b32 s4, s3, 6
    v_add_u32 v25, s4, v25
    ds_write_b32 v25, v24 offset:61184
    v_mov_b32 v24, 3
    s_lshl_b32 s4, s3, 2
    v_mov_b32 v25, s4
    ds_write_b32 v25, v24 offset:61440
    ds_read_b128 v[96:99], v21
    ds_read_b128 v[100:103], v21 offset:256
    s_waitcnt lgkmcnt(0)
    v_fma_f32 v100, -v100, v29, v50
    v_fma_f32 v101, -v101, v29, v50
    v_fma_f32 v102, -v102, v29, v50
    v_fma_f32 v103, -v103, v29, v50
    v_add_f32 v100, v100, v64
    v_add_f32 v101, v101, v65
    v_add_f32 v102, v102, v66
    v_add_f32 v103, v103, v67
    v_mul_f32 v100, v100, v96
    v_mul_f32 v101, v101, v97
    v_mul_f32 v102, v102, v98
    v_mul_f32 v103, v103, v99
    v_sub_f32 v100, v100, v27
    v_sub_f32 v101, v101, v27
    v_sub_f32 v102, v102, v27
    v_sub_f32 v103, v103, v27
    v_exp_f32 v100, v100
    v_exp_f32 v101, v101
    v_exp_f32 v102, v102
    v_exp_f32 v103, v103
    v_mul_f32 v96, v96, v100
    v_mul_f32 v97, v97, v101
    v_mul_f32 v98, v98, v102
    v_mul_f32 v99, v99, v103
    v_add_f32 v100, v100, v101
    v_add_f32 v102, v102, v103
    v_add_f32 v30, v100, v102
    v_cvt_pk_bf16_f32 v102, v96, v97
    v_cvt_pk_bf16_f32 v103, v98, v99
    v_add_f32 v96, v96, v97
    v_add_f32 v98, v98, v99
    ds_write_b64 v16, v[102:103]
    v_add_f32 v32, v96, v98
    ds_read_b128 v[96:99], v21 offset:64
    ds_read_b128 v[100:103], v21 offset:320
    s_waitcnt lgkmcnt(0)
    v_fma_f32 v100, -v100, v29, v54
    v_fma_f32 v101, -v101, v29, v54
    v_fma_f32 v102, -v102, v29, v54
    v_fma_f32 v103, -v103, v29, v54
    v_add_f32 v100, v100, v68
    v_add_f32 v101, v101, v69
    v_add_f32 v102, v102, v70
    v_add_f32 v103, v103, v71
    v_mul_f32 v100, v100, v96
    v_mul_f32 v101, v101, v97
    v_mul_f32 v102, v102, v98
    v_mul_f32 v103, v103, v99
    v_sub_f32 v100, v100, v27
    v_sub_f32 v101, v101, v27
    v_sub_f32 v102, v102, v27
    v_sub_f32 v103, v103, v27
    v_exp_f32 v100, v100
    v_exp_f32 v101, v101
    v_exp_f32 v102, v102
    v_exp_f32 v103, v103
    v_mul_f32 v96, v96, v100
    v_mul_f32 v97, v97, v101
    v_mul_f32 v98, v98, v102
    v_mul_f32 v99, v99, v103
    v_add_f32 v100, v100, v101
    v_add_f32 v102, v102, v103
    v_add_f32 v100, v100, v102
    v_add_f32 v30, v30, v100
    v_cvt_pk_bf16_f32 v102, v96, v97
    v_cvt_pk_bf16_f32 v103, v98, v99
    v_add_f32 v96, v96, v97
    v_add_f32 v98, v98, v99
    ds_write_b64 v17, v[102:103]
    v_add_f32 v33, v96, v98
    ds_read_b128 v[96:99], v21 offset:128
    ds_read_b128 v[100:103], v21 offset:384
    s_waitcnt lgkmcnt(0)
    v_fma_f32 v100, -v100, v29, v58
    v_fma_f32 v101, -v101, v29, v58
    v_fma_f32 v102, -v102, v29, v58
    v_fma_f32 v103, -v103, v29, v58
    v_add_f32 v100, v100, v72
    v_add_f32 v101, v101, v73
    v_add_f32 v102, v102, v74
    v_add_f32 v103, v103, v75
    v_mul_f32 v100, v100, v96
    v_mul_f32 v101, v101, v97
    v_mul_f32 v102, v102, v98
    v_mul_f32 v103, v103, v99
    v_sub_f32 v100, v100, v27
    v_sub_f32 v101, v101, v27
    v_sub_f32 v102, v102, v27
    v_sub_f32 v103, v103, v27
    v_exp_f32 v100, v100
    v_exp_f32 v101, v101
    v_exp_f32 v102, v102
    v_exp_f32 v103, v103
    v_mul_f32 v96, v96, v100
    v_mul_f32 v97, v97, v101
    v_mul_f32 v98, v98, v102
    v_mul_f32 v99, v99, v103
    v_add_f32 v100, v100, v101
    v_add_f32 v102, v102, v103
    v_add_f32 v100, v100, v102
    v_add_f32 v30, v30, v100
    v_cvt_pk_bf16_f32 v102, v96, v97
    v_cvt_pk_bf16_f32 v103, v98, v99
    v_add_f32 v96, v96, v97
    v_add_f32 v98, v98, v99
    ds_write_b64 v18, v[102:103]
    v_add_f32 v34, v96, v98
    ds_read_b128 v[96:99], v21 offset:192
    ds_read_b128 v[100:103], v21 offset:448
    s_waitcnt lgkmcnt(0)
    v_fma_f32 v100, -v100, v29, v62
    v_fma_f32 v101, -v101, v29, v62
    v_fma_f32 v102, -v102, v29, v62
    v_fma_f32 v103, -v103, v29, v62
    v_add_f32 v100, v100, v76
    v_add_f32 v101, v101, v77
    v_add_f32 v102, v102, v78
    v_add_f32 v103, v103, v79
    v_mul_f32 v100, v100, v96
    v_mul_f32 v101, v101, v97
    v_mul_f32 v102, v102, v98
    v_mul_f32 v103, v103, v99
    v_sub_f32 v100, v100, v27
    v_sub_f32 v101, v101, v27
    v_sub_f32 v102, v102, v27
    v_sub_f32 v103, v103, v27
    v_exp_f32 v100, v100
    v_exp_f32 v101, v101
    v_exp_f32 v102, v102
    v_exp_f32 v103, v103
    v_mul_f32 v96, v96, v100
    v_mul_f32 v97, v97, v101
    v_mul_f32 v98, v98, v102
    v_mul_f32 v99, v99, v103
    v_add_f32 v100, v100, v101
    v_add_f32 v102, v102, v103
    v_add_f32 v100, v100, v102
    v_add_f32 v30, v30, v100
    v_cvt_pk_bf16_f32 v102, v96, v97
    v_cvt_pk_bf16_f32 v103, v98, v99
    v_add_f32 v96, v96, v97
    v_add_f32 v98, v98, v99
    ds_write_b64 v19, v[102:103]
    v_add_f32 v35, v96, v98
    v_cvt_pk_bf16_f32 v32, v32, v33
    v_cvt_pk_bf16_f32 v33, v34, v35
    ds_write_b64 v20, v[32:33]
    s_waitcnt lgkmcnt(0)
    s_nop 3
    s_branch L_back_35
L_rare_36:
    s_waitcnt lgkmcnt(0)
    s_nop 15
    ds_read_b128 v[96:99], v21
    ds_read_b128 v[100:103], v21 offset:256
    s_waitcnt lgkmcnt(0)
    v_fma_f32 v100, -v100, v29, v51
    v_fma_f32 v101, -v101, v29, v51
    v_fma_f32 v102, -v102, v29, v51
    v_fma_f32 v103, -v103, v29, v51
    v_add_f32 v100, v100, v64
    v_add_f32 v101, v101, v65
    v_add_f32 v102, v102, v66
    v_add_f32 v103, v103, v67
    v_mul_f32 v100, v100, v96
    v_mul_f32 v101, v101, v97
    v_mul_f32 v102, v102, v98
    v_mul_f32 v103, v103, v99
    v_max3_f32 v31, v100, v101, v102
    v_max_f32 v31, v31, v103
    ds_read_b128 v[96:99], v21 offset:64
    ds_read_b128 v[100:103], v21 offset:320
    s_waitcnt lgkmcnt(0)
    v_fma_f32 v100, -v100, v29, v55
    v_fma_f32 v101, -v101, v29, v55
    v_fma_f32 v102, -v102, v29, v55
    v_fma_f32 v103, -v103, v29, v55
    v_add_f32 v100, v100, v68
    v_add_f32 v101, v101, v69
    v_add_f32 v102, v102, v70
    v_add_f32 v103, v103, v71
    v_mul_f32 v100, v100, v96
    v_mul_f32 v101, v101, v97
    v_mul_f32 v102, v102, v98
    v_mul_f32 v103, v103, v99
    v_max3_f32 v31, v100, v101, v31
    v_max3_f32 v31, v102, v103, v31
    ds_read_b128 v[96:99], v21 offset:128
    ds_read_b128 v[100:103], v21 offset:384
    s_waitcnt lgkmcnt(0)
    v_fma_f32 v100, -v100, v29, v59
    v_fma_f32 v101, -v101, v29, v59
    v_fma_f32 v102, -v102, v29, v59
    v_fma_f32 v103, -v103, v29, v59
    v_add_f32 v100, v100, v72
    v_add_f32 v101, v101, v73
    v_add_f32 v102, v102, v74
    v_add_f32 v103, v103, v75
    v_mul_f32 v100, v100, v96
    v_mul_f32 v101, v101, v97
    v_mul_f32 v102, v102, v98
    v_mul_f32 v103, v103, v99
    v_max3_f32 v31, v100, v101, v31
    v_max3_f32 v31, v102, v103, v31
    ds_read_b128 v[96:99], v21 offset:192
    ds_read_b128 v[100:103], v21 offset:448
    s_waitcnt lgkmcnt(0)
    v_fma_f32 v100, -v100, v29, v63
    v_fma_f32 v101, -v101, v29, v63
    v_fma_f32 v102, -v102, v29, v63
    v_fma_f32 v103, -v103, v29, v63
    v_add_f32 v100, v100, v76
    v_add_f32 v101, v101, v77
    v_add_f32 v102, v102, v78
    v_add_f32 v103, v103, v79
    v_mul_f32 v100, v100, v96
    v_mul_f32 v101, v101, v97
    v_mul_f32 v102, v102, v98
    v_mul_f32 v103, v103, v99
    v_max3_f32 v31, v100, v101, v31
    v_max3_f32 v31, v102, v103, v31
    v_mov_b32 v26, v31
    s_nop 1
    v_permlane16_swap_b32 v26, v31
    v_max_f32 v31, v31, v26
    v_mov_b32 v26, v31
    s_nop 1
    v_permlane32_swap_b32 v26, v31
    v_max_f32 v31, v31, v26
    v_max_f32 v31, v31, v27
    v_sub_f32 v24, v27, v31
    v_exp_f32 v24, v24
    v_mov_b32 v27, v31
    v_mul_f32 v28, v28, v24
    v_and_b32 v25, 15, v1
    v_lshlrev_b32 v25, 2, v25
    s_lshl_b32 s4, s3, 6
    v_add_u32 v25, s4, v25
    ds_write_b32 v25, v24 offset:61184
    v_mov_b32 v24, 4
    s_lshl_b32 s4, s3, 2
    v_mov_b32 v25, s4
    ds_write_b32 v25, v24 offset:61440
    ds_read_b128 v[96:99], v21
    ds_read_b128 v[100:103], v21 offset:256
    s_waitcnt lgkmcnt(0)
    v_fma_f32 v100, -v100, v29, v51
    v_fma_f32 v101, -v101, v29, v51
    v_fma_f32 v102, -v102, v29, v51
    v_fma_f32 v103, -v103, v29, v51
    v_add_f32 v100, v100, v64
    v_add_f32 v101, v101, v65
    v_add_f32 v102, v102, v66
    v_add_f32 v103, v103, v67
    v_mul_f32 v100, v100, v96
    v_mul_f32 v101, v101, v97
    v_mul_f32 v102, v102, v98
    v_mul_f32 v103, v103, v99
    v_sub_f32 v100, v100, v27
    v_sub_f32 v101, v101, v27
    v_sub_f32 v102, v102, v27
    v_sub_f32 v103, v103, v27
    v_exp_f32 v100, v100
    v_exp_f32 v101, v101
    v_exp_f32 v102, v102
    v_exp_f32 v103, v103
    v_mul_f32 v96, v96, v100
    v_mul_f32 v97, v97, v101
    v_mul_f32 v98, v98, v102
    v_mul_f32 v99, v99, v103
    v_add_f32 v100, v100, v101
    v_add_f32 v102, v102, v103
    v_add_f32 v30, v100, v102
    v_cvt_pk_bf16_f32 v102, v96, v97
    v_cvt_pk_bf16_f32 v103, v98, v99
    v_add_f32 v96, v96, v97
    v_add_f32 v98, v98, v99
    ds_write_b64 v16, v[102:103]
    v_add_f32 v32, v96, v98
    ds_read_b128 v[96:99], v21 offset:64
    ds_read_b128 v[100:103], v21 offset:320
    s_waitcnt lgkmcnt(0)
    v_fma_f32 v100, -v100, v29, v55
    v_fma_f32 v101, -v101, v29, v55
    v_fma_f32 v102, -v102, v29, v55
    v_fma_f32 v103, -v103, v29, v55
    v_add_f32 v100, v100, v68
    v_add_f32 v101, v101, v69
    v_add_f32 v102, v102, v70
    v_add_f32 v103, v103, v71
    v_mul_f32 v100, v100, v96
    v_mul_f32 v101, v101, v97
    v_mul_f32 v102, v102, v98
    v_mul_f32 v103, v103, v99
    v_sub_f32 v100, v100, v27
    v_sub_f32 v101, v101, v27
    v_sub_f32 v102, v102, v27
    v_sub_f32 v103, v103, v27
    v_exp_f32 v100, v100
    v_exp_f32 v101, v101
    v_exp_f32 v102, v102
    v_exp_f32 v103, v103
    v_mul_f32 v96, v96, v100
    v_mul_f32 v97, v97, v101
    v_mul_f32 v98, v98, v102
    v_mul_f32 v99, v99, v103
    v_add_f32 v100, v100, v101
    v_add_f32 v102, v102, v103
    v_add_f32 v100, v100, v102
    v_add_f32 v30, v30, v100
    v_cvt_pk_bf16_f32 v102, v96, v97
    v_cvt_pk_bf16_f32 v103, v98, v99
    v_add_f32 v96, v96, v97
    v_add_f32 v98, v98, v99
    ds_write_b64 v17, v[102:103]
    v_add_f32 v33, v96, v98
    ds_read_b128 v[96:99], v21 offset:128
    ds_read_b128 v[100:103], v21 offset:384
    s_waitcnt lgkmcnt(0)
    v_fma_f32 v100, -v100, v29, v59
    v_fma_f32 v101, -v101, v29, v59
    v_fma_f32 v102, -v102, v29, v59
    v_fma_f32 v103, -v103, v29, v59
    v_add_f32 v100, v100, v72
    v_add_f32 v101, v101, v73
    v_add_f32 v102, v102, v74
    v_add_f32 v103, v103, v75
    v_mul_f32 v100, v100, v96
    v_mul_f32 v101, v101, v97
    v_mul_f32 v102, v102, v98
    v_mul_f32 v103, v103, v99
    v_sub_f32 v100, v100, v27
    v_sub_f32 v101, v101, v27
    v_sub_f32 v102, v102, v27
    v_sub_f32 v103, v103, v27
    v_exp_f32 v100, v100
    v_exp_f32 v101, v101
    v_exp_f32 v102, v102
    v_exp_f32 v103, v103
    v_mul_f32 v96, v96, v100
    v_mul_f32 v97, v97, v101
    v_mul_f32 v98, v98, v102
    v_mul_f32 v99, v99, v103
    v_add_f32 v100, v100, v101
    v_add_f32 v102, v102, v103
    v_add_f32 v100, v100, v102
    v_add_f32 v30, v30, v100
    v_cvt_pk_bf16_f32 v102, v96, v97
    v_cvt_pk_bf16_f32 v103, v98, v99
    v_add_f32 v96, v96, v97
    v_add_f32 v98, v98, v99
    ds_write_b64 v18, v[102:103]
    v_add_f32 v34, v96, v98
    ds_read_b128 v[96:99], v21 offset:192
    ds_read_b128 v[100:103], v21 offset:448
    s_waitcnt lgkmcnt(0)
    v_fma_f32 v100, -v100, v29, v63
    v_fma_f32 v101, -v101, v29, v63
    v_fma_f32 v102, -v102, v29, v63
    v_fma_f32 v103, -v103, v29, v63
    v_add_f32 v100, v100, v76
    v_add_f32 v101, v101, v77
    v_add_f32 v102, v102, v78
    v_add_f32 v103, v103, v79
    v_mul_f32 v100, v100, v96
    v_mul_f32 v101, v101, v97
    v_mul_f32 v102, v102, v98
    v_mul_f32 v103, v103, v99
    v_sub_f32 v100, v100, v27
    v_sub_f32 v101, v101, v27
    v_sub_f32 v102, v102, v27
    v_sub_f32 v103, v103, v27
    v_exp_f32 v100, v100
    v_exp_f32 v101, v101
    v_exp_f32 v102, v102
    v_exp_f32 v103, v103
    v_mul_f32 v96, v96, v100
    v_mul_f32 v97, v97, v101
    v_mul_f32 v98, v98, v102
    v_mul_f32 v99, v99, v103
    v_add_f32 v100, v100, v101
    v_add_f32 v102, v102, v103
    v_add_f32 v100, v100, v102
    v_add_f32 v30, v30, v100
    v_cvt_pk_bf16_f32 v102, v96, v97
    v_cvt_pk_bf16_f32 v103, v98, v99
    v_add_f32 v96, v96, v97
    v_add_f32 v98, v98, v99
    ds_write_b64 v19, v[102:103]
    v_add_f32 v35, v96, v98
    v_cvt_pk_bf16_f32 v32, v32, v33
    v_cvt_pk_bf16_f32 v33, v34, v35
    ds_write_b64 v20, v[32:33]
    s_waitcnt lgkmcnt(0)
    s_nop 3
    s_branch L_back_37
L_es_47:
    s_sleep 4
    v_mov_b32 v199, 0
    buffer_load_dword v199, v199, s[24:27], 0 offen sc1
    s_waitcnt vmcnt(0)
    v_readfirstlane_b32 s44, v199
    s_nop 0
    s_cmp_lg_u32 s44, 0
    s_cbranch_scc1 L_eb_48
    s_add_u32 s56, s56, 1
    s_cmp_lt_u32 s56, 0x61a80
    s_cbranch_scc1 L_es_47
    s_branch L_eb_48
L_es_50:
    s_sleep 4
    v_mov_b32 v22, 0
    buffer_load_dword v22, v22, s[24:27], 0 offen sc1
    s_waitcnt vmcnt(0)
    v_readfirstlane_b32 s44, v22
    s_nop 0
    s_cmp_lg_u32 s44, 0
    s_cbranch_scc1 L_eb_51
    s_add_u32 s56, s56, 1
    s_cmp_lt_u32 s56, 0x61a80
    s_cbranch_scc1 L_es_50
    s_branch L_eb_51
L_resc_52:
    s_waitcnt lgkmcnt(0)
    s_nop 15
    v_and_b32 v24, 31, v1
    v_lshlrev_b32 v24, 2, v24
    v_bfe_u32 v25, v1, 4, 1
    v_lshlrev_b32 v25, 2, v25
    ds_read_b32 v26, v24 offset:61184
    ds_read_b32 v21, v25 offset:61440
    s_waitcnt lgkmcnt(0)
    v_cmp_eq_u32 vcc, 2, v21
    s_nop 1
    v_cndmask_b32 v26, 1.0, v26, vcc
    v_mul_f32 v160, v160, v26
    v_mul_f32 v161, v161, v26
    v_mul_f32 v162, v162, v26
    v_mul_f32 v163, v163, v26
    v_mul_f32 v164, v164, v26
    v_mul_f32 v165, v165, v26
    v_mul_f32 v166, v166, v26
    v_mul_f32 v167, v167, v26
    v_mul_f32 v168, v168, v26
    v_mul_f32 v169, v169, v26
    v_mul_f32 v170, v170, v26
    v_mul_f32 v171, v171, v26
    v_mul_f32 v172, v172, v26
    v_mul_f32 v173, v173, v26
    v_mul_f32 v174, v174, v26
    v_mul_f32 v175, v175, v26
    v_mul_f32 v192, v192, v26
    v_mul_f32 v193, v193, v26
    v_mul_f32 v194, v194, v26
    v_mul_f32 v195, v195, v26
    v_mul_f32 v196, v196, v26
    v_mul_f32 v197, v197, v26
    v_mul_f32 v198, v198, v26
    v_mul_f32 v199, v199, v26
    v_mul_f32 v200, v200, v26
    v_mul_f32 v201, v201, v26
    v_mul_f32 v202, v202, v26
    v_mul_f32 v203, v203, v26
    v_mul_f32 v204, v204, v26
    v_mul_f32 v205, v205, v26
    v_mul_f32 v206, v206, v26
    v_mul_f32 v207, v207, v26
    v_mul_f32 v224, v224, v26
    v_mul_f32 v225, v225, v26
    v_mul_f32 v226, v226, v26
    v_mul_f32 v227, v227, v26
    v_mul_f32 v228, v228, v26
    v_mul_f32 v229, v229, v26
    v_mul_f32 v230, v230, v26
    v_mul_f32 v231, v231, v26
    v_mul_f32 v232, v232, v26
    v_mul_f32 v233, v233, v26
    v_mul_f32 v234, v234, v26
    v_mul_f32 v235, v235, v26
    v_mul_f32 v236, v236, v26
    v_mul_f32 v237, v237, v26
    v_mul_f32 v238, v238, v26
    v_mul_f32 v239, v239, v26
    ds_read_b32 v26, v24 offset:61312
    ds_read_b32 v21, v25 offset:61448
    s_waitcnt lgkmcnt(0)
    v_cmp_eq_u32 vcc, 2, v21
    s_nop 1
    v_cndmask_b32 v26, 1.0, v26, vcc
    v_mul_f32 v176, v176, v26
    v_mul_f32 v177, v177, v26
    v_mul_f32 v178, v178, v26
    v_mul_f32 v179, v179, v26
    v_mul_f32 v180, v180, v26
    v_mul_f32 v181, v181, v26
    v_mul_f32 v182, v182, v26
    v_mul_f32 v183, v183, v26
    v_mul_f32 v184, v184, v26
    v_mul_f32 v185, v185, v26
    v_mul_f32 v186, v186, v26
    v_mul_f32 v187, v187, v26
    v_mul_f32 v188, v188, v26
    v_mul_f32 v189, v189, v26
    v_mul_f32 v190, v190, v26
    v_mul_f32 v191, v191, v26
    v_mul_f32 v208, v208, v26
    v_mul_f32 v209, v209, v26
    v_mul_f32 v210, v210, v26
    v_mul_f32 v211, v211, v26
    v_mul_f32 v212, v212, v26
    v_mul_f32 v213, v213, v26
    v_mul_f32 v214, v214, v26
    v_mul_f32 v215, v215, v26
    v_mul_f32 v216, v216, v26
    v_mul_f32 v217, v217, v26
    v_mul_f32 v218, v218, v26
    v_mul_f32 v219, v219, v26
    v_mul_f32 v220, v220, v26
    v_mul_f32 v221, v221, v26
    v_mul_f32 v222, v222, v26
    v_mul_f32 v223, v223, v26
    v_mul_f32 v240, v240, v26
    v_mul_f32 v241, v241, v26
    v_mul_f32 v242, v242, v26
    v_mul_f32 v243, v243, v26
    v_mul_f32 v244, v244, v26
    v_mul_f32 v245, v245, v26
    v_mul_f32 v246, v246, v26
    v_mul_f32 v247, v247, v26
    v_mul_f32 v248, v248, v26
    v_mul_f32 v249, v249, v26
    v_mul_f32 v250, v250, v26
    v_mul_f32 v251, v251, v26
    v_mul_f32 v252, v252, v26
    v_mul_f32 v253, v253, v26
    v_mul_f32 v254, v254, v26
    v_mul_f32 v255, v255, v26
    s_nop 3
    s_branch L_rback_53
L_resc_54:
    s_waitcnt lgkmcnt(0)
    s_nop 15
    v_and_b32 v24, 31, v1
    v_lshlrev_b32 v24, 2, v24
    v_bfe_u32 v25, v1, 4, 1
    v_lshlrev_b32 v25, 2, v25
    ds_read_b32 v26, v24 offset:61184
    ds_read_b32 v21, v25 offset:61440
    s_waitcnt lgkmcnt(0)
    v_cmp_eq_u32 vcc, 3, v21
    s_nop 1
    v_cndmask_b32 v26, 1.0, v26, vcc
    v_mul_f32 v160, v160, v26
    v_mul_f32 v161, v161, v26
    v_mul_f32 v162, v162, v26
    v_mul_f32 v163, v163, v26
    v_mul_f32 v164, v164, v26
    v_mul_f32 v165, v165, v26
    v_mul_f32 v166, v166, v26
    v_mul_f32 v167, v167, v26
    v_mul_f32 v168, v168, v26
    v_mul_f32 v169, v169, v26
    v_mul_f32 v170, v170, v26
    v_mul_f32 v171, v171, v26
    v_mul_f32 v172, v172, v26
    v_mul_f32 v173, v173, v26
    v_mul_f32 v174, v174, v26
    v_mul_f32 v175, v175, v26
    v_mul_f32 v192, v192, v26
    v_mul_f32 v193, v193, v26
    v_mul_f32 v194, v194, v26
    v_mul_f32 v195, v195, v26
    v_mul_f32 v196, v196, v26
    v_mul_f32 v197, v197, v26
    v_mul_f32 v198, v198, v26
    v_mul_f32 v199, v199, v26
    v_mul_f32 v200, v200, v26
    v_mul_f32 v201, v201, v26
    v_mul_f32 v202, v202, v26
    v_mul_f32 v203, v203, v26
    v_mul_f32 v204, v204, v26
    v_mul_f32 v205, v205, v26
    v_mul_f32 v206, v206, v26
    v_mul_f32 v207, v207, v26
    v_mul_f32 v224, v224, v26
    v_mul_f32 v225, v225, v26
    v_mul_f32 v226, v226, v26
    v_mul_f32 v227, v227, v26
    v_mul_f32 v228, v228, v26
    v_mul_f32 v229, v229, v26
    v_mul_f32 v230, v230, v26
    v_mul_f32 v231, v231, v26
    v_mul_f32 v232, v232, v26
    v_mul_f32 v233, v233, v26
    v_mul_f32 v234, v234, v26
    v_mul_f32 v235, v235, v26
    v_mul_f32 v236, v236, v26
    v_mul_f32 v237, v237, v26
    v_mul_f32 v238, v238, v26
    v_mul_f32 v239, v239, v26
    ds_read_b32 v26, v24 offset:61312
    ds_read_b32 v21, v25 offset:61448
    s_waitcnt lgkmcnt(0)
    v_cmp_eq_u32 vcc, 3, v21
    s_nop 1
    v_cndmask_b32 v26, 1.0, v26, vcc
    v_mul_f32 v176, v176, v26
    v_mul_f32 v177, v177, v26
    v_mul_f32 v178, v178, v26
    v_mul_f32 v179, v179, v26
    v_mul_f32 v180, v180, v26
    v_mul_f32 v181, v181, v26
    v_mul_f32 v182, v182, v26
    v_mul_f32 v183, v183, v26
    v_mul_f32 v184, v184, v26
    v_mul_f32 v185, v185, v26
    v_mul_f32 v186, v186, v26
    v_mul_f32 v187, v187, v26
    v_mul_f32 v188, v188, v26
    v_mul_f32 v189, v189, v26
    v_mul_f32 v190, v190, v26
    v_mul_f32 v191, v191, v26
    v_mul_f32 v208, v208, v26
    v_mul_f32 v209, v209, v26
    v_mul_f32 v210, v210, v26
    v_mul_f32 v211, v211, v26
    v_mul_f32 v212, v212, v26
    v_mul_f32 v213, v213, v26
    v_mul_f32 v214, v214, v26
    v_mul_f32 v215, v215, v26
    v_mul_f32 v216, v216, v26
    v_mul_f32 v217, v217, v26
    v_mul_f32 v218, v218, v26
    v_mul_f32 v219, v219, v26
    v_mul_f32 v220, v220, v26
    v_mul_f32 v221, v221, v26
    v_mul_f32 v222, v222, v26
    v_mul_f32 v223, v223, v26
    v_mul_f32 v240, v240, v26
    v_mul_f32 v241, v241, v26
    v_mul_f32 v242, v242, v26
    v_mul_f32 v243, v243, v26
    v_mul_f32 v244, v244, v26
    v_mul_f32 v245, v245, v26
    v_mul_f32 v246, v246, v26
    v_mul_f32 v247, v247, v26
    v_mul_f32 v248, v248, v26
    v_mul_f32 v249, v249, v26
    v_mul_f32 v250, v250, v26
    v_mul_f32 v251, v251, v26
    v_mul_f32 v252, v252, v26
    v_mul_f32 v253, v253, v26
    v_mul_f32 v254, v254, v26
    v_mul_f32 v255, v255, v26
    s_nop 3
    s_branch L_rback_55
L_resc_56:
    s_waitcnt lgkmcnt(0)
    s_nop 15
    v_and_b32 v24, 31, v1
    v_lshlrev_b32 v24, 2, v24
    v_bfe_u32 v25, v1, 4, 1
    v_lshlrev_b32 v25, 2, v25
    ds_read_b32 v26, v24 offset:61184
    ds_read_b32 v21, v25 offset:61440
    s_waitcnt lgkmcnt(0)
    v_cmp_eq_u32 vcc, 4, v21
    s_nop 1
    v_cndmask_b32 v26, 1.0, v26, vcc
    v_mul_f32 v160, v160, v26
    v_mul_f32 v161, v161, v26
    v_mul_f32 v162, v162, v26
    v_mul_f32 v163, v163, v26
    v_mul_f32 v164, v164, v26
    v_mul_f32 v165, v165, v26
    v_mul_f32 v166, v166, v26
    v_mul_f32 v167, v167, v26
    v_mul_f32 v168, v168, v26
    v_mul_f32 v169, v169, v26
    v_mul_f32 v170, v170, v26
    v_mul_f32 v171, v171, v26
    v_mul_f32 v172, v172, v26
    v_mul_f32 v173, v173, v26
    v_mul_f32 v174, v174, v26
    v_mul_f32 v175, v175, v26
    v_mul_f32 v192, v192, v26
    v_mul_f32 v193, v193, v26
    v_mul_f32 v194, v194, v26
    v_mul_f32 v195, v195, v26
    v_mul_f32 v196, v196, v26
    v_mul_f32 v197, v197, v26
    v_mul_f32 v198, v198, v26
    v_mul_f32 v199, v199, v26
    v_mul_f32 v200, v200, v26
    v_mul_f32 v201, v201, v26
    v_mul_f32 v202, v202, v26
    v_mul_f32 v203, v203, v26
    v_mul_f32 v204, v204, v26
    v_mul_f32 v205, v205, v26
    v_mul_f32 v206, v206, v26
    v_mul_f32 v207, v207, v26
    v_mul_f32 v224, v224, v26
    v_mul_f32 v225, v225, v26
    v_mul_f32 v226, v226, v26
    v_mul_f32 v227, v227, v26
    v_mul_f32 v228, v228, v26
    v_mul_f32 v229, v229, v26
    v_mul_f32 v230, v230, v26
    v_mul_f32 v231, v231, v26
    v_mul_f32 v232, v232, v26
    v_mul_f32 v233, v233, v26
    v_mul_f32 v234, v234, v26
    v_mul_f32 v235, v235, v26
    v_mul_f32 v236, v236, v26
    v_mul_f32 v237, v237, v26
    v_mul_f32 v238, v238, v26
    v_mul_f32 v239, v239, v26
    ds_read_b32 v26, v24 offset:61312
    ds_read_b32 v21, v25 offset:61448
    s_waitcnt lgkmcnt(0)
    v_cmp_eq_u32 vcc, 4, v21
    s_nop 1
    v_cndmask_b32 v26, 1.0, v26, vcc
    v_mul_f32 v176, v176, v26
    v_mul_f32 v177, v177, v26
    v_mul_f32 v178, v178, v26
    v_mul_f32 v179, v179, v26
    v_mul_f32 v180, v180, v26
    v_mul_f32 v181, v181, v26
    v_mul_f32 v182, v182, v26
    v_mul_f32 v183, v183, v26
    v_mul_f32 v184, v184, v26
    v_mul_f32 v185, v185, v26
    v_mul_f32 v186, v186, v26
    v_mul_f32 v187, v187, v26
    v_mul_f32 v188, v188, v26
    v_mul_f32 v189, v189, v26
    v_mul_f32 v190, v190, v26
    v_mul_f32 v191, v191, v26
    v_mul_f32 v208, v208, v26
    v_mul_f32 v209, v209, v26
    v_mul_f32 v210, v210, v26
    v_mul_f32 v211, v211, v26
    v_mul_f32 v212, v212, v26
    v_mul_f32 v213, v213, v26
    v_mul_f32 v214, v214, v26
    v_mul_f32 v215, v215, v26
    v_mul_f32 v216, v216, v26
    v_mul_f32 v217, v217, v26
    v_mul_f32 v218, v218, v26
    v_mul_f32 v219, v219, v26
    v_mul_f32 v220, v220, v26
    v_mul_f32 v221, v221, v26
    v_mul_f32 v222, v222, v26
    v_mul_f32 v223, v223, v26
    v_mul_f32 v240, v240, v26
    v_mul_f32 v241, v241, v26
    v_mul_f32 v242, v242, v26
    v_mul_f32 v243, v243, v26
    v_mul_f32 v244, v244, v26
    v_mul_f32 v245, v245, v26
    v_mul_f32 v246, v246, v26
    v_mul_f32 v247, v247, v26
    v_mul_f32 v248, v248, v26
    v_mul_f32 v249, v249, v26
    v_mul_f32 v250, v250, v26
    v_mul_f32 v251, v251, v26
    v_mul_f32 v252, v252, v26
    v_mul_f32 v253, v253, v26
    v_mul_f32 v254, v254, v26
    v_mul_f32 v255, v255, v26
    s_nop 3
    s_branch L_rback_57
L_tbs_59:
    s_sleep 2
    s_mov_b32 s41, 0x60000
    buffer_load_dword v68, v70, s[20:23], s41 offen sc1
    s_waitcnt vmcnt(0)
    s_add_u32 s56, s56, 1
    s_cmp_lt_u32 s56, 0x61a80
    s_cbranch_scc1 L_tb_58
    s_branch L_tbb_60
L_pl_61:
    s_sleep 1
    s_add_u32 s56, s56, 1
    s_cmp_ge_u32 s56, 0x61a80
    s_cbranch_scc1 L_pd_62
    buffer_load_dwordx4 v[164:167], v8, s[20:23], s80 offen sc1
    buffer_load_dwordx4 v[168:171], v9, s[20:23], s80 offen sc1
    buffer_load_dwordx4 v[172:175], v10, s[20:23], s80 offen sc1
    buffer_load_dwordx4 v[176:179], v11, s[20:23], s80 offen sc1
    s_waitcnt vmcnt(0)
    v_xor_b32 v24, v167, v2
    v_cmp_lt_u32 vcc, 0xffff, v24
    s_nop 0
    s_and_b64 s[52:53], vcc, s[66:67]
    v_xor_b32 v24, v171, v2
    v_cmp_lt_u32 vcc, 0xffff, v24
    s_nop 0
    s_and_b64 s[54:55], vcc, s[68:69]
    s_or_b64 s[52:53], s[52:53], s[54:55]
    v_xor_b32 v24, v175, v2
    v_cmp_lt_u32 vcc, 0xffff, v24
    s_nop 0
    s_and_b64 s[54:55], vcc, s[70:71]
    s_or_b64 s[52:53], s[52:53], s[54:55]
    v_xor_b32 v24, v179, v2
    v_cmp_lt_u32 vcc, 0xffff, v24
    s_nop 0
    s_and_b64 s[54:55], vcc, s[72:73]
    s_or_b64 s[52:53], s[52:53], s[54:55]
    s_cbranch_scc1 L_pl_61
    s_branch L_pd_62
L_pl_65:
    s_sleep 1
    s_add_u32 s56, s56, 1
    s_cmp_ge_u32 s56, 0x61a80
    s_cbranch_scc1 L_pd_66
    buffer_load_dwordx4 v[164:167], v8, s[20:23], s80 offen sc1
    buffer_load_dwordx4 v[168:171], v9, s[20:23], s80 offen sc1
    buffer_load_dwordx4 v[172:175], v10, s[20:23], s80 offen sc1
    buffer_load_dwordx4 v[176:179], v11, s[20:23], s80 offen sc1
    s_waitcnt vmcnt(0)
    v_xor_b32 v24, v167, v2
    v_cmp_lt_u32 vcc, 0xffff, v24
    s_nop 0
    s_and_b64 s[52:53], vcc, s[66:67]
    v_xor_b32 v24, v171, v2
    v_cmp_lt_u32 vcc, 0xffff, v24
    s_nop 0
    s_and_b64 s[54:55], vcc, s[68:69]
    s_or_b64 s[52:53], s[52:53], s[54:55]
    v_xor_b32 v24, v175, v2
    v_cmp_lt_u32 vcc, 0xffff, v24
    s_nop 0
    s_and_b64 s[54:55], vcc, s[70:71]
    s_or_b64 s[52:53], s[52:53], s[54:55]
    v_xor_b32 v24, v179, v2
    v_cmp_lt_u32 vcc, 0xffff, v24
    s_nop 0
    s_and_b64 s[54:55], vcc, s[72:73]
    s_or_b64 s[52:53], s[52:53], s[54:55]
    s_cbranch_scc1 L_pl_65
    s_branch L_pd_66
L_pl_69:
    s_sleep 1
    s_add_u32 s56, s56, 1
    s_cmp_ge_u32 s56, 0x61a80
    s_cbranch_scc1 L_pd_70
    buffer_load_dwordx4 v[164:167], v8, s[20:23], s80 offen sc1
    buffer_load_dwordx4 v[168:171], v9, s[20:23], s80 offen sc1
    buffer_load_dwordx4 v[172:175], v10, s[20:23], s80 offen sc1
    buffer_load_dwordx4 v[176:179], v11, s[20:23], s80 offen sc1
    s_waitcnt vmcnt(0)
    v_xor_b32 v24, v167, v2
    v_cmp_lt_u32 vcc, 0xffff, v24
    s_nop 0
    s_and_b64 s[52:53], vcc, s[66:67]
    v_xor_b32 v24, v171, v2
    v_cmp_lt_u32 vcc, 0xffff, v24
    s_nop 0
    s_and_b64 s[54:55], vcc, s[68:69]
    s_or_b64 s[52:53], s[52:53], s[54:55]
    v_xor_b32 v24, v175, v2
    v_cmp_lt_u32 vcc, 0xffff, v24
    s_nop 0
    s_and_b64 s[54:55], vcc, s[70:71]
    s_or_b64 s[52:53], s[52:53], s[54:55]
    v_xor_b32 v24, v179, v2
    v_cmp_lt_u32 vcc, 0xffff, v24
    s_nop 0
    s_and_b64 s[54:55], vcc, s[72:73]
    s_or_b64 s[52:53], s[52:53], s[54:55]
    s_cbranch_scc1 L_pl_69
    s_branch L_pd_70
L_nextrow:
    s_waitcnt vmcnt(0)
    s_nop 3
    s_mov_b32 s100, 0
    s_add_u32 s4, s100, 0
    v_add_u32 v24, s4, v14
    v_cmp_gt_u32 s[66:67], s47, v24
    v_min_u32 v24, 0xff, v24
    v_lshlrev_b32 v24, 2, v24
    ds_read_b32 v8, v24 offset:63232
    s_add_u32 s4, s100, 8
    v_add_u32 v24, s4, v14
    v_cmp_gt_u32 s[68:69], s47, v24
    v_min_u32 v24, 0xff, v24
    v_lshlrev_b32 v24, 2, v24
    ds_read_b32 v9, v24 offset:63232
    s_add_u32 s4, s100, 16
    v_add_u32 v24, s4, v14
    v_cmp_gt_u32 s[70:71], s47, v24
    v_min_u32 v24, 0xff, v24
    v_lshlrev_b32 v24, 2, v24
    ds_read_b32 v10, v24 offset:63232
    s_add_u32 s4, s100, 24
    v_add_u32 v24, s4, v14
    v_cmp_gt_u32 s[72:73], s47, v24
    v_min_u32 v24, 0xff, v24
    v_lshlrev_b32 v24, 2, v24
    ds_read_b32 v11, v24 offset:63232
    v_mov_b32 v25, 0x7ffffff0
    s_waitcnt lgkmcnt(3)
    v_lshl_add_u32 v8, v8, 14, v15
    v_cndmask_b32 v8, v25, v8, s[66:67]
    s_waitcnt lgkmcnt(2)
    v_lshl_add_u32 v9, v9, 14, v15
    v_cndmask_b32 v9, v25, v9, s[68:69]
    s_waitcnt lgkmcnt(1)
    v_lshl_add_u32 v10, v10, 14, v15
    v_cndmask_b32 v10, v25, v10, s[70:71]
    s_waitcnt lgkmcnt(0)
    v_lshl_add_u32 v11, v11, 14, v15
    v_cndmask_b32 v11, v25, v11, s[72:73]
    s_lshl_b32 s80, s99, 8
    s_add_u32 s80, s80, 0x100000
    buffer_load_dwordx4 v[164:167], v8, s[20:23], s80 offen sc1
    buffer_load_dwordx4 v[168:171], v9, s[20:23], s80 offen sc1
    buffer_load_dwordx4 v[172:175], v10, s[20:23], s80 offen sc1
    buffer_load_dwordx4 v[176:179], v11, s[20:23], s80 offen sc1
    s_waitcnt vmcnt(0)
    v_xor_b32 v24, v167, v2
    v_cmp_lt_u32 vcc, 0xffff, v24
    s_nop 0
    s_and_b64 s[52:53], vcc, s[66:67]
    v_xor_b32 v24, v171, v2
    v_cmp_lt_u32 vcc, 0xffff, v24
    s_nop 0
    s_and_b64 s[54:55], vcc, s[68:69]
    s_or_b64 s[52:53], s[52:53], s[54:55]
    v_xor_b32 v24, v175, v2
    v_cmp_lt_u32 vcc, 0xffff, v24
    s_nop 0
    s_and_b64 s[54:55], vcc, s[70:71]
    s_or_b64 s[52:53], s[52:53], s[54:55]
    v_xor_b32 v24, v179, v2
    v_cmp_lt_u32 vcc, 0xffff, v24
    s_nop 0
    s_and_b64 s[54:55], vcc, s[72:73]
    s_or_b64 s[52:53], s[52:53], s[54:55]
    s_cbranch_scc1 L_pl_65
L_pd_66:
    v_and_b32 v24, 0xffff, v167
    s_nop 1
    v_mov_b32_dpp v40, v24 quad_perm:[0,0,0,0] row_mask:0xf bank_mask:0xf
    v_mov_b32_dpp v25, v24 quad_perm:[1,1,1,1] row_mask:0xf bank_mask:0xf
    v_mov_b32_dpp v44, v24 quad_perm:[2,2,2,2] row_mask:0xf bank_mask:0xf
    v_mov_b32_dpp v26, v24 quad_perm:[3,3,3,3] row_mask:0xf bank_mask:0xf
    v_lshl_or_b32 v40, v40, 16, v25
    v_lshl_or_b32 v44, v44, 16, v26
    v_cndmask_b32 v40, v3, v40, s[66:67]
    v_and_b32 v24, 0xffff, v171
    s_nop 1
    v_mov_b32_dpp v41, v24 quad_perm:[0,0,0,0] row_mask:0xf bank_mask:0xf
    v_mov_b32_dpp v25, v24 quad_perm:[1,1,1,1] row_mask:0xf bank_mask:0xf
    v_mov_b32_dpp v45, v24 quad_perm:[2,2,2,2] row_mask:0xf bank_mask:0xf
    v_mov_b32_dpp v26, v24 quad_perm:[3,3,3,3] row_mask:0xf bank_mask:0xf
    v_lshl_or_b32 v41, v41, 16, v25
    v_lshl_or_b32 v45, v45, 16, v26
    v_cndmask_b32 v41, v3, v41, s[68:69]
    v_and_b32 v24, 0xffff, v175
    s_nop 1
    v_mov_b32_dpp v42, v24 quad_perm:[0,0,0,0] row_mask:0xf bank_mask:0xf
    v_mov_b32_dpp v25, v24 quad_perm:[1,1,1,1] row_mask:0xf bank_mask:0xf
    v_mov_b32_dpp v46, v24 quad_perm:[2,2,2,2] row_mask:0xf bank_mask:0xf
    v_mov_b32_dpp v26, v24 quad_perm:[3,3,3,3] row_mask:0xf bank_mask:0xf
    v_lshl_or_b32 v42, v42, 16, v25
    v_lshl_or_b32 v46, v46, 16, v26
    v_cndmask_b32 v42, v3, v42, s[70:71]
    v_and_b32 v24, 0xffff, v179
    s_nop 1
    v_mov_b32_dpp v43, v24 quad_perm:[0,0,0,0] row_mask:0xf bank_mask:0xf
    v_mov_b32_dpp v25, v24 quad_perm:[1,1,1,1] row_mask:0xf bank_mask:0xf
    v_mov_b32_dpp v47, v24 quad_perm:[2,2,2,2] row_mask:0xf bank_mask:0xf
    v_mov_b32_dpp v26, v24 quad_perm:[3,3,3,3] row_mask:0xf bank_mask:0xf
    v_lshl_or_b32 v43, v43, 16, v25
    v_lshl_or_b32 v47, v47, 16, v26
    v_cndmask_b32 v43, v3, v43, s[72:73]
    v_max3_f32 v38, v40, v41, v42
    v_max_f32 v38, v38, v43
    s_nop 1
    v_max_f32_dpp v38, v38, v38 row_ror:8 row_mask:0xf bank_mask:0xf
    v_mov_b32 v26, v38
    s_nop 1
    v_permlane16_swap_b32 v26, v38
    v_max_f32 v38, v38, v26
    v_mov_b32 v26, v38
    s_nop 1
    v_permlane32_swap_b32 v26, v38
    v_max_f32 v38, v38, v26
    v_sub_f32 v40, v40, v38
    v_sub_f32 v41, v41, v38
    v_sub_f32 v42, v42, v38
    v_sub_f32 v43, v43, v38
    v_exp_f32 v40, v40
    v_exp_f32 v41, v41
    v_exp_f32 v42, v42
    v_exp_f32 v43, v43
    v_mul_f32 v39, v40, v44
    v_lshlrev_b32 v76, 16, v164
    v_and_b32 v77, 0xffff0000, v164
    v_pk_mul_f32 v[32:33], v[76:77], v[40:41] op_sel:[0,0] op_sel_hi:[1,0]
    v_lshlrev_b32 v76, 16, v165
    v_and_b32 v77, 0xffff0000, v165
    v_pk_mul_f32 v[34:35], v[76:77], v[40:41] op_sel:[0,0] op_sel_hi:[1,0]
    v_lshlrev_b32 v76, 16, v166
    v_and_b32 v77, 0xffff0000, v166
    v_pk_mul_f32 v[36:37], v[76:77], v[40:41] op_sel:[0,0] op_sel_hi:[1,0]
    v_fma_f32 v39, v41, v45, v39
    v_lshlrev_b32 v76, 16, v168
    v_and_b32 v77, 0xffff0000, v168
    v_pk_fma_f32 v[32:33], v[76:77], v[40:41], v[32:33] op_sel:[0,1,0] op_sel_hi:[1,1,1]
    v_lshlrev_b32 v76, 16, v169
    v_and_b32 v77, 0xffff0000, v169
    v_pk_fma_f32 v[34:35], v[76:77], v[40:41], v[34:35] op_sel:[0,1,0] op_sel_hi:[1,1,1]
    v_lshlrev_b32 v76, 16, v170
    v_and_b32 v77, 0xffff0000, v170
    v_pk_fma_f32 v[36:37], v[76:77], v[40:41], v[36:37] op_sel:[0,1,0] op_sel_hi:[1,1,1]
    v_fma_f32 v39, v42, v46, v39
    v_lshlrev_b32 v76, 16, v172
    v_and_b32 v77, 0xffff0000, v172
    v_pk_fma_f32 v[32:33], v[76:77], v[42:43], v[32:33] op_sel:[0,0,0] op_sel_hi:[1,0,1]
    v_lshlrev_b32 v76, 16, v173
    v_and_b32 v77, 0xffff0000, v173
    v_pk_fma_f32 v[34:35], v[76:77], v[42:43], v[34:35] op_sel:[0,0,0] op_sel_hi:[1,0,1]
    v_lshlrev_b32 v76, 16, v174
    v_and_b32 v77, 0xffff0000, v174
    v_pk_fma_f32 v[36:37], v[76:77], v[42:43], v[36:37] op_sel:[0,0,0] op_sel_hi:[1,0,1]
    v_fma_f32 v39, v43, v47, v39
    v_lshlrev_b32 v76, 16, v176
    v_and_b32 v77, 0xffff0000, v176
    v_pk_fma_f32 v[32:33], v[76:77], v[42:43], v[32:33] op_sel:[0,1,0] op_sel_hi:[1,1,1]
    v_lshlrev_b32 v76, 16, v177
    v_and_b32 v77, 0xffff0000, v177
    v_pk_fma_f32 v[34:35], v[76:77], v[42:43], v[34:35] op_sel:[0,1,0] op_sel_hi:[1,1,1]
    v_lshlrev_b32 v76, 16, v178
    v_and_b32 v77, 0xffff0000, v178
    v_pk_fma_f32 v[36:37], v[76:77], v[42:43], v[36:37] op_sel:[0,1,0] op_sel_hi:[1,1,1]
L_more:
    s_nop 3
    s_add_u32 s100, s100, 32
    s_cmp_ge_u32 s100, s47
    s_cbranch_scc1 L_rowdone
    s_add_u32 s4, s100, 0
    v_add_u32 v24, s4, v14
    v_cmp_gt_u32 s[66:67], s47, v24
    v_min_u32 v24, 0xff, v24
    v_lshlrev_b32 v24, 2, v24
    ds_read_b32 v8, v24 offset:63232
    s_add_u32 s4, s100, 8
    v_add_u32 v24, s4, v14
    v_cmp_gt_u32 s[68:69], s47, v24
    v_min_u32 v24, 0xff, v24
    v_lshlrev_b32 v24, 2, v24
    ds_read_b32 v9, v24 offset:63232
    s_add_u32 s4, s100, 16
    v_add_u32 v24, s4, v14
    v_cmp_gt_u32 s[70:71], s47, v24
    v_min_u32 v24, 0xff, v24
    v_lshlrev_b32 v24, 2, v24
    ds_read_b32 v10, v24 offset:63232
    s_add_u32 s4, s100, 24
    v_add_u32 v24, s4, v14
    v_cmp_gt_u32 s[72:73], s47, v24
    v_min_u32 v24, 0xff, v24
    v_lshlrev_b32 v24, 2, v24
    ds_read_b32 v11, v24 offset:63232
    v_mov_b32 v25, 0x7ffffff0
    s_waitcnt lgkmcnt(3)
    v_lshl_add_u32 v8, v8, 14, v15
    v_cndmask_b32 v8, v25, v8, s[66:67]
    s_waitcnt lgkmcnt(2)
    v_lshl_add_u32 v9, v9, 14, v15
    v_cndmask_b32 v9, v25, v9, s[68:69]
    s_waitcnt lgkmcnt(1)
    v_lshl_add_u32 v10, v10, 14, v15
    v_cndmask_b32 v10, v25, v10, s[70:71]
    s_waitcnt lgkmcnt(0)
    v_lshl_add_u32 v11, v11, 14, v15
    v_cndmask_b32 v11, v25, v11, s[72:73]
    s_lshl_b32 s80, s99, 8
    s_add_u32 s80, s80, 0x100000
    buffer_load_dwordx4 v[164:167], v8, s[20:23], s80 offen sc1
    buffer_load_dwordx4 v[168:171], v9, s[20:23], s80 offen sc1
    buffer_load_dwordx4 v[172:175], v10, s[20:23], s80 offen sc1
    buffer_load_dwordx4 v[176:179], v11, s[20:23], s80 offen sc1
    s_waitcnt vmcnt(0)
    v_xor_b32 v24, v167, v2
    v_cmp_lt_u32 vcc, 0xffff, v24
    s_nop 0
    s_and_b64 s[52:53], vcc, s[66:67]
    v_xor_b32 v24, v171, v2
    v_cmp_lt_u32 vcc, 0xffff, v24
    s_nop 0
    s_and_b64 s[54:55], vcc, s[68:69]
    s_or_b64 s[52:53], s[52:53], s[54:55]
    v_xor_b32 v24, v175, v2
    v_cmp_lt_u32 vcc, 0xffff, v24
    s_nop 0
    s_and_b64 s[54:55], vcc, s[70:71]
    s_or_b64 s[52:53], s[52:53], s[54:55]
    v_xor_b32 v24, v179, v2
    v_cmp_lt_u32 vcc, 0xffff, v24
    s_nop 0
    s_and_b64 s[54:55], vcc, s[72:73]
    s_or_b64 s[52:53], s[52:53], s[54:55]
    s_cbranch_scc1 L_pl_69
L_pd_70:
    v_and_b32 v24, 0xffff, v167
    s_nop 1
    v_mov_b32_dpp v40, v24 quad_perm:[0,0,0,0] row_mask:0xf bank_mask:0xf
    v_mov_b32_dpp v25, v24 quad_perm:[1,1,1,1] row_mask:0xf bank_mask:0xf
    v_mov_b32_dpp v44, v24 quad_perm:[2,2,2,2] row_mask:0xf bank_mask:0xf
    v_mov_b32_dpp v26, v24 quad_perm:[3,3,3,3] row_mask:0xf bank_mask:0xf
    v_lshl_or_b32 v40, v40, 16, v25
    v_lshl_or_b32 v44, v44, 16, v26
    v_cndmask_b32 v40, v3, v40, s[66:67]
    v_and_b32 v24, 0xffff, v171
    s_nop 1
    v_mov_b32_dpp v41, v24 quad_perm:[0,0,0,0] row_mask:0xf bank_mask:0xf
    v_mov_b32_dpp v25, v24 quad_perm:[1,1,1,1] row_mask:0xf bank_mask:0xf
    v_mov_b32_dpp v45, v24 quad_perm:[2,2,2,2] row_mask:0xf bank_mask:0xf
    v_mov_b32_dpp v26, v24 quad_perm:[3,3,3,3] row_mask:0xf bank_mask:0xf
    v_lshl_or_b32 v41, v41, 16, v25
    v_lshl_or_b32 v45, v45, 16, v26
    v_cndmask_b32 v41, v3, v41, s[68:69]
    v_and_b32 v24, 0xffff, v175
    s_nop 1
    v_mov_b32_dpp v42, v24 quad_perm:[0,0,0,0] row_mask:0xf bank_mask:0xf
    v_mov_b32_dpp v25, v24 quad_perm:[1,1,1,1] row_mask:0xf bank_mask:0xf
    v_mov_b32_dpp v46, v24 quad_perm:[2,2,2,2] row_mask:0xf bank_mask:0xf
    v_mov_b32_dpp v26, v24 quad_perm:[3,3,3,3] row_mask:0xf bank_mask:0xf
    v_lshl_or_b32 v42, v42, 16, v25
    v_lshl_or_b32 v46, v46, 16, v26
    v_cndmask_b32 v42, v3, v42, s[70:71]
    v_and_b32 v24, 0xffff, v179
    s_nop 1
    v_mov_b32_dpp v43, v24 quad_perm:[0,0,0,0] row_mask:0xf bank_mask:0xf
    v_mov_b32_dpp v25, v24 quad_perm:[1,1,1,1] row_mask:0xf bank_mask:0xf
    v_mov_b32_dpp v47, v24 quad_perm:[2,2,2,2] row_mask:0xf bank_mask:0xf
    v_mov_b32_dpp v26, v24 quad_perm:[3,3,3,3] row_mask:0xf bank_mask:0xf
    v_lshl_or_b32 v43, v43, 16, v25
    v_lshl_or_b32 v47, v47, 16, v26
    v_cndmask_b32 v43, v3, v43, s[72:73]
    v_max3_f32 v76, v40, v41, v42
    v_max_f32 v76, v76, v43
    s_nop 1
    v_max_f32_dpp v76, v76, v76 row_ror:8 row_mask:0xf bank_mask:0xf
    v_mov_b32 v26, v76
    s_nop 1
    v_permlane16_swap_b32 v26, v76
    v_max_f32 v76, v76, v26
    v_mov_b32 v26, v76
    s_nop 1
    v_permlane32_swap_b32 v26, v76
    v_max_f32 v76, v76, v26
    v_max_f32 v76, v76, v38
    v_sub_f32 v25, v38, v76
    v_exp_f32 v25, v25
    v_mov_b32 v38, v76
    v_mul_f32 v39, v39, v25
    v_mul_f32 v32, v32, v25
    v_mul_f32 v33, v33, v25
    v_mul_f32 v34, v34, v25
    v_mul_f32 v35, v35, v25
    v_mul_f32 v36, v36, v25
    v_mul_f32 v37, v37, v25
    v_sub_f32 v40, v40, v38
    v_sub_f32 v41, v41, v38
    v_sub_f32 v42, v42, v38
    v_sub_f32 v43, v43, v38
    v_exp_f32 v40, v40
    v_exp_f32 v41, v41
    v_exp_f32 v42, v42
    v_exp_f32 v43, v43
    v_fma_f32 v39, v40, v44, v39
    v_lshlrev_b32 v76, 16, v164
    v_and_b32 v77, 0xffff0000, v164
    v_pk_fma_f32 v[32:33], v[76:77], v[40:41], v[32:33] op_sel:[0,0,0] op_sel_hi:[1,0,1]
    v_lshlrev_b32 v76, 16, v165
    v_and_b32 v77, 0xffff0000, v165
    v_pk_fma_f32 v[34:35], v[76:77], v[40:41], v[34:35] op_sel:[0,0,0] op_sel_hi:[1,0,1]
    v_lshlrev_b32 v76, 16, v166
    v_and_b32 v77, 0xffff0000, v166
    v_pk_fma_f32 v[36:37], v[76:77], v[40:41], v[36:37] op_sel:[0,0,0] op_sel_hi:[1,0,1]
    v_fma_f32 v39, v41, v45, v39
    v_lshlrev_b32 v76, 16, v168
    v_and_b32 v77, 0xffff0000, v168
    v_pk_fma_f32 v[32:33], v[76:77], v[40:41], v[32:33] op_sel:[0,1,0] op_sel_hi:[1,1,1]
    v_lshlrev_b32 v76, 16, v169
    v_and_b32 v77, 0xffff0000, v169
    v_pk_fma_f32 v[34:35], v[76:77], v[40:41], v[34:35] op_sel:[0,1,0] op_sel_hi:[1,1,1]
    v_lshlrev_b32 v76, 16, v170
    v_and_b32 v77, 0xffff0000, v170
    v_pk_fma_f32 v[36:37], v[76:77], v[40:41], v[36:37] op_sel:[0,1,0] op_sel_hi:[1,1,1]
    v_fma_f32 v39, v42, v46, v39
    v_lshlrev_b32 v76, 16, v172
    v_and_b32 v77, 0xffff0000, v172
    v_pk_fma_f32 v[32:33], v[76:77], v[42:43], v[32:33] op_sel:[0,0,0] op_sel_hi:[1,0,1]
    v_lshlrev_b32 v76, 16, v173
    v_and_b32 v77, 0xffff0000, v173
    v_pk_fma_f32 v[34:35], v[76:77], v[42:43], v[34:35] op_sel:[0,0,0] op_sel_hi:[1,0,1]
    v_lshlrev_b32 v76, 16, v174
    v_and_b32 v77, 0xffff0000, v174
    v_pk_fma_f32 v[36:37], v[76:77], v[42:43], v[36:37] op_sel:[0,0,0] op_sel_hi:[1,0,1]
    v_fma_f32 v39, v43, v47, v39
    v_lshlrev_b32 v76, 16, v176
    v_and_b32 v77, 0xffff0000, v176
    v_pk_fma_f32 v[32:33], v[76:77], v[42:43], v[32:33] op_sel:[0,1,0] op_sel_hi:[1,1,1]
    v_lshlrev_b32 v76, 16, v177
    v_and_b32 v77, 0xffff0000, v177
    v_pk_fma_f32 v[34:35], v[76:77], v[42:43], v[34:35] op_sel:[0,1,0] op_sel_hi:[1,1,1]
    v_lshlrev_b32 v76, 16, v178
    v_and_b32 v77, 0xffff0000, v178
    v_pk_fma_f32 v[36:37], v[76:77], v[42:43], v[36:37] op_sel:[0,1,0] op_sel_hi:[1,1,1]
    s_branch L_more
L_pl_73:
    s_sleep 4
    s_add_u32 s56, s56, 1
    s_cmp_ge_u32 s56, 0x61a80
    s_cbranch_scc1 L_pd_74
    buffer_load_dwordx4 v[164:167], v12, s[20:23], s81 offen sc1
    buffer_load_dwordx4 v[168:171], v13, s[20:23], s81 offen sc1
    s_waitcnt vmcnt(0)
    v_xor_b32 v24, v167, v2
    v_cmp_lt_u32 vcc, 0xffff, v24
    s_nop 0
    s_and_b64 s[52:53], vcc, s[74:75]
    v_xor_b32 v24, v171, v2
    v_cmp_lt_u32 vcc, 0xffff, v24
    s_nop 0
    s_and_b64 s[54:55], vcc, s[76:77]
    s_or_b64 s[52:53], s[52:53], s[54:55]
    s_cbranch_scc1 L_pl_73
    s_branch L_pd_74
L_pl_77:
    s_sleep 4
    s_add_u32 s56, s56, 1
    s_cmp_ge_u32 s56, 0x61a80
    s_cbranch_scc1 L_pd_78
    buffer_load_dwordx4 v[164:167], v12, s[20:23], s81 offen sc1
    buffer_load_dwordx4 v[168:171], v13, s[20:23], s81 offen sc1
    s_waitcnt vmcnt(0)
    v_xor_b32 v24, v167, v2
    v_cmp_lt_u32 vcc, 0xffff, v24
    s_nop 0
    s_and_b64 s[52:53], vcc, s[74:75]
    v_xor_b32 v24, v171, v2
    v_cmp_lt_u32 vcc, 0xffff, v24
    s_nop 0
    s_and_b64 s[54:55], vcc, s[76:77]
    s_or_b64 s[52:53], s[52:53], s[54:55]
    s_cbranch_scc1 L_pl_77
    s_branch L_pd_78
L_moreB:
    s_nop 3
    v_mov_b32 v26, 0x7ffffff0
    v_add_u32 v24, 8, v16
    v_lshrrev_b32 v25, v24, s49
    v_and_b32 v25, 1, v25
    v_cmp_eq_u32 s[74:75], 1, v25
    v_lshl_add_u32 v12, v24, 8, v17
    s_nop 0
    v_cndmask_b32 v12, v26, v12, s[74:75]
    v_add_u32 v24, 12, v16
    v_lshrrev_b32 v25, v24, s49
    v_and_b32 v25, 1, v25
    v_cmp_eq_u32 s[76:77], 1, v25
    v_lshl_add_u32 v13, v24, 8, v17
    s_nop 0
    v_cndmask_b32 v13, v26, v13, s[76:77]
    buffer_load_dwordx4 v[164:167], v12, s[20:23], s81 offen sc1
    buffer_load_dwordx4 v[168:171], v13, s[20:23], s81 offen sc1
    s_waitcnt vmcnt(0)
    v_xor_b32 v24, v167, v2
    v_cmp_lt_u32 vcc, 0xffff, v24
    s_nop 0
    s_and_b64 s[52:53], vcc, s[74:75]
    v_xor_b32 v24, v171, v2
    v_cmp_lt_u32 vcc, 0xffff, v24
    s_nop 0
    s_and_b64 s[54:55], vcc, s[76:77]
    s_or_b64 s[52:53], s[52:53], s[54:55]
    s_cbranch_scc1 L_pl_77
L_pd_78:
    v_and_b32 v24, 0xffff, v167
    s_nop 1
    v_mov_b32_dpp v40, v24 quad_perm:[0,0,0,0] row_mask:0xf bank_mask:0xf
    v_mov_b32_dpp v25, v24 quad_perm:[1,1,1,1] row_mask:0xf bank_mask:0xf
    v_mov_b32_dpp v44, v24 quad_perm:[2,2,2,2] row_mask:0xf bank_mask:0xf
    v_mov_b32_dpp v26, v24 quad_perm:[3,3,3,3] row_mask:0xf bank_mask:0xf
    v_lshl_or_b32 v40, v40, 16, v25
    v_lshl_or_b32 v44, v44, 16, v26
    v_cndmask_b32 v40, v3, v40, s[74:75]
    v_and_b32 v24, 0xffff, v171
    s_nop 1
    v_mov_b32_dpp v41, v24 quad_perm:[0,0,0,0] row_mask:0xf bank_mask:0xf
    v_mov_b32_dpp v25, v24 quad_perm:[1,1,1,1] row_mask:0xf bank_mask:0xf
    v_mov_b32_dpp v45, v24 quad_perm:[2,2,2,2] row_mask:0xf bank_mask:0xf
    v_mov_b32_dpp v26, v24 quad_perm:[3,3,3,3] row_mask:0xf bank_mask:0xf
    v_lshl_or_b32 v41, v41, 16, v25
    v_lshl_or_b32 v45, v45, 16, v26
    v_cndmask_b32 v41, v3, v41, s[76:77]
    v_max_f32 v76, v40, v41
    v_mov_b32 v26, v76
    s_nop 1
    v_permlane16_swap_b32 v26, v76
    v_max_f32 v76, v76, v26
    v_mov_b32 v26, v76
    s_nop 1
    v_permlane32_swap_b32 v26, v76
    v_max_f32 v76, v76, v26
    v_max_f32 v76, v76, v38
    v_sub_f32 v25, v38, v76
    v_exp_f32 v25, v25
    v_mov_b32 v38, v76
    v_mul_f32 v39, v39, v25
    v_mul_f32 v32, v32, v25
    v_mul_f32 v33, v33, v25
    v_mul_f32 v34, v34, v25
    v_mul_f32 v35, v35, v25
    v_mul_f32 v36, v36, v25
    v_mul_f32 v37, v37, v25
    v_sub_f32 v40, v40, v38
    v_sub_f32 v41, v41, v38
    v_exp_f32 v40, v40
    v_exp_f32 v41, v41
    v_fma_f32 v39, v40, v44, v39
    v_lshlrev_b32 v76, 16, v164
    v_and_b32 v77, 0xffff0000, v164
    v_pk_fma_f32 v[32:33], v[76:77], v[40:41], v[32:33] op_sel:[0,0,0] op_sel_hi:[1,0,1]
    v_lshlrev_b32 v76, 16, v165
    v_and_b32 v77, 0xffff0000, v165
    v_pk_fma_f32 v[34:35], v[76:77], v[40:41], v[34:35] op_sel:[0,0,0] op_sel_hi:[1,0,1]
    v_lshlrev_b32 v76, 16, v166
    v_and_b32 v77, 0xffff0000, v166
    v_pk_fma_f32 v[36:37], v[76:77], v[40:41], v[36:37] op_sel:[0,0,0] op_sel_hi:[1,0,1]
    v_fma_f32 v39, v41, v45, v39
    v_lshlrev_b32 v76, 16, v168
    v_and_b32 v77, 0xffff0000, v168
    v_pk_fma_f32 v[32:33], v[76:77], v[40:41], v[32:33] op_sel:[0,1,0] op_sel_hi:[1,1,1]
    v_lshlrev_b32 v76, 16, v169
    v_and_b32 v77, 0xffff0000, v169
    v_pk_fma_f32 v[34:35], v[76:77], v[40:41], v[34:35] op_sel:[0,1,0] op_sel_hi:[1,1,1]
    v_lshlrev_b32 v76, 16, v170
    v_and_b32 v77, 0xffff0000, v170
    v_pk_fma_f32 v[36:37], v[76:77], v[40:41], v[36:37] op_sel:[0,1,0] op_sel_hi:[1,1,1]
    s_nop 3
    s_branch L_fin
L_codeend:
    s_endpgm
.section .rodata,"a"
.p2align 6
.amdhsa_kernel standalone__detection_seg_mask2former__vision_kernel
  .amdhsa_next_free_vgpr 256
  .amdhsa_next_free_sgpr 102
  .amdhsa_accum_offset 256
  .amdhsa_group_segment_fixed_size 0
  .amdhsa_kernarg_size 96
  .amdhsa_user_sgpr_count 2
  .amdhsa_user_sgpr_kernarg_segment_ptr 1
  .amdhsa_system_sgpr_workgroup_id_x 1
  .amdhsa_float_denorm_mode_32 3
.end_amdhsa_kernel
```
